```python
import torch

def _softmax(x, axis=-1):
    return torch.softmax(x, dim=axis)
def _gelu(x):
    return torch.nn.functional.gelu(x, approximate="tanh")
def _silu(x):
    return torch.nn.functional.silu(x)
def _sigmoid(x):
    return torch.sigmoid(x)
def _layernorm(x, axis=-1, eps=1e-5):
    m = x.mean(dim=axis, keepdim=True)
    v = x.var(dim=axis, keepdim=True, unbiased=False)
    return (x - m) / torch.sqrt(v + eps)
def _scatter_add(tgt, idx, src, axis=0):
    return tgt.clone().index_add_(axis, idx, src)
def _segment_sum(src, seg, n):
    out = torch.zeros((n,) + src.shape[1:], dtype=src.dtype)
    return out.index_add_(0, seg, src)
def _pad(x, pw):
    flat = tuple(v for pair in reversed(pw) for v in pair)
    return torch.nn.functional.pad(x, flat)

kernel_name = 'gated_mix__ssm_conv_s5__softmax_full_mha__prompt'

def setup_inputs():

    _w = (lambda a: (lambda t: t.to(torch.bfloat16) if t.is_floating_point() else t)(torch.as_tensor(a)))
    def _A_setup():
        B, S, D = 1, 2048, 1024
        P = D
        Lambda_re = -0.5 * (lambda _x: torch.exp(torch.as_tensor(_x)))((lambda *s: torch.randn(*s, dtype=torch.bfloat16) * 0.4)(P))
        Lambda_im = (lambda *s: torch.randn(*s, dtype=torch.bfloat16) * 0.4)(P) * 1.0
        B_re = (lambda *s: torch.randn(*s, dtype=torch.bfloat16) * 0.4)(P, D) * (D ** -0.5)
        B_im = (lambda *s: torch.randn(*s, dtype=torch.bfloat16) * 0.4)(P, D) * (D ** -0.5)
        C_re = (lambda *s: torch.randn(*s, dtype=torch.bfloat16) * 0.4)(D, P) * (P ** -0.5)
        C_im = (lambda *s: torch.randn(*s, dtype=torch.bfloat16) * 0.4)(D, P) * (P ** -0.5)
        log_dt = (lambda *s: torch.randn(*s, dtype=torch.bfloat16) * 0.4)(P) * 0.3 - 2.0
        Dskip = (lambda *s: torch.randn(*s, dtype=torch.bfloat16) * 0.05)(D)
        return {
            "x": _w((lambda *s: torch.randn(*s, dtype=torch.bfloat16) * 0.05)(B, S, D)),
            "Lambda_re": _w(Lambda_re),
            "Lambda_im": _w(Lambda_im),
            "B_re": _w(B_re),
            "B_im": _w(B_im),
            "C_re": _w(C_re),
            "C_im": _w(C_im),
            "log_dt": _w(log_dt),
            "Dskip": _w(Dskip),
        }
    _A_in = _A_setup()

    def _B_setup():
        B, S, D = 1, 2048, 1024
        return {
            "x": _w((lambda *s: torch.randn(*s, dtype=torch.bfloat16) * 0.05)(B, S, D)),
            "wqkv": _w((lambda *s: torch.randn(*s, dtype=torch.bfloat16) * 0.4)(D, 3 * D)),
            "wo": _w((lambda *s: torch.randn(*s, dtype=torch.bfloat16) * 0.05)(D, D)),
        }
    _B_in = _B_setup()

    return {
        "A_x": _A_in["x"],
        "A_Lambda_re": _A_in["Lambda_re"],
        "A_Lambda_im": _A_in["Lambda_im"],
        "A_B_re": _A_in["B_re"],
        "A_B_im": _A_in["B_im"],
        "A_C_re": _A_in["C_re"],
        "A_C_im": _A_in["C_im"],
        "A_log_dt": _A_in["log_dt"],
        "A_Dskip": _A_in["Dskip"],
        "B_x": _B_in["x"],
        "B_wqkv": _B_in["wqkv"],
        "B_wo": _B_in["wo"],
        "gate_w": _w((lambda *s: torch.randn(*s, dtype=torch.bfloat16) * 0.05)(1024) * 16.0),
    }

def reference(A_x, A_Lambda_re, A_Lambda_im, A_B_re, A_B_im, A_C_re, A_C_im, A_log_dt, A_Dskip, B_x, B_wqkv, B_wo, gate_w):
    def _A_ref(x, Lambda_re, Lambda_im, B_re, B_im, C_re, C_im, log_dt, Dskip):
        Bsz, L, H = x.shape
        Lam = Lambda_re + 1j * Lambda_im
        Bmat = B_re + 1j * B_im
        Cmat = C_re + 1j * C_im
        dt = torch.exp(log_dt)
        Lam_bar = torch.exp(dt * Lam)
        B_bar = ((Lam_bar - 1.0) / Lam)[:, None] * Bmat
        Bu = torch.einsum("bld,pd->blp", x + 0j, B_bar)
        h = torch.zeros_like(Bu[:, 0, :])
        hs = []
        for t in range(L):
            h = Lam_bar[None, :] * h + Bu[:, t, :]
            hs.append(h)
        hseq = torch.stack(hs, 1)
        y = 2.0 * torch.einsum("blp,dp->bld", hseq, Cmat).real + x * Dskip[None, None, :]
        return y

    def _B_ref(x, wqkv, wo):
        B, S, D = x.shape
        H = 32; Dh = D // H
        qkv = (lambda x, *d: x.permute(*d))((x @ wqkv).reshape(B, S, 3, H, Dh), 2, 0, 3, 1, 4)
        q, k, v = qkv[0], qkv[1], qkv[2]
        scale = Dh ** -0.5
        scores = torch.einsum("bhqd,bhkd->bhqk", q, k) * scale
        p = _softmax(scores, axis=-1)
        o = torch.einsum("bhqk,bhkd->bhqd", p, v)
        return (lambda x, *d: x.permute(*d))(o, 0, 2, 1, 3).reshape(B, S, D) @ wo

    x = A_x
    g = _sigmoid((x * gate_w).sum(-1, keepdims=True))
    a = _A_ref(x, A_Lambda_re, A_Lambda_im, A_B_re, A_B_im, A_C_re, A_C_im, A_log_dt, A_Dskip)
    b = _B_ref(x, B_wqkv, B_wo)
    return g * a + (1 - g) * b
```

```asm
; @launch grid=(256,1,1) block=(512,1,1) lds=163840
.amdgcn_target "amdgcn-amd-amdhsa--gfx950"
.text
.globl gated_mix__ssm_conv_s5__softmax_full_mha__prompt_kernel
.p2align 8
.type gated_mix__ssm_conv_s5__softmax_full_mha__prompt_kernel,@function
gated_mix__ssm_conv_s5__softmax_full_mha__prompt_kernel:
    s_cmp_ge_u32 s2, 256
    s_cbranch_scc1 L_end
    s_load_dwordx16 s[8:23], s[0:1], 0
    s_load_dwordx16 s[24:39], s[0:1], 64
    v_lshrrev_b32 v1, 6, v0
    v_and_b32 v0, 63, v0
    v_readfirstlane_b32 s3, v1
    s_and_b32 s5, s2, 7
    s_lshl_b32 s5, s5, 2
    s_lshr_b32 s4, s2, 3
    s_and_b32 s6, s4, 3
    s_add_u32 s5, s5, s6
    s_lshr_b32 s4, s4, 2
    s_cmp_lt_u32 s3, 4
    s_cbranch_scc1 L_comp
    s_sub_u32 s101, s3, 4
    v_lshrrev_b32 v34, 5, v0
    v_lshlrev_b32 v34, 4, v34
    v_bfe_u32 v35, v0, 3, 2
    v_add_u32 v34, v34, v35
    s_lshl_b32 s7, s101, 6
    v_add_u32 v34, s7, v34
    v_lshlrev_b32 v34, 11, v34
    v_and_b32 v35, 7, v0
    v_lshrrev_b32 v36, 4, v0
    v_xor_b32 v37, v35, v36
    v_lshlrev_b32 v37, 4, v37
    v_xor_b32 v38, 64, v37
    v_add_u32 v20, 0, v34
    v_add_u32 v20, v20, v37
    v_add_u32 v21, 65536, v34
    v_add_u32 v21, v21, v38
    v_add_u32 v22, 8192, v34
    v_add_u32 v22, v22, v37
    v_add_u32 v23, 73728, v34
    v_add_u32 v23, v23, v38
    v_add_u32 v24, 16384, v34
    v_add_u32 v24, v24, v37
    v_add_u32 v25, 81920, v34
    v_add_u32 v25, v25, v38
    v_add_u32 v26, 24576, v34
    v_add_u32 v26, v26, v37
    v_add_u32 v27, 90112, v34
    v_add_u32 v27, v27, v38
    s_and_b32 s7, s101, 1
    s_lshl_b32 s7, s7, 4
    s_lshl_b32 s6, s5, 5
    s_add_u32 s7, s7, s6
    v_lshrrev_b32 v34, 3, v0
    v_add_u32 v34, s7, v34
    v_lshlrev_b32 v34, 11, v34
    v_add_u32 v28, v34, v37
    v_add_u32 v29, v34, v38
    v_add_u32 v29, 16384, v29
    s_lshl_b32 s7, s101, 4
    v_lshrrev_b32 v34, 2, v0
    v_add_u32 v34, s7, v34
    v_mul_u32_u24 v34, 6144, v34
    v_and_b32 v35, 3, v0
    v_lshrrev_b32 v36, 5, v0
    v_lshlrev_b32 v36, 1, v36
    v_xor_b32 v35, v35, v36
    v_lshl_add_u32 v34, v35, 4, v34
    s_lshl_b32 s7, s5, 6
    v_add_u32 v30, s7, v34
    v_add_u32 v31, 2048, v30
    v_add_u32 v32, 4096, v30
    s_waitcnt lgkmcnt(0)
    s_lshl_b32 s7, s4, 19
    s_add_u32 s40, s8, s7
    s_addc_u32 s41, s9, 0
    s_mov_b32 s42, 524288
    s_mov_b32 s43, 0x20000
    s_cmp_ge_u32 s101, 2
    s_cselect_b32 s44, s16, s14
    s_cselect_b32 s45, s17, s15
    s_mov_b32 s46, 2097152
    s_mov_b32 s47, 0x20000
    s_mov_b32 s48, s28
    s_mov_b32 s49, s29
    s_mov_b32 s50, 6291456
    s_mov_b32 s51, 0x20000
    s_lshr_b32 s14, s4, 0
    s_lshl_b32 s14, s14, 8
    s_mul_i32 s15, s14, 3072
    s_lshl_b32 s16, s101, 13
    s_lshl_b32 s17, s101, 11
    s_add_u32 s17, s17, 98304
    s_lshl_b32 s28, s101, 10
    s_add_u32 s28, s28, 122880
    s_add_u32 m0, s28, 24576
    s_nop 0
    buffer_load_dwordx4 v30, s[48:51], s15 offen lds
    s_add_u32 m0, s28, 28672
    s_nop 0
    buffer_load_dwordx4 v31, s[48:51], s15 offen lds
    s_add_u32 m0, s28, 32768
    s_nop 0
    buffer_load_dwordx4 v32, s[48:51], s15 offen lds
    s_add_u32 m0, s16, 65536
    s_nop 0
    buffer_load_dwordx4 v20, s[40:43], s14 offen lds
    s_add_u32 m0, s16, 66560
    s_nop 0
    buffer_load_dwordx4 v21, s[40:43], s14 offen lds
    s_add_u32 m0, s16, 67584
    s_nop 0
    buffer_load_dwordx4 v22, s[40:43], s14 offen lds
    s_add_u32 m0, s16, 68608
    s_nop 0
    buffer_load_dwordx4 v23, s[40:43], s14 offen lds
    s_add_u32 m0, s16, 69632
    s_nop 0
    buffer_load_dwordx4 v24, s[40:43], s14 offen lds
    s_add_u32 m0, s16, 70656
    s_nop 0
    buffer_load_dwordx4 v25, s[40:43], s14 offen lds
    s_add_u32 m0, s16, 71680
    s_nop 0
    buffer_load_dwordx4 v26, s[40:43], s14 offen lds
    s_add_u32 m0, s16, 72704
    s_nop 0
    buffer_load_dwordx4 v27, s[40:43], s14 offen lds
    s_add_u32 m0, s17, 16384
    s_nop 0
    buffer_load_dwordx4 v28, s[44:47], s14 offen lds
    s_add_u32 m0, s17, 17408
    s_nop 0
    buffer_load_dwordx4 v29, s[44:47], s14 offen lds
    s_add_u32 s14, s14, 128
    s_and_b32 s14, s14, 2047
    s_mul_i32 s15, s14, 3072
    s_mov_b32 s52, s38
    s_mov_b32 s53, s39
    s_mov_b32 s54, 268435456
    s_mov_b32 s55, 0x20000
    s_branch L_loader
L_comp:
    s_waitcnt lgkmcnt(0)
    s_mov_b32 s52, s38
    s_mov_b32 s53, s39
    s_mov_b32 s54, 268435456
    s_mov_b32 s55, 0x20000
    s_getpc_b64 s[6:7]
L_pc:
    s_lshl_b32 s83, s3, 13
    v_lshl_add_u32 v2, v0, 7, s83
    v_add_u32 v4, 32768, v2
    v_min_u32 v2, L_codeend-L_pc-4, v2
    v_min_u32 v4, L_codeend-L_pc-4, v4
    v_mov_b32 v3, s7
    v_mov_b32 v5, s7
    v_add_co_u32 v2, vcc, s6, v2
    v_addc_co_u32 v3, vcc, 0, v3, vcc
    v_add_co_u32 v4, vcc, s6, v4
    v_addc_co_u32 v5, vcc, 0, v5, vcc
    global_load_dword v28, v[2:3], off
    global_load_dword v28, v[4:5], off
    s_mov_b32 s60, s36
    s_mov_b32 s61, s37
    s_mov_b32 s62, 256
    s_mov_b32 s63, 0x20000
    s_or_b32 s6, s2, s3
    s_cmp_lg_u32 s6, 0
    s_cbranch_scc1 L_nononce
    s_memrealtime s[6:7]
    s_waitcnt lgkmcnt(0)
    s_or_b32 s6, s6, 1
    v_mov_b32 v2, s6
    v_mov_b32 v3, s7
    v_mov_b32 v1, 0
    s_mov_b64 exec, 1
    buffer_store_dwordx2 v[2:3], v1, s[60:63], 0 offen sc0 sc1
    s_mov_b64 exec, -1
L_nononce:
    v_and_b32 v32, 15, v0
    v_lshrrev_b32 v33, 4, v0
    v_lshrrev_b32 v34, 1, v32
    v_xor_b32 v34, v34, v33
    v_lshlrev_b32 v35, 7, v32
    v_lshl_add_u32 v34, v34, 4, v35
    v_xor_b32 v35, 64, v34
    s_lshl_b32 s6, s3, 13
    v_add_u32 v16, s6, v34
    v_add_u32 v17, s6, v35
    v_add_u32 v18, 65536, v16
    v_add_u32 v19, 65536, v17
    v_add_u32 v30, 98304, v34
    v_add_u32 v31, 98304, v35
    v_bfe_u32 v34, v0, 2, 2
    v_lshl_add_u32 v34, v33, 3, v34
    v_lshlrev_b32 v34, 6, v34
    v_and_b32 v35, 1, v33
    v_lshl_add_u32 v34, v35, 5, v34
    v_and_b32 v36, 3, v0
    v_lshl_add_u32 v34, v36, 3, v34
    v_add_u32 v20, 122880, v34
    v_xor_b32 v25, 32, v20
    v_bfe_u32 v34, v0, 3, 1
    v_lshl_add_u32 v34, v34, 2, v36
    v_lshl_add_u32 v34, v35, 5, v34
    v_lshrrev_b32 v36, 5, v0
    v_lshl_add_u32 v34, v36, 6, v34
    v_lshlrev_b32 v34, 4, v34
    v_bfe_u32 v37, v0, 2, 1
    v_lshl_add_u32 v23, v37, 12, v34
    v_add_u32 v23, s6, v23
    v_lshl_add_u32 v24, v37, 11, v34
    v_lshl_add_u32 v34, v36, 5, v32
    v_lshlrev_b32 v34, 4, v34
    v_lshl_add_u32 v34, v35, 12, v34
    s_add_u32 s6, s6, 2048
    v_add_u32 v29, s6, v34
    s_lshl_b32 s6, s3, 12
    s_add_u32 s6, s6, 98304
    v_add_u32 v24, s6, v24
    s_lshr_b32 s64, s3, 2
    s_and_b32 s65, s3, 3
    s_lshr_b32 s66, s3, 1
    s_and_b32 s67, s3, 1
    v_lshlrev_b32 v4, 4, v0
    s_lshl_b32 s76, s3, 11
    s_lshl_b32 s75, s3, 10
    s_add_u32 s77, s4, 2
    s_and_b32 s77, s77, 7
    s_lshl_b32 s77, s77, 15
    s_add_u32 s77, s77, s76
    s_mov_b32 s78, s76
    s_lshr_b32 s6, s2, 3
    s_and_b32 s7, s6, 3
    s_lshr_b32 s6, s6, 2
    s_lshl_b32 s82, s7, 1
    s_add_u32 s82, s82, s6
    s_and_b32 s82, s82, 7
    s_lshl_b32 s79, s82, 14
    s_lshl_b32 s80, s82, 8
    s_mov_b32 s81, 0
    s_and_b32 s68, s2, 6
    s_lshl_b32 s68, s68, 1
    s_add_u32 s68, s68, s7
    s_and_b32 s69, s2, 1
    s_lshl_b32 s69, s69, 3
    s_add_u32 s69, s69, s6
    s_mov_b32 s79, 0
    s_mov_b32 s80, 0
    v_lshrrev_b32 v144, 3, v0
    s_lshl_b32 s6, s69, 6
    s_lshl_b32 s7, s3, 3
    s_add_u32 s6, s6, s7
    v_add_u32 v145, s6, v144
    v_lshlrev_b32 v145, 11, v145
    v_lshrrev_b32 v146, 4, v0
    s_lshl_b32 s7, s3, 2
    v_add_u32 v146, s7, v146
    v_xor_b32 v146, v146, v0
    v_and_b32 v146, 7, v146
    v_lshl_add_u32 v5, v146, 4, v145
    s_lshl_b32 s7, s3, 4
    v_add_u32 v145, s7, v144
    v_lshlrev_b32 v145, 11, v145
    v_bfe_u32 v146, v0, 4, 1
    v_lshlrev_b32 v146, 2, v146
    v_xor_b32 v146, v146, v0
    v_and_b32 v146, 7, v146
    v_lshl_add_u32 v145, v146, 4, v145
    s_lshl_b32 s7, s69, 7
    v_add_u32 v6, s7, v145
    v_add_u32 v7, 16384, v6
    s_lshl_b32 s6, s68, 2
    s_lshl_b32 s7, s67, 1
    s_add_u32 s6, s6, s7
    s_lshr_b32 s7, s66, 1
    s_add_u32 s70, s6, s7
    s_xor_b32 s7, s70, 1
    s_lshl_b32 s6, s66, 11
    s_lshl_b32 s71, s70, 17
    s_lshl_b32 s72, s7, 17
    s_lshl_b32 s73, s70, 16
    s_lshl_b32 s74, s7, 16
    s_add_u32 s7, s6, 12582912
    s_add_u32 s71, s71, s7
    s_add_u32 s72, s72, s7
    s_add_u32 s7, s6, 20971520
    s_add_u32 s73, s73, s7
    s_add_u32 s74, s74, s7
    v_and_b32 v144, 31, v0
    v_lshrrev_b32 v145, 5, v0
    s_lshr_b32 s6, s66, 1
    s_lshl_b32 s6, s6, 2
    v_add_u32 v146, s6, v145
    v_bfe_u32 v147, v0, 1, 3
    v_xor_b32 v146, v146, v147
    v_lshlrev_b32 v147, 7, v144
    s_and_b32 s6, s66, 1
    s_mul_i32 s6, s6, 12288
    s_add_u32 s6, s6, 65536
    v_add_u32 v147, s6, v147
    v_lshl_add_u32 v8, v146, 4, v147
    v_xor_b32 v9, 32, v8
    v_xor_b32 v10, 4096, v8
    v_xor_b32 v11, 4096, v9
    v_bfe_u32 v146, v0, 2, 2
    v_lshl_add_u32 v146, v145, 2, v146
    s_lshl_b32 s6, s66, 5
    v_add_u32 v146, s6, v146
    v_lshlrev_b32 v146, 7, v146
    v_bfe_u32 v147, v0, 4, 1
    v_lshl_add_u32 v146, v147, 5, v146
    v_and_b32 v147, 3, v0
    v_lshl_add_u32 v146, v147, 3, v146
    v_bfe_u32 v147, v0, 3, 1
    s_and_b32 s6, s66, 1
    v_xor_b32 v147, s6, v147
    v_lshl_add_u32 v12, v147, 6, v146
    v_xor_b32 v13, 64, v12
    s_and_b32 s6, s66, 1
    s_lshl_b32 s6, s6, 5
    s_lshl_b32 s7, s69, 6
    s_add_u32 s6, s6, s7
    v_add_u32 v146, s6, v144
    s_lshl_b32 s6, s70, 5
    v_lshl_add_u32 v148, v145, 2, s6
    v_lshl_add_u32 v14, v148, 10, v146
    v_lshlrev_b32 v14, 2, v14
    s_lshl_b32 s6, s64, 13
    v_add_u32 v2, s6, v4
    v_add_u32 v3, 32768, v2
    s_lshl_b32 s6, s5, 18
    s_add_u32 s6, s6, 4194304
    s_add_u32 s40, s38, s6
    s_addc_u32 s41, s39, 0
    s_mov_b32 s42, 262144
    s_mov_b32 s43, 0x20000
    s_mov_b32 s44, s18
    s_mov_b32 s45, s19
    s_mov_b32 s46, 2097152
    s_mov_b32 s47, 0x20000
    s_mov_b32 s48, s20
    s_mov_b32 s49, s21
    s_mov_b32 s50, 2097152
    s_mov_b32 s51, 0x20000
    s_mov_b32 s56, s30
    s_mov_b32 s57, s31
    s_mov_b32 s58, 2097152
    s_mov_b32 s59, 0x20000
    v_and_b32 v21, 31, v0
    v_lshlrev_b32 v21, 4, v21
    v_add_u32 v21, 161792, v21
    s_lshl_b32 s6, s3, 9
    s_add_u32 s6, s6, 159744
    v_lshl_add_u32 v22, v0, 3, s6
    s_lshl_b32 s12, s4, 15
    s_lshl_b32 s13, s3, 12
    s_add_u32 s13, s13, 98304
    v_mov_b32 v1, 0
    v_mov_b32 v96, 0
    v_mov_b32 v97, 0
    v_mov_b32 v98, 0
    v_mov_b32 v99, 0
    v_mov_b32 v100, 0
    v_mov_b32 v101, 0
    v_mov_b32 v102, 0
    v_mov_b32 v103, 0
    v_mov_b32 v104, 0
    v_mov_b32 v105, 0
    v_mov_b32 v106, 0
    v_mov_b32 v107, 0
    v_mov_b32 v108, 0
    v_mov_b32 v109, 0
    v_mov_b32 v110, 0
    v_mov_b32 v111, 0
    v_mov_b32 v112, 0
    v_mov_b32 v113, 0
    v_mov_b32 v114, 0
    v_mov_b32 v115, 0
    v_mov_b32 v116, 0
    v_mov_b32 v117, 0
    v_mov_b32 v118, 0
    v_mov_b32 v119, 0
    v_mov_b32 v120, 0
    v_mov_b32 v121, 0
    v_mov_b32 v122, 0
    v_mov_b32 v123, 0
    v_mov_b32 v124, 0
    v_mov_b32 v125, 0
    v_mov_b32 v126, 0
    v_mov_b32 v127, 0
    v_mov_b32 v128, 0
    v_mov_b32 v129, 0
    v_mov_b32 v130, 0
    v_mov_b32 v131, 0
    v_mov_b32 v132, 0
    v_mov_b32 v133, 0
    v_mov_b32 v134, 0
    v_mov_b32 v135, 0
    v_mov_b32 v136, 0
    v_mov_b32 v137, 0
    v_mov_b32 v138, 0
    v_mov_b32 v139, 0
    v_mov_b32 v140, 0
    v_mov_b32 v141, 0
    v_mov_b32 v142, 0
    v_mov_b32 v143, 0
    v_mov_b32 v144, 0
    v_mov_b32 v145, 0
    v_mov_b32 v146, 0
    v_mov_b32 v147, 0
    v_mov_b32 v148, 0
    v_mov_b32 v149, 0
    v_mov_b32 v150, 0
    v_mov_b32 v151, 0
    v_mov_b32 v152, 0
    v_mov_b32 v153, 0
    v_mov_b32 v154, 0
    v_mov_b32 v155, 0
    v_mov_b32 v156, 0
    v_mov_b32 v157, 0
    v_mov_b32 v158, 0
    v_mov_b32 v159, 0
    v_mov_b32 v160, 0
    v_mov_b32 v161, 0
    v_mov_b32 v162, 0
    v_mov_b32 v163, 0
    v_mov_b32 v164, 0
    v_mov_b32 v165, 0
    v_mov_b32 v166, 0
    v_mov_b32 v167, 0
    v_mov_b32 v168, 0
    v_mov_b32 v169, 0
    v_mov_b32 v170, 0
    v_mov_b32 v171, 0
    v_mov_b32 v172, 0
    v_mov_b32 v173, 0
    v_mov_b32 v174, 0
    v_mov_b32 v175, 0
    v_mov_b32 v176, 0
    v_mov_b32 v177, 0
    v_mov_b32 v178, 0
    v_mov_b32 v179, 0
    v_mov_b32 v180, 0
    v_mov_b32 v181, 0
    v_mov_b32 v182, 0
    v_mov_b32 v183, 0
    v_mov_b32 v184, 0
    v_mov_b32 v185, 0
    v_mov_b32 v186, 0
    v_mov_b32 v187, 0
    v_mov_b32 v188, 0
    v_mov_b32 v189, 0
    v_mov_b32 v190, 0
    v_mov_b32 v191, 0
    v_mov_b32 v192, 0
    v_mov_b32 v193, 0
    v_mov_b32 v194, 0
    v_mov_b32 v195, 0
    v_mov_b32 v196, 0
    v_mov_b32 v197, 0
    v_mov_b32 v198, 0
    v_mov_b32 v199, 0
    v_mov_b32 v200, 0
    v_mov_b32 v201, 0
    v_mov_b32 v202, 0
    v_mov_b32 v203, 0
    v_mov_b32 v204, 0
    v_mov_b32 v205, 0
    v_mov_b32 v206, 0
    v_mov_b32 v207, 0
    v_mov_b32 v208, 0
    v_mov_b32 v209, 0
    v_mov_b32 v210, 0
    v_mov_b32 v211, 0
    v_mov_b32 v212, 0
    v_mov_b32 v213, 0
    v_mov_b32 v214, 0
    v_mov_b32 v215, 0
    v_mov_b32 v216, 0
    v_mov_b32 v217, 0
    v_mov_b32 v218, 0
    v_mov_b32 v219, 0
    v_mov_b32 v220, 0
    v_mov_b32 v221, 0
    v_mov_b32 v222, 0
    v_mov_b32 v223, 0
    v_mov_b32 v224, 0
    v_mov_b32 v225, 0
    v_mov_b32 v226, 0
    v_mov_b32 v227, 0
    v_mov_b32 v228, 0
    v_mov_b32 v229, 0
    v_mov_b32 v230, 0
    v_mov_b32 v231, 0
    v_mov_b32 v232, 0
    v_mov_b32 v233, 0
    v_mov_b32 v234, 0
    v_mov_b32 v235, 0
    v_mov_b32 v236, 0
    v_mov_b32 v237, 0
    v_mov_b32 v238, 0
    v_mov_b32 v239, 0
    v_mov_b32 v240, 0
    v_mov_b32 v241, 0
    v_mov_b32 v242, 0
    v_mov_b32 v243, 0
    v_mov_b32 v244, 0
    v_mov_b32 v245, 0
    v_mov_b32 v246, 0
    v_mov_b32 v247, 0
    v_mov_b32 v248, 0
    v_mov_b32 v249, 0
    v_mov_b32 v250, 0
    v_mov_b32 v251, 0
    v_mov_b32 v252, 0
    v_mov_b32 v253, 0
    v_mov_b32 v254, 0
    v_mov_b32 v255, 0
    s_barrier
    ds_read_b64_tr_b16 v[64:65], v20 offset:28672
    ds_read_b64_tr_b16 v[66:67], v20 offset:28928
    ds_read_b64_tr_b16 v[68:69], v20 offset:30720
    ds_read_b64_tr_b16 v[70:71], v20 offset:30976
    ds_read_b128 v[32:35], v18 offset:0
    ds_read_b128 v[36:39], v19 offset:0
    ds_read_b64_tr_b16 v[72:73], v25 offset:28672
    ds_read_b64_tr_b16 v[74:75], v25 offset:28928
    ds_read_b64_tr_b16 v[76:77], v25 offset:30720
    ds_read_b64_tr_b16 v[78:79], v25 offset:30976
    ds_read_b128 v[40:43], v18 offset:2048
    ds_read_b128 v[44:47], v19 offset:2048
    ds_read_b128 v[48:51], v18 offset:4096
    ds_read_b128 v[52:55], v19 offset:4096
    ds_read_b128 v[56:59], v18 offset:6144
    ds_read_b128 v[60:63], v19 offset:6144
    s_mov_b32 s83, 5
    .p2align 6
L_p1_loop:
    s_waitcnt lgkmcnt(11)
    v_mfma_f32_16x16x32_bf16 v[128:131], v[64:67], v[32:35], v[128:131]
    s_waitcnt lgkmcnt(10)
    v_mfma_f32_16x16x32_bf16 v[128:131], v[68:71], v[36:39], v[128:131]
    ds_read_b64_tr_b16 v[80:81], v20 offset:32768
    s_waitcnt lgkmcnt(9)
    v_mfma_f32_16x16x32_bf16 v[132:135], v[72:75], v[32:35], v[132:135]
    ds_read_b64_tr_b16 v[82:83], v20 offset:33024
    s_waitcnt lgkmcnt(8)
    v_mfma_f32_16x16x32_bf16 v[132:135], v[76:79], v[36:39], v[132:135]
    ds_read_b64_tr_b16 v[84:85], v20 offset:34816
    s_waitcnt lgkmcnt(8)
    v_mfma_f32_16x16x32_bf16 v[136:139], v[64:67], v[40:43], v[136:139]
    ds_read_b64_tr_b16 v[86:87], v20 offset:35072
    s_waitcnt lgkmcnt(8)
    v_mfma_f32_16x16x32_bf16 v[136:139], v[68:71], v[44:47], v[136:139]
    v_mfma_f32_16x16x32_bf16 v[140:143], v[72:75], v[40:43], v[140:143]
    v_mfma_f32_16x16x32_bf16 v[140:143], v[76:79], v[44:47], v[140:143]
    s_waitcnt lgkmcnt(7)
    v_mfma_f32_16x16x32_bf16 v[144:147], v[64:67], v[48:51], v[144:147]
    ds_read_b64_tr_b16 v[88:89], v25 offset:32768
    s_waitcnt lgkmcnt(7)
    v_mfma_f32_16x16x32_bf16 v[144:147], v[68:71], v[52:55], v[144:147]
    ds_read_b64_tr_b16 v[90:91], v25 offset:33024
    v_mfma_f32_16x16x32_bf16 v[148:151], v[72:75], v[48:51], v[148:151]
    ds_read_b64_tr_b16 v[92:93], v25 offset:34816
    v_mfma_f32_16x16x32_bf16 v[148:151], v[76:79], v[52:55], v[148:151]
    ds_read_b64_tr_b16 v[94:95], v25 offset:35072
    s_waitcnt lgkmcnt(9)
    v_mfma_f32_16x16x32_bf16 v[152:155], v[64:67], v[56:59], v[152:155]
    s_waitcnt lgkmcnt(8)
    v_mfma_f32_16x16x32_bf16 v[152:155], v[68:71], v[60:63], v[152:155]
    v_mfma_f32_16x16x32_bf16 v[156:159], v[72:75], v[56:59], v[156:159]
    v_mfma_f32_16x16x32_bf16 v[156:159], v[76:79], v[60:63], v[156:159]
    s_waitcnt lgkmcnt(6)
    v_mfma_f32_16x16x32_bf16 v[160:163], v[32:35], v[80:83], v[160:163]
    ds_read_b128 v[64:67], v30 offset:16384
    s_waitcnt lgkmcnt(5)
    v_mfma_f32_16x16x32_bf16 v[160:163], v[36:39], v[84:87], v[160:163]
    ds_read_b128 v[68:71], v31 offset:16384
    v_mfma_f32_16x16x32_bf16 v[164:167], v[40:43], v[80:83], v[164:167]
    v_mfma_f32_16x16x32_bf16 v[164:167], v[44:47], v[84:87], v[164:167]
    ds_read_b128 v[72:75], v30 offset:20480
    v_mfma_f32_16x16x32_bf16 v[168:171], v[48:51], v[80:83], v[168:171]
    ds_read_b128 v[76:79], v31 offset:20480
    v_mfma_f32_16x16x32_bf16 v[168:171], v[52:55], v[84:87], v[168:171]
    v_mfma_f32_16x16x32_bf16 v[172:175], v[56:59], v[80:83], v[172:175]
    v_mfma_f32_16x16x32_bf16 v[172:175], v[60:63], v[84:87], v[172:175]
    s_waitcnt lgkmcnt(6)
    v_mfma_f32_16x16x32_bf16 v[176:179], v[32:35], v[88:91], v[176:179]
    ds_read_b128 v[80:83], v30 offset:18432
    s_waitcnt lgkmcnt(5)
    v_mfma_f32_16x16x32_bf16 v[176:179], v[36:39], v[92:95], v[176:179]
    ds_read_b128 v[84:87], v31 offset:18432
    v_mfma_f32_16x16x32_bf16 v[180:183], v[40:43], v[88:91], v[180:183]
    v_mfma_f32_16x16x32_bf16 v[180:183], v[44:47], v[92:95], v[180:183]
    v_mfma_f32_16x16x32_bf16 v[184:187], v[48:51], v[88:91], v[184:187]
    v_mfma_f32_16x16x32_bf16 v[184:187], v[52:55], v[92:95], v[184:187]
    v_mfma_f32_16x16x32_bf16 v[188:191], v[56:59], v[88:91], v[188:191]
    v_mfma_f32_16x16x32_bf16 v[188:191], v[60:63], v[92:95], v[188:191]
    s_waitcnt lgkmcnt(5)
    v_mfma_f32_16x16x32_bf16 v[192:195], v[32:35], v[64:67], v[192:195]
    ds_read_b64_tr_b16 v[88:89], v20 offset:24576
    s_waitcnt lgkmcnt(5)
    v_mfma_f32_16x16x32_bf16 v[192:195], v[36:39], v[68:71], v[192:195]
    ds_read_b64_tr_b16 v[90:91], v20 offset:24832
    v_mfma_f32_16x16x32_bf16 v[196:199], v[40:43], v[64:67], v[196:199]
    ds_read_b64_tr_b16 v[92:93], v20 offset:26624
    v_mfma_f32_16x16x32_bf16 v[196:199], v[44:47], v[68:71], v[196:199]
    ds_read_b64_tr_b16 v[94:95], v20 offset:26880
    v_mfma_f32_16x16x32_bf16 v[200:203], v[48:51], v[64:67], v[200:203]
    v_mfma_f32_16x16x32_bf16 v[200:203], v[52:55], v[68:71], v[200:203]
    v_mfma_f32_16x16x32_bf16 v[204:207], v[56:59], v[64:67], v[204:207]
    v_mfma_f32_16x16x32_bf16 v[204:207], v[60:63], v[68:71], v[204:207]
    s_waitcnt lgkmcnt(5)
    v_mfma_f32_16x16x32_bf16 v[208:211], v[32:35], v[80:83], v[208:211]
    ds_read_b128 v[64:67], v30 offset:22528
    s_waitcnt lgkmcnt(5)
    v_mfma_f32_16x16x32_bf16 v[208:211], v[36:39], v[84:87], v[208:211]
    ds_read_b128 v[68:71], v31 offset:22528
    v_mfma_f32_16x16x32_bf16 v[212:215], v[40:43], v[80:83], v[212:215]
    v_mfma_f32_16x16x32_bf16 v[212:215], v[44:47], v[84:87], v[212:215]
    v_mfma_f32_16x16x32_bf16 v[216:219], v[48:51], v[80:83], v[216:219]
    v_mfma_f32_16x16x32_bf16 v[216:219], v[52:55], v[84:87], v[216:219]
    v_mfma_f32_16x16x32_bf16 v[220:223], v[56:59], v[80:83], v[220:223]
    v_mfma_f32_16x16x32_bf16 v[220:223], v[60:63], v[84:87], v[220:223]
    v_mfma_f32_16x16x32_bf16 v[224:227], v[32:35], v[72:75], v[224:227]
    ds_read_b64_tr_b16 v[80:81], v25 offset:24576
    v_mfma_f32_16x16x32_bf16 v[224:227], v[36:39], v[76:79], v[224:227]
    ds_read_b64_tr_b16 v[82:83], v25 offset:24832
    v_mfma_f32_16x16x32_bf16 v[228:231], v[40:43], v[72:75], v[228:231]
    ds_read_b64_tr_b16 v[84:85], v25 offset:26624
    v_mfma_f32_16x16x32_bf16 v[228:231], v[44:47], v[76:79], v[228:231]
    ds_read_b64_tr_b16 v[86:87], v25 offset:26880
    v_mfma_f32_16x16x32_bf16 v[232:235], v[48:51], v[72:75], v[232:235]
    v_mfma_f32_16x16x32_bf16 v[232:235], v[52:55], v[76:79], v[232:235]
    v_mfma_f32_16x16x32_bf16 v[236:239], v[56:59], v[72:75], v[236:239]
    v_mfma_f32_16x16x32_bf16 v[236:239], v[60:63], v[76:79], v[236:239]
    s_waitcnt lgkmcnt(5)
    v_mfma_f32_16x16x32_bf16 v[240:243], v[32:35], v[64:67], v[240:243]
    s_waitcnt lgkmcnt(4)
    v_mfma_f32_16x16x32_bf16 v[240:243], v[36:39], v[68:71], v[240:243]
    v_mfma_f32_16x16x32_bf16 v[244:247], v[40:43], v[64:67], v[244:247]
    v_mfma_f32_16x16x32_bf16 v[244:247], v[44:47], v[68:71], v[244:247]
    v_mfma_f32_16x16x32_bf16 v[248:251], v[48:51], v[64:67], v[248:251]
    v_mfma_f32_16x16x32_bf16 v[248:251], v[52:55], v[68:71], v[248:251]
    v_mfma_f32_16x16x32_bf16 v[252:255], v[56:59], v[64:67], v[252:255]
    v_mfma_f32_16x16x32_bf16 v[252:255], v[60:63], v[68:71], v[252:255]
    v_mfma_f32_16x16x32_bf16 v[96:99], v[88:91], v[32:35], v[96:99]
    s_waitcnt lgkmcnt(0)
    s_barrier
    v_mfma_f32_16x16x32_bf16 v[96:99], v[92:95], v[36:39], v[96:99]
    ds_read_b64_tr_b16 v[64:65], v20 offset:4096
    ds_read_b64_tr_b16 v[66:67], v20 offset:4352
    v_mfma_f32_16x16x32_bf16 v[100:103], v[80:83], v[32:35], v[100:103]
    ds_read_b64_tr_b16 v[68:69], v20 offset:6144
    ds_read_b64_tr_b16 v[70:71], v20 offset:6400
    v_mfma_f32_16x16x32_bf16 v[100:103], v[84:87], v[36:39], v[100:103]
    ds_read_b128 v[32:35], v16 offset:0
    ds_read_b128 v[36:39], v17 offset:0
    v_mfma_f32_16x16x32_bf16 v[104:107], v[88:91], v[40:43], v[104:107]
    ds_read_b64_tr_b16 v[72:73], v25 offset:4096
    ds_read_b64_tr_b16 v[74:75], v25 offset:4352
    v_mfma_f32_16x16x32_bf16 v[104:107], v[92:95], v[44:47], v[104:107]
    ds_read_b64_tr_b16 v[76:77], v25 offset:6144
    ds_read_b64_tr_b16 v[78:79], v25 offset:6400
    v_mfma_f32_16x16x32_bf16 v[108:111], v[80:83], v[40:43], v[108:111]
    v_mfma_f32_16x16x32_bf16 v[108:111], v[84:87], v[44:47], v[108:111]
    ds_read_b128 v[40:43], v16 offset:2048
    ds_read_b128 v[44:47], v17 offset:2048
    v_mfma_f32_16x16x32_bf16 v[112:115], v[88:91], v[48:51], v[112:115]
    v_mfma_f32_16x16x32_bf16 v[112:115], v[92:95], v[52:55], v[112:115]
    v_mfma_f32_16x16x32_bf16 v[116:119], v[80:83], v[48:51], v[116:119]
    v_mfma_f32_16x16x32_bf16 v[116:119], v[84:87], v[52:55], v[116:119]
    ds_read_b128 v[48:51], v16 offset:4096
    ds_read_b128 v[52:55], v17 offset:4096
    v_mfma_f32_16x16x32_bf16 v[120:123], v[88:91], v[56:59], v[120:123]
    v_mfma_f32_16x16x32_bf16 v[120:123], v[92:95], v[60:63], v[120:123]
    v_mfma_f32_16x16x32_bf16 v[124:127], v[80:83], v[56:59], v[124:127]
    v_mfma_f32_16x16x32_bf16 v[124:127], v[84:87], v[60:63], v[124:127]
    ds_read_b128 v[56:59], v16 offset:6144
    ds_read_b128 v[60:63], v17 offset:6144
    s_waitcnt lgkmcnt(11)
    v_mfma_f32_16x16x32_bf16 v[128:131], v[64:67], v[32:35], v[128:131]
    s_waitcnt lgkmcnt(10)
    v_mfma_f32_16x16x32_bf16 v[128:131], v[68:71], v[36:39], v[128:131]
    ds_read_b64_tr_b16 v[80:81], v20 offset:8192
    s_waitcnt lgkmcnt(9)
    v_mfma_f32_16x16x32_bf16 v[132:135], v[72:75], v[32:35], v[132:135]
    ds_read_b64_tr_b16 v[82:83], v20 offset:8448
    s_waitcnt lgkmcnt(8)
    v_mfma_f32_16x16x32_bf16 v[132:135], v[76:79], v[36:39], v[132:135]
    ds_read_b64_tr_b16 v[84:85], v20 offset:10240
    s_waitcnt lgkmcnt(8)
    v_mfma_f32_16x16x32_bf16 v[136:139], v[64:67], v[40:43], v[136:139]
    ds_read_b64_tr_b16 v[86:87], v20 offset:10496
    s_waitcnt lgkmcnt(8)
    v_mfma_f32_16x16x32_bf16 v[136:139], v[68:71], v[44:47], v[136:139]
    v_mfma_f32_16x16x32_bf16 v[140:143], v[72:75], v[40:43], v[140:143]
    v_mfma_f32_16x16x32_bf16 v[140:143], v[76:79], v[44:47], v[140:143]
    s_waitcnt lgkmcnt(7)
    v_mfma_f32_16x16x32_bf16 v[144:147], v[64:67], v[48:51], v[144:147]
    ds_read_b64_tr_b16 v[88:89], v25 offset:8192
    s_waitcnt lgkmcnt(7)
    v_mfma_f32_16x16x32_bf16 v[144:147], v[68:71], v[52:55], v[144:147]
    ds_read_b64_tr_b16 v[90:91], v25 offset:8448
    v_mfma_f32_16x16x32_bf16 v[148:151], v[72:75], v[48:51], v[148:151]
    ds_read_b64_tr_b16 v[92:93], v25 offset:10240
    v_mfma_f32_16x16x32_bf16 v[148:151], v[76:79], v[52:55], v[148:151]
    ds_read_b64_tr_b16 v[94:95], v25 offset:10496
    s_waitcnt lgkmcnt(9)
    v_mfma_f32_16x16x32_bf16 v[152:155], v[64:67], v[56:59], v[152:155]
    s_waitcnt lgkmcnt(8)
    v_mfma_f32_16x16x32_bf16 v[152:155], v[68:71], v[60:63], v[152:155]
    v_mfma_f32_16x16x32_bf16 v[156:159], v[72:75], v[56:59], v[156:159]
    v_mfma_f32_16x16x32_bf16 v[156:159], v[76:79], v[60:63], v[156:159]
    s_waitcnt lgkmcnt(6)
    v_mfma_f32_16x16x32_bf16 v[160:163], v[32:35], v[80:83], v[160:163]
    ds_read_b128 v[64:67], v30 offset:0
    s_waitcnt lgkmcnt(5)
    v_mfma_f32_16x16x32_bf16 v[160:163], v[36:39], v[84:87], v[160:163]
    ds_read_b128 v[68:71], v31 offset:0
    v_mfma_f32_16x16x32_bf16 v[164:167], v[40:43], v[80:83], v[164:167]
    v_mfma_f32_16x16x32_bf16 v[164:167], v[44:47], v[84:87], v[164:167]
    ds_read_b128 v[72:75], v30 offset:4096
    v_mfma_f32_16x16x32_bf16 v[168:171], v[48:51], v[80:83], v[168:171]
    ds_read_b128 v[76:79], v31 offset:4096
    v_mfma_f32_16x16x32_bf16 v[168:171], v[52:55], v[84:87], v[168:171]
    v_mfma_f32_16x16x32_bf16 v[172:175], v[56:59], v[80:83], v[172:175]
    v_mfma_f32_16x16x32_bf16 v[172:175], v[60:63], v[84:87], v[172:175]
    s_waitcnt lgkmcnt(6)
    v_mfma_f32_16x16x32_bf16 v[176:179], v[32:35], v[88:91], v[176:179]
    ds_read_b128 v[80:83], v30 offset:2048
    s_waitcnt lgkmcnt(5)
    v_mfma_f32_16x16x32_bf16 v[176:179], v[36:39], v[92:95], v[176:179]
    ds_read_b128 v[84:87], v31 offset:2048
    v_mfma_f32_16x16x32_bf16 v[180:183], v[40:43], v[88:91], v[180:183]
    v_mfma_f32_16x16x32_bf16 v[180:183], v[44:47], v[92:95], v[180:183]
    v_mfma_f32_16x16x32_bf16 v[184:187], v[48:51], v[88:91], v[184:187]
    v_mfma_f32_16x16x32_bf16 v[184:187], v[52:55], v[92:95], v[184:187]
    v_mfma_f32_16x16x32_bf16 v[188:191], v[56:59], v[88:91], v[188:191]
    v_mfma_f32_16x16x32_bf16 v[188:191], v[60:63], v[92:95], v[188:191]
    s_waitcnt lgkmcnt(5)
    v_mfma_f32_16x16x32_bf16 v[192:195], v[32:35], v[64:67], v[192:195]
    ds_read_b64_tr_b16 v[88:89], v20 offset:0
    s_waitcnt lgkmcnt(5)
    v_mfma_f32_16x16x32_bf16 v[192:195], v[36:39], v[68:71], v[192:195]
    ds_read_b64_tr_b16 v[90:91], v20 offset:256
    v_mfma_f32_16x16x32_bf16 v[196:199], v[40:43], v[64:67], v[196:199]
    ds_read_b64_tr_b16 v[92:93], v20 offset:2048
    v_mfma_f32_16x16x32_bf16 v[196:199], v[44:47], v[68:71], v[196:199]
    ds_read_b64_tr_b16 v[94:95], v20 offset:2304
    v_mfma_f32_16x16x32_bf16 v[200:203], v[48:51], v[64:67], v[200:203]
    v_mfma_f32_16x16x32_bf16 v[200:203], v[52:55], v[68:71], v[200:203]
    v_mfma_f32_16x16x32_bf16 v[204:207], v[56:59], v[64:67], v[204:207]
    v_mfma_f32_16x16x32_bf16 v[204:207], v[60:63], v[68:71], v[204:207]
    s_waitcnt lgkmcnt(5)
    v_mfma_f32_16x16x32_bf16 v[208:211], v[32:35], v[80:83], v[208:211]
    ds_read_b128 v[64:67], v30 offset:6144
    s_waitcnt lgkmcnt(5)
    v_mfma_f32_16x16x32_bf16 v[208:211], v[36:39], v[84:87], v[208:211]
    ds_read_b128 v[68:71], v31 offset:6144
    v_mfma_f32_16x16x32_bf16 v[212:215], v[40:43], v[80:83], v[212:215]
    v_mfma_f32_16x16x32_bf16 v[212:215], v[44:47], v[84:87], v[212:215]
    v_mfma_f32_16x16x32_bf16 v[216:219], v[48:51], v[80:83], v[216:219]
    v_mfma_f32_16x16x32_bf16 v[216:219], v[52:55], v[84:87], v[216:219]
    v_mfma_f32_16x16x32_bf16 v[220:223], v[56:59], v[80:83], v[220:223]
    v_mfma_f32_16x16x32_bf16 v[220:223], v[60:63], v[84:87], v[220:223]
    v_mfma_f32_16x16x32_bf16 v[224:227], v[32:35], v[72:75], v[224:227]
    ds_read_b64_tr_b16 v[80:81], v25 offset:0
    v_mfma_f32_16x16x32_bf16 v[224:227], v[36:39], v[76:79], v[224:227]
    ds_read_b64_tr_b16 v[82:83], v25 offset:256
    v_mfma_f32_16x16x32_bf16 v[228:231], v[40:43], v[72:75], v[228:231]
    ds_read_b64_tr_b16 v[84:85], v25 offset:2048
    v_mfma_f32_16x16x32_bf16 v[228:231], v[44:47], v[76:79], v[228:231]
    ds_read_b64_tr_b16 v[86:87], v25 offset:2304
    v_mfma_f32_16x16x32_bf16 v[232:235], v[48:51], v[72:75], v[232:235]
    v_mfma_f32_16x16x32_bf16 v[232:235], v[52:55], v[76:79], v[232:235]
    v_mfma_f32_16x16x32_bf16 v[236:239], v[56:59], v[72:75], v[236:239]
    v_mfma_f32_16x16x32_bf16 v[236:239], v[60:63], v[76:79], v[236:239]
    s_waitcnt lgkmcnt(5)
    v_mfma_f32_16x16x32_bf16 v[240:243], v[32:35], v[64:67], v[240:243]
    s_waitcnt lgkmcnt(4)
    v_mfma_f32_16x16x32_bf16 v[240:243], v[36:39], v[68:71], v[240:243]
    v_mfma_f32_16x16x32_bf16 v[244:247], v[40:43], v[64:67], v[244:247]
    v_mfma_f32_16x16x32_bf16 v[244:247], v[44:47], v[68:71], v[244:247]
    v_mfma_f32_16x16x32_bf16 v[248:251], v[48:51], v[64:67], v[248:251]
    v_mfma_f32_16x16x32_bf16 v[248:251], v[52:55], v[68:71], v[248:251]
    v_mfma_f32_16x16x32_bf16 v[252:255], v[56:59], v[64:67], v[252:255]
    v_mfma_f32_16x16x32_bf16 v[252:255], v[60:63], v[68:71], v[252:255]
    v_mfma_f32_16x16x32_bf16 v[96:99], v[88:91], v[32:35], v[96:99]
    s_waitcnt lgkmcnt(0)
    s_barrier
    v_mfma_f32_16x16x32_bf16 v[96:99], v[92:95], v[36:39], v[96:99]
    ds_read_b64_tr_b16 v[64:65], v20 offset:16384
    ds_read_b64_tr_b16 v[66:67], v20 offset:16640
    v_mfma_f32_16x16x32_bf16 v[100:103], v[80:83], v[32:35], v[100:103]
    ds_read_b64_tr_b16 v[68:69], v20 offset:18432
    ds_read_b64_tr_b16 v[70:71], v20 offset:18688
    v_mfma_f32_16x16x32_bf16 v[100:103], v[84:87], v[36:39], v[100:103]
    ds_read_b128 v[32:35], v16 offset:32768
    ds_read_b128 v[36:39], v17 offset:32768
    v_mfma_f32_16x16x32_bf16 v[104:107], v[88:91], v[40:43], v[104:107]
    ds_read_b64_tr_b16 v[72:73], v25 offset:16384
    ds_read_b64_tr_b16 v[74:75], v25 offset:16640
    v_mfma_f32_16x16x32_bf16 v[104:107], v[92:95], v[44:47], v[104:107]
    ds_read_b64_tr_b16 v[76:77], v25 offset:18432
    ds_read_b64_tr_b16 v[78:79], v25 offset:18688
    v_mfma_f32_16x16x32_bf16 v[108:111], v[80:83], v[40:43], v[108:111]
    v_mfma_f32_16x16x32_bf16 v[108:111], v[84:87], v[44:47], v[108:111]
    ds_read_b128 v[40:43], v16 offset:34816
    ds_read_b128 v[44:47], v17 offset:34816
    v_mfma_f32_16x16x32_bf16 v[112:115], v[88:91], v[48:51], v[112:115]
    v_mfma_f32_16x16x32_bf16 v[112:115], v[92:95], v[52:55], v[112:115]
    v_mfma_f32_16x16x32_bf16 v[116:119], v[80:83], v[48:51], v[116:119]
    v_mfma_f32_16x16x32_bf16 v[116:119], v[84:87], v[52:55], v[116:119]
    ds_read_b128 v[48:51], v16 offset:36864
    ds_read_b128 v[52:55], v17 offset:36864
    v_mfma_f32_16x16x32_bf16 v[120:123], v[88:91], v[56:59], v[120:123]
    v_mfma_f32_16x16x32_bf16 v[120:123], v[92:95], v[60:63], v[120:123]
    v_mfma_f32_16x16x32_bf16 v[124:127], v[80:83], v[56:59], v[124:127]
    v_mfma_f32_16x16x32_bf16 v[124:127], v[84:87], v[60:63], v[124:127]
    ds_read_b128 v[56:59], v16 offset:38912
    ds_read_b128 v[60:63], v17 offset:38912
    s_waitcnt lgkmcnt(11)
    v_mfma_f32_16x16x32_bf16 v[128:131], v[64:67], v[32:35], v[128:131]
    s_waitcnt lgkmcnt(10)
    v_mfma_f32_16x16x32_bf16 v[128:131], v[68:71], v[36:39], v[128:131]
    ds_read_b64_tr_b16 v[80:81], v20 offset:20480
    s_waitcnt lgkmcnt(9)
    v_mfma_f32_16x16x32_bf16 v[132:135], v[72:75], v[32:35], v[132:135]
    ds_read_b64_tr_b16 v[82:83], v20 offset:20736
    s_waitcnt lgkmcnt(8)
    v_mfma_f32_16x16x32_bf16 v[132:135], v[76:79], v[36:39], v[132:135]
    ds_read_b64_tr_b16 v[84:85], v20 offset:22528
    s_waitcnt lgkmcnt(8)
    v_mfma_f32_16x16x32_bf16 v[136:139], v[64:67], v[40:43], v[136:139]
    ds_read_b64_tr_b16 v[86:87], v20 offset:22784
    s_waitcnt lgkmcnt(8)
    v_mfma_f32_16x16x32_bf16 v[136:139], v[68:71], v[44:47], v[136:139]
    v_mfma_f32_16x16x32_bf16 v[140:143], v[72:75], v[40:43], v[140:143]
    v_mfma_f32_16x16x32_bf16 v[140:143], v[76:79], v[44:47], v[140:143]
    s_waitcnt lgkmcnt(7)
    v_mfma_f32_16x16x32_bf16 v[144:147], v[64:67], v[48:51], v[144:147]
    ds_read_b64_tr_b16 v[88:89], v25 offset:20480
    s_waitcnt lgkmcnt(7)
    v_mfma_f32_16x16x32_bf16 v[144:147], v[68:71], v[52:55], v[144:147]
    ds_read_b64_tr_b16 v[90:91], v25 offset:20736
    v_mfma_f32_16x16x32_bf16 v[148:151], v[72:75], v[48:51], v[148:151]
    ds_read_b64_tr_b16 v[92:93], v25 offset:22528
    v_mfma_f32_16x16x32_bf16 v[148:151], v[76:79], v[52:55], v[148:151]
    ds_read_b64_tr_b16 v[94:95], v25 offset:22784
    s_waitcnt lgkmcnt(9)
    v_mfma_f32_16x16x32_bf16 v[152:155], v[64:67], v[56:59], v[152:155]
    s_waitcnt lgkmcnt(8)
    v_mfma_f32_16x16x32_bf16 v[152:155], v[68:71], v[60:63], v[152:155]
    v_mfma_f32_16x16x32_bf16 v[156:159], v[72:75], v[56:59], v[156:159]
    v_mfma_f32_16x16x32_bf16 v[156:159], v[76:79], v[60:63], v[156:159]
    s_waitcnt lgkmcnt(6)
    v_mfma_f32_16x16x32_bf16 v[160:163], v[32:35], v[80:83], v[160:163]
    ds_read_b128 v[64:67], v30 offset:8192
    s_waitcnt lgkmcnt(5)
    v_mfma_f32_16x16x32_bf16 v[160:163], v[36:39], v[84:87], v[160:163]
    ds_read_b128 v[68:71], v31 offset:8192
    v_mfma_f32_16x16x32_bf16 v[164:167], v[40:43], v[80:83], v[164:167]
    v_mfma_f32_16x16x32_bf16 v[164:167], v[44:47], v[84:87], v[164:167]
    ds_read_b128 v[72:75], v30 offset:12288
    v_mfma_f32_16x16x32_bf16 v[168:171], v[48:51], v[80:83], v[168:171]
    ds_read_b128 v[76:79], v31 offset:12288
    v_mfma_f32_16x16x32_bf16 v[168:171], v[52:55], v[84:87], v[168:171]
    v_mfma_f32_16x16x32_bf16 v[172:175], v[56:59], v[80:83], v[172:175]
    v_mfma_f32_16x16x32_bf16 v[172:175], v[60:63], v[84:87], v[172:175]
    s_waitcnt lgkmcnt(6)
    v_mfma_f32_16x16x32_bf16 v[176:179], v[32:35], v[88:91], v[176:179]
    ds_read_b128 v[80:83], v30 offset:10240
    s_waitcnt lgkmcnt(5)
    v_mfma_f32_16x16x32_bf16 v[176:179], v[36:39], v[92:95], v[176:179]
    ds_read_b128 v[84:87], v31 offset:10240
    v_mfma_f32_16x16x32_bf16 v[180:183], v[40:43], v[88:91], v[180:183]
    v_mfma_f32_16x16x32_bf16 v[180:183], v[44:47], v[92:95], v[180:183]
    v_mfma_f32_16x16x32_bf16 v[184:187], v[48:51], v[88:91], v[184:187]
    v_mfma_f32_16x16x32_bf16 v[184:187], v[52:55], v[92:95], v[184:187]
    v_mfma_f32_16x16x32_bf16 v[188:191], v[56:59], v[88:91], v[188:191]
    v_mfma_f32_16x16x32_bf16 v[188:191], v[60:63], v[92:95], v[188:191]
    s_waitcnt lgkmcnt(5)
    v_mfma_f32_16x16x32_bf16 v[192:195], v[32:35], v[64:67], v[192:195]
    ds_read_b64_tr_b16 v[88:89], v20 offset:12288
    s_waitcnt lgkmcnt(5)
    v_mfma_f32_16x16x32_bf16 v[192:195], v[36:39], v[68:71], v[192:195]
    ds_read_b64_tr_b16 v[90:91], v20 offset:12544
    v_mfma_f32_16x16x32_bf16 v[196:199], v[40:43], v[64:67], v[196:199]
    ds_read_b64_tr_b16 v[92:93], v20 offset:14336
    v_mfma_f32_16x16x32_bf16 v[196:199], v[44:47], v[68:71], v[196:199]
    ds_read_b64_tr_b16 v[94:95], v20 offset:14592
    v_mfma_f32_16x16x32_bf16 v[200:203], v[48:51], v[64:67], v[200:203]
    v_mfma_f32_16x16x32_bf16 v[200:203], v[52:55], v[68:71], v[200:203]
    v_mfma_f32_16x16x32_bf16 v[204:207], v[56:59], v[64:67], v[204:207]
    v_mfma_f32_16x16x32_bf16 v[204:207], v[60:63], v[68:71], v[204:207]
    s_waitcnt lgkmcnt(5)
    v_mfma_f32_16x16x32_bf16 v[208:211], v[32:35], v[80:83], v[208:211]
    ds_read_b128 v[64:67], v30 offset:14336
    s_waitcnt lgkmcnt(5)
    v_mfma_f32_16x16x32_bf16 v[208:211], v[36:39], v[84:87], v[208:211]
    ds_read_b128 v[68:71], v31 offset:14336
    v_mfma_f32_16x16x32_bf16 v[212:215], v[40:43], v[80:83], v[212:215]
    v_mfma_f32_16x16x32_bf16 v[212:215], v[44:47], v[84:87], v[212:215]
    v_mfma_f32_16x16x32_bf16 v[216:219], v[48:51], v[80:83], v[216:219]
    v_mfma_f32_16x16x32_bf16 v[216:219], v[52:55], v[84:87], v[216:219]
    v_mfma_f32_16x16x32_bf16 v[220:223], v[56:59], v[80:83], v[220:223]
    v_mfma_f32_16x16x32_bf16 v[220:223], v[60:63], v[84:87], v[220:223]
    v_mfma_f32_16x16x32_bf16 v[224:227], v[32:35], v[72:75], v[224:227]
    ds_read_b64_tr_b16 v[80:81], v25 offset:12288
    v_mfma_f32_16x16x32_bf16 v[224:227], v[36:39], v[76:79], v[224:227]
    ds_read_b64_tr_b16 v[82:83], v25 offset:12544
    v_mfma_f32_16x16x32_bf16 v[228:231], v[40:43], v[72:75], v[228:231]
    ds_read_b64_tr_b16 v[84:85], v25 offset:14336
    v_mfma_f32_16x16x32_bf16 v[228:231], v[44:47], v[76:79], v[228:231]
    ds_read_b64_tr_b16 v[86:87], v25 offset:14592
    v_mfma_f32_16x16x32_bf16 v[232:235], v[48:51], v[72:75], v[232:235]
    v_mfma_f32_16x16x32_bf16 v[232:235], v[52:55], v[76:79], v[232:235]
    v_mfma_f32_16x16x32_bf16 v[236:239], v[56:59], v[72:75], v[236:239]
    v_mfma_f32_16x16x32_bf16 v[236:239], v[60:63], v[76:79], v[236:239]
    s_waitcnt lgkmcnt(5)
    v_mfma_f32_16x16x32_bf16 v[240:243], v[32:35], v[64:67], v[240:243]
    s_waitcnt lgkmcnt(4)
    v_mfma_f32_16x16x32_bf16 v[240:243], v[36:39], v[68:71], v[240:243]
    v_mfma_f32_16x16x32_bf16 v[244:247], v[40:43], v[64:67], v[244:247]
    v_mfma_f32_16x16x32_bf16 v[244:247], v[44:47], v[68:71], v[244:247]
    v_mfma_f32_16x16x32_bf16 v[248:251], v[48:51], v[64:67], v[248:251]
    v_mfma_f32_16x16x32_bf16 v[248:251], v[52:55], v[68:71], v[248:251]
    v_mfma_f32_16x16x32_bf16 v[252:255], v[56:59], v[64:67], v[252:255]
    v_mfma_f32_16x16x32_bf16 v[252:255], v[60:63], v[68:71], v[252:255]
    v_mfma_f32_16x16x32_bf16 v[96:99], v[88:91], v[32:35], v[96:99]
    s_waitcnt lgkmcnt(0)
    s_barrier
    v_mfma_f32_16x16x32_bf16 v[96:99], v[92:95], v[36:39], v[96:99]
    ds_read_b64_tr_b16 v[64:65], v20 offset:28672
    ds_read_b64_tr_b16 v[66:67], v20 offset:28928
    v_mfma_f32_16x16x32_bf16 v[100:103], v[80:83], v[32:35], v[100:103]
    ds_read_b64_tr_b16 v[68:69], v20 offset:30720
    ds_read_b64_tr_b16 v[70:71], v20 offset:30976
    v_mfma_f32_16x16x32_bf16 v[100:103], v[84:87], v[36:39], v[100:103]
    ds_read_b128 v[32:35], v18 offset:0
    ds_read_b128 v[36:39], v19 offset:0
    v_mfma_f32_16x16x32_bf16 v[104:107], v[88:91], v[40:43], v[104:107]
    ds_read_b64_tr_b16 v[72:73], v25 offset:28672
    ds_read_b64_tr_b16 v[74:75], v25 offset:28928
    v_mfma_f32_16x16x32_bf16 v[104:107], v[92:95], v[44:47], v[104:107]
    ds_read_b64_tr_b16 v[76:77], v25 offset:30720
    ds_read_b64_tr_b16 v[78:79], v25 offset:30976
    v_mfma_f32_16x16x32_bf16 v[108:111], v[80:83], v[40:43], v[108:111]
    v_mfma_f32_16x16x32_bf16 v[108:111], v[84:87], v[44:47], v[108:111]
    ds_read_b128 v[40:43], v18 offset:2048
    ds_read_b128 v[44:47], v19 offset:2048
    v_mfma_f32_16x16x32_bf16 v[112:115], v[88:91], v[48:51], v[112:115]
    v_mfma_f32_16x16x32_bf16 v[112:115], v[92:95], v[52:55], v[112:115]
    v_mfma_f32_16x16x32_bf16 v[116:119], v[80:83], v[48:51], v[116:119]
    v_mfma_f32_16x16x32_bf16 v[116:119], v[84:87], v[52:55], v[116:119]
    ds_read_b128 v[48:51], v18 offset:4096
    ds_read_b128 v[52:55], v19 offset:4096
    v_mfma_f32_16x16x32_bf16 v[120:123], v[88:91], v[56:59], v[120:123]
    v_mfma_f32_16x16x32_bf16 v[120:123], v[92:95], v[60:63], v[120:123]
    v_mfma_f32_16x16x32_bf16 v[124:127], v[80:83], v[56:59], v[124:127]
    v_mfma_f32_16x16x32_bf16 v[124:127], v[84:87], v[60:63], v[124:127]
    ds_read_b128 v[56:59], v18 offset:6144
    ds_read_b128 v[60:63], v19 offset:6144
    s_sub_u32 s83, s83, 1
    s_cmp_lg_u32 s83, 0
    s_cbranch_scc1 L_p1_loop
    buffer_load_dwordx2 v[26:27], v1, s[60:63], 0 offen sc1
    s_waitcnt lgkmcnt(11)
    v_mfma_f32_16x16x32_bf16 v[128:131], v[64:67], v[32:35], v[128:131]
    s_waitcnt lgkmcnt(10)
    v_mfma_f32_16x16x32_bf16 v[128:131], v[68:71], v[36:39], v[128:131]
    ds_read_b64_tr_b16 v[80:81], v20 offset:32768
    s_waitcnt lgkmcnt(9)
    v_mfma_f32_16x16x32_bf16 v[132:135], v[72:75], v[32:35], v[132:135]
    ds_read_b64_tr_b16 v[82:83], v20 offset:33024
    s_waitcnt lgkmcnt(8)
    v_mfma_f32_16x16x32_bf16 v[132:135], v[76:79], v[36:39], v[132:135]
    ds_read_b64_tr_b16 v[84:85], v20 offset:34816
    s_waitcnt lgkmcnt(8)
    v_mfma_f32_16x16x32_bf16 v[136:139], v[64:67], v[40:43], v[136:139]
    ds_read_b64_tr_b16 v[86:87], v20 offset:35072
    s_waitcnt lgkmcnt(8)
    v_mfma_f32_16x16x32_bf16 v[136:139], v[68:71], v[44:47], v[136:139]
    v_mfma_f32_16x16x32_bf16 v[140:143], v[72:75], v[40:43], v[140:143]
    v_mfma_f32_16x16x32_bf16 v[140:143], v[76:79], v[44:47], v[140:143]
    s_waitcnt lgkmcnt(7)
    v_mfma_f32_16x16x32_bf16 v[144:147], v[64:67], v[48:51], v[144:147]
    ds_read_b64_tr_b16 v[88:89], v25 offset:32768
    s_waitcnt lgkmcnt(7)
    v_mfma_f32_16x16x32_bf16 v[144:147], v[68:71], v[52:55], v[144:147]
    ds_read_b64_tr_b16 v[90:91], v25 offset:33024
    v_mfma_f32_16x16x32_bf16 v[148:151], v[72:75], v[48:51], v[148:151]
    ds_read_b64_tr_b16 v[92:93], v25 offset:34816
    v_mfma_f32_16x16x32_bf16 v[148:151], v[76:79], v[52:55], v[148:151]
    ds_read_b64_tr_b16 v[94:95], v25 offset:35072
    s_waitcnt lgkmcnt(9)
    v_mfma_f32_16x16x32_bf16 v[152:155], v[64:67], v[56:59], v[152:155]
    s_waitcnt lgkmcnt(8)
    v_mfma_f32_16x16x32_bf16 v[152:155], v[68:71], v[60:63], v[152:155]
    v_mfma_f32_16x16x32_bf16 v[156:159], v[72:75], v[56:59], v[156:159]
    v_mfma_f32_16x16x32_bf16 v[156:159], v[76:79], v[60:63], v[156:159]
    s_waitcnt lgkmcnt(6)
    v_mfma_f32_16x16x32_bf16 v[160:163], v[32:35], v[80:83], v[160:163]
    ds_read_b128 v[64:67], v30 offset:16384
    s_waitcnt lgkmcnt(5)
    v_mfma_f32_16x16x32_bf16 v[160:163], v[36:39], v[84:87], v[160:163]
    ds_read_b128 v[68:71], v31 offset:16384
    v_mfma_f32_16x16x32_bf16 v[164:167], v[40:43], v[80:83], v[164:167]
    v_cvt_pk_bf16_f32 v128, v128, v129
    v_cvt_pk_bf16_f32 v129, v130, v131
    v_mfma_f32_16x16x32_bf16 v[164:167], v[44:47], v[84:87], v[164:167]
    ds_read_b128 v[72:75], v30 offset:20480
    v_cvt_pk_bf16_f32 v130, v132, v133
    v_cvt_pk_bf16_f32 v131, v134, v135
    v_mfma_f32_16x16x32_bf16 v[168:171], v[48:51], v[80:83], v[168:171]
    ds_read_b128 v[76:79], v31 offset:20480
    buffer_store_dwordx4 v[128:131], v23, s[40:43], s12 offen offset:0 sc1
    ds_write_b128 v23, v[128:131] offset:0
    v_mfma_f32_16x16x32_bf16 v[168:171], v[52:55], v[84:87], v[168:171]
    v_cvt_pk_bf16_f32 v136, v136, v137
    v_cvt_pk_bf16_f32 v137, v138, v139
    v_mfma_f32_16x16x32_bf16 v[172:175], v[56:59], v[80:83], v[172:175]
    v_cvt_pk_bf16_f32 v138, v140, v141
    v_cvt_pk_bf16_f32 v139, v142, v143
    v_mfma_f32_16x16x32_bf16 v[172:175], v[60:63], v[84:87], v[172:175]
    buffer_store_dwordx4 v[136:139], v23, s[40:43], s12 offen offset:128 sc1
    ds_write_b128 v23, v[136:139] offset:128
    s_waitcnt lgkmcnt(8)
    v_mfma_f32_16x16x32_bf16 v[176:179], v[32:35], v[88:91], v[176:179]
    ds_read_b128 v[80:83], v30 offset:18432
    v_cvt_pk_bf16_f32 v144, v144, v145
    v_cvt_pk_bf16_f32 v145, v146, v147
    s_waitcnt lgkmcnt(7)
    v_mfma_f32_16x16x32_bf16 v[176:179], v[36:39], v[92:95], v[176:179]
    ds_read_b128 v[84:87], v31 offset:18432
    v_cvt_pk_bf16_f32 v146, v148, v149
    v_cvt_pk_bf16_f32 v147, v150, v151
    v_mfma_f32_16x16x32_bf16 v[180:183], v[40:43], v[88:91], v[180:183]
    buffer_store_dwordx4 v[144:147], v23, s[40:43], s12 offen offset:256 sc1
    ds_write_b128 v23, v[144:147] offset:256
    v_mfma_f32_16x16x32_bf16 v[180:183], v[44:47], v[92:95], v[180:183]
    v_cvt_pk_bf16_f32 v152, v152, v153
    v_cvt_pk_bf16_f32 v153, v154, v155
    v_mfma_f32_16x16x32_bf16 v[184:187], v[48:51], v[88:91], v[184:187]
    v_cvt_pk_bf16_f32 v154, v156, v157
    v_cvt_pk_bf16_f32 v155, v158, v159
    v_mfma_f32_16x16x32_bf16 v[184:187], v[52:55], v[92:95], v[184:187]
    buffer_store_dwordx4 v[152:155], v23, s[40:43], s12 offen offset:384 sc1
    ds_write_b128 v23, v[152:155] offset:384
    v_mfma_f32_16x16x32_bf16 v[188:191], v[56:59], v[88:91], v[188:191]
    v_cvt_pk_bf16_f32 v160, v160, v161
    v_cvt_pk_bf16_f32 v161, v162, v163
    v_cvt_pk_bf16_f32 v162, v164, v165
    v_mfma_f32_16x16x32_bf16 v[188:191], v[60:63], v[92:95], v[188:191]
    v_cvt_pk_bf16_f32 v163, v166, v167
    buffer_store_dwordx4 v[160:163], v29, s[40:43], s12 offen offset:0 sc1
    s_waitcnt lgkmcnt(9)
    v_mfma_f32_16x16x32_bf16 v[192:195], v[32:35], v[64:67], v[192:195]
    ds_read_b64_tr_b16 v[88:89], v20 offset:24576
    ds_write_b128 v29, v[160:163] offset:0
    v_cvt_pk_bf16_f32 v168, v168, v169
    s_waitcnt lgkmcnt(10)
    v_mfma_f32_16x16x32_bf16 v[192:195], v[36:39], v[68:71], v[192:195]
    ds_read_b64_tr_b16 v[90:91], v20 offset:24832
    v_cvt_pk_bf16_f32 v169, v170, v171
    v_cvt_pk_bf16_f32 v170, v172, v173
    v_mfma_f32_16x16x32_bf16 v[196:199], v[40:43], v[64:67], v[196:199]
    ds_read_b64_tr_b16 v[92:93], v20 offset:26624
    v_cvt_pk_bf16_f32 v171, v174, v175
    buffer_store_dwordx4 v[168:171], v29, s[40:43], s12 offen offset:1024 sc1
    v_mfma_f32_16x16x32_bf16 v[196:199], v[44:47], v[68:71], v[196:199]
    ds_read_b64_tr_b16 v[94:95], v20 offset:26880
    ds_write_b128 v29, v[168:171] offset:1024
    ds_read_b128 v[132:135], v21
    v_mfma_f32_16x16x32_bf16 v[200:203], v[48:51], v[64:67], v[200:203]
    v_cvt_pk_bf16_f32 v176, v176, v177
    v_cvt_pk_bf16_f32 v177, v178, v179
    v_mfma_f32_16x16x32_bf16 v[200:203], v[52:55], v[68:71], v[200:203]
    v_cvt_pk_bf16_f32 v178, v180, v181
    v_mfma_f32_16x16x32_bf16 v[204:207], v[56:59], v[64:67], v[204:207]
    v_cvt_pk_bf16_f32 v179, v182, v183
    buffer_store_dwordx4 v[176:179], v29, s[40:43], s12 offen offset:256 sc1
    v_mfma_f32_16x16x32_bf16 v[204:207], v[60:63], v[68:71], v[204:207]
    ds_write_b128 v29, v[176:179] offset:256
    s_waitcnt lgkmcnt(11)
    v_mfma_f32_16x16x32_bf16 v[208:211], v[32:35], v[80:83], v[208:211]
    ds_read_b128 v[64:67], v30 offset:22528
    v_cvt_pk_bf16_f32 v184, v184, v185
    v_cvt_pk_bf16_f32 v185, v186, v187
    s_waitcnt lgkmcnt(11)
    v_mfma_f32_16x16x32_bf16 v[208:211], v[36:39], v[84:87], v[208:211]
    ds_read_b128 v[68:71], v31 offset:22528
    v_cvt_pk_bf16_f32 v186, v188, v189
    v_mfma_f32_16x16x32_bf16 v[212:215], v[40:43], v[80:83], v[212:215]
    v_cvt_pk_bf16_f32 v187, v190, v191
    buffer_store_dwordx4 v[184:187], v29, s[40:43], s12 offen offset:1280 sc1
    v_mfma_f32_16x16x32_bf16 v[212:215], v[44:47], v[84:87], v[212:215]
    ds_write_b128 v29, v[184:187] offset:1280
    v_mfma_f32_16x16x32_bf16 v[216:219], v[48:51], v[80:83], v[216:219]
    v_mfma_f32_16x16x32_bf16 v[216:219], v[52:55], v[84:87], v[216:219]
    v_mfma_f32_16x16x32_bf16 v[220:223], v[56:59], v[80:83], v[220:223]
    v_mfma_f32_16x16x32_bf16 v[220:223], v[60:63], v[84:87], v[220:223]
    v_mfma_f32_16x16x32_bf16 v[224:227], v[32:35], v[72:75], v[224:227]
    ds_read_b64_tr_b16 v[80:81], v25 offset:24576
    v_mfma_f32_16x16x32_bf16 v[224:227], v[36:39], v[76:79], v[224:227]
    ds_read_b64_tr_b16 v[82:83], v25 offset:24832
    s_waitcnt lgkmcnt(4)
    v_mfma_f32_16x16x32_bf16 v[240:243], v[32:35], v[64:67], v[240:243]
    ds_read_b64_tr_b16 v[84:85], v25 offset:26624
    v_permlane16_swap_b32 v192, v208
    v_permlane16_swap_b32 v193, v209
    v_permlane16_swap_b32 v194, v210
    s_waitcnt lgkmcnt(4)
    v_mfma_f32_16x16x32_bf16 v[240:243], v[36:39], v[68:71], v[240:243]
    ds_read_b64_tr_b16 v[86:87], v25 offset:26880
    v_permlane16_swap_b32 v195, v211
    v_permlane16_swap_b32 v196, v212
    v_permlane16_swap_b32 v197, v213
    v_mfma_f32_16x16x32_bf16 v[228:231], v[40:43], v[72:75], v[228:231]
    v_permlane16_swap_b32 v198, v214
    v_permlane16_swap_b32 v199, v215
    v_mfma_f32_16x16x32_bf16 v[228:231], v[44:47], v[76:79], v[228:231]
    v_permlane16_swap_b32 v200, v216
    v_permlane16_swap_b32 v201, v217
    v_permlane16_swap_b32 v202, v218
    v_mfma_f32_16x16x32_bf16 v[244:247], v[40:43], v[64:67], v[244:247]
    v_permlane16_swap_b32 v203, v219
    v_permlane16_swap_b32 v204, v220
    v_permlane16_swap_b32 v205, v221
    v_mfma_f32_16x16x32_bf16 v[244:247], v[44:47], v[68:71], v[244:247]
    v_permlane16_swap_b32 v206, v222
    v_permlane16_swap_b32 v207, v223
    v_mfma_f32_16x16x32_bf16 v[232:235], v[48:51], v[72:75], v[232:235]
    v_permlane16_swap_b32 v224, v240
    v_permlane16_swap_b32 v225, v241
    v_mfma_f32_16x16x32_bf16 v[232:235], v[52:55], v[76:79], v[232:235]
    v_permlane16_swap_b32 v226, v242
    v_permlane16_swap_b32 v227, v243
    v_mfma_f32_16x16x32_bf16 v[248:251], v[48:51], v[64:67], v[248:251]
    v_mfma_f32_16x16x32_bf16 v[248:251], v[52:55], v[68:71], v[248:251]
    v_mfma_f32_16x16x32_bf16 v[236:239], v[56:59], v[72:75], v[236:239]
    v_permlane16_swap_b32 v228, v244
    v_permlane16_swap_b32 v229, v245
    v_permlane16_swap_b32 v230, v246
    v_mfma_f32_16x16x32_bf16 v[236:239], v[60:63], v[76:79], v[236:239]
    v_permlane16_swap_b32 v231, v247
    s_waitcnt lgkmcnt(0)
    v_sub_f32 v148, 0, v133
    v_mfma_f32_16x16x32_bf16 v[252:255], v[56:59], v[64:67], v[252:255]
    v_fma_f32 v142, v132, v192, v193
    v_fma_f32 v143, v132, v224, v225
    v_mfma_f32_16x16x32_bf16 v[252:255], v[60:63], v[68:71], v[252:255]
    v_fmac_f32 v142, v148, v224
    v_fmac_f32 v143, v133, v192
    v_mfma_f32_16x16x32_bf16 v[96:99], v[88:91], v[32:35], v[96:99]
    v_permlane16_swap_b32 v232, v248
    v_permlane16_swap_b32 v233, v249
    v_mfma_f32_16x16x32_bf16 v[96:99], v[92:95], v[36:39], v[96:99]
    v_permlane16_swap_b32 v234, v250
    v_permlane16_swap_b32 v235, v251
    v_mfma_f32_16x16x32_bf16 v[100:103], v[80:83], v[32:35], v[100:103]
    v_fma_f32 v140, v132, v142, v194
    v_fma_f32 v141, v132, v143, v226
    v_mfma_f32_16x16x32_bf16 v[100:103], v[84:87], v[36:39], v[100:103]
    v_fmac_f32 v140, v148, v143
    v_fmac_f32 v141, v133, v142
    v_mfma_f32_16x16x32_bf16 v[104:107], v[88:91], v[40:43], v[104:107]
    v_permlane16_swap_b32 v236, v252
    v_permlane16_swap_b32 v237, v253
    v_mfma_f32_16x16x32_bf16 v[104:107], v[92:95], v[44:47], v[104:107]
    v_permlane16_swap_b32 v238, v254
    v_permlane16_swap_b32 v239, v255
    v_mfma_f32_16x16x32_bf16 v[108:111], v[80:83], v[40:43], v[108:111]
    v_fma_f32 v142, v132, v140, v195
    v_fma_f32 v143, v132, v141, v227
    v_fmac_f32 v142, v148, v141
    v_fmac_f32 v143, v133, v140
    v_mfma_f32_16x16x32_bf16 v[108:111], v[84:87], v[44:47], v[108:111]
    v_fma_f32 v140, v132, v142, v196
    v_fma_f32 v141, v132, v143, v228
    v_fmac_f32 v140, v148, v143
    v_mfma_f32_16x16x32_bf16 v[112:115], v[88:91], v[48:51], v[112:115]
    v_fmac_f32 v141, v133, v142
    v_fma_f32 v142, v132, v140, v197
    v_fma_f32 v143, v132, v141, v229
    v_mfma_f32_16x16x32_bf16 v[112:115], v[92:95], v[52:55], v[112:115]
    v_fmac_f32 v142, v148, v141
    v_fmac_f32 v143, v133, v140
    v_fma_f32 v140, v132, v142, v198
    v_mfma_f32_16x16x32_bf16 v[116:119], v[80:83], v[48:51], v[116:119]
    v_fma_f32 v141, v132, v143, v230
    v_fmac_f32 v140, v148, v143
    v_fmac_f32 v141, v133, v142
    v_mfma_f32_16x16x32_bf16 v[116:119], v[84:87], v[52:55], v[116:119]
    v_fma_f32 v142, v132, v140, v199
    v_fma_f32 v143, v132, v141, v231
    v_fmac_f32 v142, v148, v141
    v_fmac_f32 v143, v133, v140
    v_mfma_f32_16x16x32_bf16 v[120:123], v[88:91], v[56:59], v[120:123]
    v_fma_f32 v140, v132, v142, v200
    v_fma_f32 v141, v132, v143, v232
    v_fmac_f32 v140, v148, v143
    v_mfma_f32_16x16x32_bf16 v[120:123], v[92:95], v[60:63], v[120:123]
    v_fmac_f32 v141, v133, v142
    v_fma_f32 v142, v132, v140, v201
    v_fma_f32 v143, v132, v141, v233
    v_mfma_f32_16x16x32_bf16 v[124:127], v[80:83], v[56:59], v[124:127]
    v_fmac_f32 v142, v148, v141
    v_fmac_f32 v143, v133, v140
    v_fma_f32 v140, v132, v142, v202
    v_mfma_f32_16x16x32_bf16 v[124:127], v[84:87], v[60:63], v[124:127]
    v_fma_f32 v141, v132, v143, v234
    v_fmac_f32 v140, v148, v143
    v_fmac_f32 v141, v133, v142
    s_mov_b32 s6, 0x3e8293ee
    v_mov_b32 v56, v22
    v_mov_b32 v57, v24
    v_add_u32 v62, s13, v4
    v_fma_f32 v142, v132, v140, v203
    v_fma_f32 v143, v132, v141, v235
    v_fmac_f32 v142, v148, v141
    v_fmac_f32 v143, v133, v140
    v_fma_f32 v140, v132, v142, v204
    v_fma_f32 v141, v132, v143, v236
    v_fmac_f32 v140, v148, v143
    v_fmac_f32 v141, v133, v142
    v_fma_f32 v142, v132, v140, v205
    v_fma_f32 v143, v132, v141, v237
    v_fmac_f32 v142, v148, v141
    v_fmac_f32 v143, v133, v140
    v_fma_f32 v140, v132, v142, v206
    v_fma_f32 v141, v132, v143, v238
    v_fmac_f32 v140, v148, v143
    v_fmac_f32 v141, v133, v142
    s_waitcnt vmcnt(8)
    v_mov_b32 v58, v26
    v_mov_b32 v59, v27
    v_fma_f32 v142, v132, v140, v207
    v_mul_f32 v96, s6, v96
    v_mul_f32 v97, s6, v97
    v_fma_f32 v143, v132, v141, v239
    v_mul_f32 v98, s6, v98
    v_fmac_f32 v142, v148, v141
    v_mul_f32 v99, s6, v99
    v_fmac_f32 v143, v133, v140
    v_mul_f32 v100, s6, v100
    v_fma_f32 v140, v132, v142, v208
    v_mul_f32 v101, s6, v101
    v_fma_f32 v141, v132, v143, v240
    v_mul_f32 v102, s6, v102
    v_fmac_f32 v140, v148, v143
    v_mul_f32 v103, s6, v103
    v_fmac_f32 v141, v133, v142
    v_cvt_pk_bf16_f32 v96, v96, v97
    v_cvt_pk_bf16_f32 v97, v98, v99
    v_fma_f32 v142, v132, v140, v209
    v_cvt_pk_bf16_f32 v98, v100, v101
    v_fma_f32 v143, v132, v141, v241
    v_cvt_pk_bf16_f32 v99, v102, v103
    v_fmac_f32 v142, v148, v141
    ds_write_b128 v57, v[96:99] offset:0
    v_fmac_f32 v143, v133, v140
    v_mul_f32 v104, s6, v104
    v_fma_f32 v140, v132, v142, v210
    v_mul_f32 v105, s6, v105
    v_fma_f32 v141, v132, v143, v242
    v_mul_f32 v106, s6, v106
    v_fmac_f32 v140, v148, v143
    v_mul_f32 v107, s6, v107
    v_fmac_f32 v141, v133, v142
    v_mul_f32 v108, s6, v108
    v_mul_f32 v109, s6, v109
    v_fma_f32 v142, v132, v140, v211
    v_mul_f32 v110, s6, v110
    v_fma_f32 v143, v132, v141, v243
    v_mul_f32 v111, s6, v111
    v_fmac_f32 v142, v148, v141
    v_cvt_pk_bf16_f32 v104, v104, v105
    v_fmac_f32 v143, v133, v140
    v_cvt_pk_bf16_f32 v105, v106, v107
    v_fma_f32 v140, v132, v142, v212
    v_cvt_pk_bf16_f32 v106, v108, v109
    v_fma_f32 v141, v132, v143, v244
    v_cvt_pk_bf16_f32 v107, v110, v111
    v_fmac_f32 v140, v148, v143
    ds_write_b128 v57, v[104:107] offset:128
    v_mul_f32 v112, s6, v112
    v_fmac_f32 v141, v133, v142
    v_mul_f32 v113, s6, v113
    v_fma_f32 v142, v132, v140, v213
    v_mul_f32 v114, s6, v114
    v_fma_f32 v143, v132, v141, v245
    v_mul_f32 v115, s6, v115
    v_fmac_f32 v142, v148, v141
    v_mul_f32 v116, s6, v116
    v_fmac_f32 v143, v133, v140
    v_mul_f32 v117, s6, v117
    v_fma_f32 v140, v132, v142, v214
    v_mul_f32 v118, s6, v118
    v_fma_f32 v141, v132, v143, v246
    v_mul_f32 v119, s6, v119
    v_fmac_f32 v140, v148, v143
    v_cvt_pk_bf16_f32 v112, v112, v113
    v_cvt_pk_bf16_f32 v113, v114, v115
    v_fmac_f32 v141, v133, v142
    v_cvt_pk_bf16_f32 v114, v116, v117
    v_fma_f32 v142, v132, v140, v215
    v_cvt_pk_bf16_f32 v115, v118, v119
    v_fma_f32 v143, v132, v141, v247
    ds_write_b128 v57, v[112:115] offset:256
    v_fmac_f32 v142, v148, v141
    v_mul_f32 v120, s6, v120
    v_fmac_f32 v143, v133, v140
    v_mul_f32 v121, s6, v121
    v_fma_f32 v140, v132, v142, v216
    v_mul_f32 v122, s6, v122
    v_fma_f32 v141, v132, v143, v248
    v_mul_f32 v123, s6, v123
    v_mul_f32 v124, s6, v124
    v_fmac_f32 v140, v148, v143
    v_mul_f32 v125, s6, v125
    v_fmac_f32 v141, v133, v142
    v_mul_f32 v126, s6, v126
    v_fma_f32 v142, v132, v140, v217
    v_mul_f32 v127, s6, v127
    v_fma_f32 v143, v132, v141, v249
    v_cvt_pk_bf16_f32 v120, v120, v121
    v_fmac_f32 v142, v148, v141
    v_cvt_pk_bf16_f32 v121, v122, v123
    v_fmac_f32 v143, v133, v140
    v_cvt_pk_bf16_f32 v122, v124, v125
    v_fma_f32 v140, v132, v142, v218
    v_cvt_pk_bf16_f32 v123, v126, v127
    v_fma_f32 v141, v132, v143, v250
    ds_write_b128 v57, v[120:123] offset:384
    ds_read_b128 v[16:19], v62 offset:0
    v_fmac_f32 v140, v148, v143
    ds_read_b128 v[20:23], v62 offset:1024
    v_fmac_f32 v141, v133, v142
    ds_read_b128 v[24:27], v62 offset:2048
    v_fma_f32 v142, v132, v140, v219
    ds_read_b128 v[28:31], v62 offset:3072
    v_fma_f32 v143, v132, v141, v251
    v_and_b32 v60, 1, v0
    v_fmac_f32 v142, v148, v141
    v_cmp_eq_u32 vcc, 0, v60
    v_fmac_f32 v143, v133, v140
    v_mov_b32 v60, 0xeeeeeeee
    v_fma_f32 v140, v132, v142, v220
    v_mov_b32 v61, 0x44444444
    v_cndmask_b32 v159, v60, v61, vcc
    v_fma_f32 v141, v132, v143, v252
    v_and_b32 v60, 6, v0
    v_fmac_f32 v140, v148, v143
    v_mov_b32 v61, 0x3f803f80
    v_fmac_f32 v141, v133, v142
    v_cmp_eq_u32 vcc, 0, v60
    v_fma_f32 v142, v132, v140, v221
    v_cndmask_b32 v32, 0, v61, vcc
    v_fma_f32 v143, v132, v141, v253
    v_cmp_eq_u32 vcc, 4, v60
    v_fmac_f32 v142, v148, v141
    v_cndmask_b32 v34, 0, v61, vcc
    v_fmac_f32 v143, v133, v140
    v_mov_b32 v33, v32
    v_fma_f32 v140, v132, v142, v222
    v_mov_b32 v35, v34
    v_mov_b32 v36, 0
    v_fma_f32 v141, v132, v143, v254
    v_mov_b32 v37, 0
    v_fmac_f32 v140, v148, v143
    v_mov_b32 v38, 0
    v_fmac_f32 v141, v133, v142
    v_mov_b32 v39, 0
    v_fma_f32 v142, v132, v140, v223
    v_mov_b32 v40, 0
    v_fma_f32 v143, v132, v141, v255
    v_mov_b32 v41, 0
    v_fmac_f32 v142, v148, v141
    v_mov_b32 v42, 0
    v_fmac_f32 v143, v133, v140
    v_mov_b32 v43, 0
    ds_write_b64 v56, v[142:143]
    s_mov_b32 s83, 0
L_an:
    v_readfirstlane_b32 s26, v58
    v_readfirstlane_b32 s27, v59
    s_add_u32 s83, s83, 1
    s_cmp_lg_u32 s26, 0
    s_cbranch_scc1 L_ank
    s_cmp_ge_u32 s83, 65536
    s_cbranch_scc1 L_ank
    buffer_load_dwordx2 v[58:59], v1, s[60:63], 0 offen sc1
    s_waitcnt vmcnt(0)
    s_branch L_an
L_ank:
    s_lshl_b32 s6, s5, 5
    s_lshl_b32 s7, s4, 2
    s_add_u32 s6, s6, s7
    s_add_u32 s6, s6, s3
    s_lshl_b32 s6, s6, 3
    s_add_u32 s6, s6, 27328512
    s_waitcnt vmcnt(0)
    v_mov_b32 v144, s26
    v_mov_b32 v145, s27
    v_mov_b32 v146, 0
    s_mov_b64 exec, 1
    buffer_store_dwordx2 v[144:145], v146, s[52:55], s6 offen sc1
    s_mov_b64 exec, -1
    s_waitcnt lgkmcnt(0)
    s_barrier
    ds_read_b128 v[44:47], v2
    ds_read_b128 v[48:51], v2 offset:1024
    s_waitcnt lgkmcnt(0)
    v_mfma_f32_32x32x16_bf16 v[76:91], v[44:47], v[16:19], 0
    v_mfma_f32_32x32x16_bf16 v[76:91], v[48:51], v[20:23], v[76:91]
    v_sub_f32 v60, 0, v134
    v_sub_f32 v61, 0, v135
    v_mul_f32 v160, v134, v192
    v_fmac_f32 v160, v61, v224
    v_mul_f32 v224, v60, v224
    v_fmac_f32 v224, v61, v192
    v_mul_f32 v161, v134, v193
    v_fmac_f32 v161, v61, v225
    v_mul_f32 v225, v60, v225
    v_fmac_f32 v225, v61, v193
    v_mul_f32 v162, v134, v194
    v_fmac_f32 v162, v61, v226
    v_mul_f32 v226, v60, v226
    v_fmac_f32 v226, v61, v194
    v_mul_f32 v163, v134, v195
    v_fmac_f32 v163, v61, v227
    v_mul_f32 v227, v60, v227
    v_fmac_f32 v227, v61, v195
    v_mul_f32 v164, v134, v196
    v_fmac_f32 v164, v61, v228
    v_mul_f32 v228, v60, v228
    v_fmac_f32 v228, v61, v196
    v_mul_f32 v165, v134, v197
    v_fmac_f32 v165, v61, v229
    v_mul_f32 v229, v60, v229
    v_fmac_f32 v229, v61, v197
    v_mul_f32 v166, v134, v198
    v_fmac_f32 v166, v61, v230
    v_mul_f32 v230, v60, v230
    v_fmac_f32 v230, v61, v198
    v_mul_f32 v167, v134, v199
    v_fmac_f32 v167, v61, v231
    v_mul_f32 v231, v60, v231
    v_fmac_f32 v231, v61, v199
    v_mul_f32 v168, v134, v200
    v_fmac_f32 v168, v61, v232
    v_mul_f32 v232, v60, v232
    v_fmac_f32 v232, v61, v200
    v_mul_f32 v169, v134, v201
    v_fmac_f32 v169, v61, v233
    v_mul_f32 v233, v60, v233
    v_fmac_f32 v233, v61, v201
    v_mul_f32 v170, v134, v202
    v_fmac_f32 v170, v61, v234
    v_mul_f32 v234, v60, v234
    v_fmac_f32 v234, v61, v202
    v_mul_f32 v171, v134, v203
    v_fmac_f32 v171, v61, v235
    v_mul_f32 v235, v60, v235
    v_fmac_f32 v235, v61, v203
    v_mul_f32 v172, v134, v204
    v_fmac_f32 v172, v61, v236
    v_mul_f32 v236, v60, v236
    v_fmac_f32 v236, v61, v204
    v_mul_f32 v173, v134, v205
    v_fmac_f32 v173, v61, v237
    v_mul_f32 v237, v60, v237
    v_fmac_f32 v237, v61, v205
    v_mul_f32 v174, v134, v206
    v_fmac_f32 v174, v61, v238
    v_mul_f32 v238, v60, v238
    v_fmac_f32 v238, v61, v206
    v_mul_f32 v175, v134, v207
    v_fmac_f32 v175, v61, v239
    v_mul_f32 v239, v60, v239
    v_fmac_f32 v239, v61, v207
    v_mul_f32 v176, v134, v208
    v_fmac_f32 v176, v61, v240
    v_mul_f32 v240, v60, v240
    v_fmac_f32 v240, v61, v208
    v_mul_f32 v177, v134, v209
    v_fmac_f32 v177, v61, v241
    v_mul_f32 v241, v60, v241
    v_fmac_f32 v241, v61, v209
    v_mul_f32 v178, v134, v210
    v_fmac_f32 v178, v61, v242
    v_mul_f32 v242, v60, v242
    v_fmac_f32 v242, v61, v210
    v_mul_f32 v179, v134, v211
    v_fmac_f32 v179, v61, v243
    v_mul_f32 v243, v60, v243
    v_fmac_f32 v243, v61, v211
    v_mul_f32 v180, v134, v212
    v_fmac_f32 v180, v61, v244
    v_mul_f32 v244, v60, v244
    v_fmac_f32 v244, v61, v212
    v_mul_f32 v181, v134, v213
    v_fmac_f32 v181, v61, v245
    v_mul_f32 v245, v60, v245
    v_fmac_f32 v245, v61, v213
    v_mul_f32 v182, v134, v214
    v_fmac_f32 v182, v61, v246
    v_mul_f32 v246, v60, v246
    v_fmac_f32 v246, v61, v214
    v_mul_f32 v183, v134, v215
    v_fmac_f32 v183, v61, v247
    v_mul_f32 v247, v60, v247
    v_fmac_f32 v247, v61, v215
    v_mul_f32 v184, v134, v216
    v_fmac_f32 v184, v61, v248
    v_mul_f32 v248, v60, v248
    v_fmac_f32 v248, v61, v216
    v_mul_f32 v185, v134, v217
    v_fmac_f32 v185, v61, v249
    v_mul_f32 v249, v60, v249
    v_fmac_f32 v249, v61, v217
    v_mul_f32 v186, v134, v218
    v_fmac_f32 v186, v61, v250
    v_mul_f32 v250, v60, v250
    v_fmac_f32 v250, v61, v218
    v_mul_f32 v187, v134, v219
    v_fmac_f32 v187, v61, v251
    v_mul_f32 v251, v60, v251
    v_fmac_f32 v251, v61, v219
    v_mul_f32 v188, v134, v220
    v_fmac_f32 v188, v61, v252
    v_mul_f32 v252, v60, v252
    v_fmac_f32 v252, v61, v220
    v_mul_f32 v189, v134, v221
    v_fmac_f32 v189, v61, v253
    v_mul_f32 v253, v60, v253
    v_fmac_f32 v253, v61, v221
    v_mul_f32 v190, v134, v222
    v_fmac_f32 v190, v61, v254
    v_mul_f32 v254, v60, v254
    v_fmac_f32 v254, v61, v222
    v_mul_f32 v191, v134, v223
    v_fmac_f32 v191, v61, v255
    v_mul_f32 v255, v60, v255
    v_fmac_f32 v255, v61, v223
    v_exp_f32 v76, v76
    v_exp_f32 v77, v77
    v_mfma_f32_32x32x16_bf16 v[92:107], v[44:47], v[24:27], 0
    v_exp_f32 v78, v78
    v_cvt_pk_bf16_f32 v60, v76, v77
    v_exp_f32 v79, v79
    v_exp_f32 v80, v80
    v_mfma_f32_32x32x16_bf16 v[92:107], v[48:51], v[28:31], v[92:107]
    v_cvt_pk_bf16_f32 v61, v78, v79
    ds_read_b128 v[44:47], v2 offset:4096
    v_exp_f32 v81, v81
    ds_read_b128 v[48:51], v2 offset:5120
    v_exp_f32 v82, v82
    v_cvt_pk_bf16_f32 v62, v80, v81
    v_exp_f32 v83, v83
    v_exp_f32 v84, v84
    v_cvt_pk_bf16_f32 v63, v82, v83
    v_exp_f32 v85, v85
    v_exp_f32 v86, v86
    v_cvt_pk_bf16_f32 v64, v84, v85
    ds_read_b128 v[52:55], v2 offset:2048
    v_exp_f32 v87, v87
    ds_read_b128 v[56:59], v2 offset:3072
    v_exp_f32 v88, v88
    v_cvt_pk_bf16_f32 v65, v86, v87
    v_exp_f32 v89, v89
    v_exp_f32 v90, v90
    v_cvt_pk_bf16_f32 v66, v88, v89
    v_exp_f32 v91, v91
    v_exp_f32 v92, v92
    v_cvt_pk_bf16_f32 v67, v90, v91
    v_exp_f32 v93, v93
    s_waitcnt lgkmcnt(2)
    v_mfma_f32_32x32x16_bf16 v[76:91], v[44:47], v[16:19], 0
    v_exp_f32 v94, v94
    v_cvt_pk_bf16_f32 v68, v92, v93
    v_exp_f32 v95, v95
    v_exp_f32 v96, v96
    v_mfma_f32_32x32x16_bf16 v[76:91], v[48:51], v[20:23], v[76:91]
    v_cvt_pk_bf16_f32 v69, v94, v95
    v_exp_f32 v97, v97
    v_exp_f32 v98, v98
    v_cvt_pk_bf16_f32 v70, v96, v97
    v_exp_f32 v99, v99
    s_waitcnt lgkmcnt(0)
    v_mfma_f32_32x32x16_bf16 v[108:123], v[52:55], v[60:63], 0
    v_exp_f32 v100, v100
    v_cvt_pk_bf16_f32 v71, v98, v99
    v_exp_f32 v101, v101
    v_exp_f32 v102, v102
    v_mfma_f32_32x32x16_bf16 v[108:123], v[56:59], v[64:67], v[108:123]
    v_cvt_pk_bf16_f32 v72, v100, v101
    v_exp_f32 v103, v103
    v_exp_f32 v104, v104
    v_cvt_pk_bf16_f32 v73, v102, v103
    v_exp_f32 v105, v105
    v_smfmac_f32_16x16x64_bf16 v[36:39], v[32:35], v[60:67], v159
    v_exp_f32 v106, v106
    v_cvt_pk_bf16_f32 v74, v104, v105
    v_exp_f32 v107, v107
    v_exp_f32 v76, v76
    v_cvt_pk_bf16_f32 v75, v106, v107
    v_exp_f32 v77, v77
    v_mfma_f32_32x32x16_bf16 v[92:107], v[44:47], v[24:27], 0
    v_exp_f32 v78, v78
    v_cvt_pk_bf16_f32 v60, v76, v77
    v_exp_f32 v79, v79
    v_exp_f32 v80, v80
    v_mfma_f32_32x32x16_bf16 v[92:107], v[48:51], v[28:31], v[92:107]
    v_cvt_pk_bf16_f32 v61, v78, v79
    ds_read_b128 v[44:47], v2 offset:16384
    v_exp_f32 v81, v81
    ds_read_b128 v[48:51], v2 offset:17408
    v_exp_f32 v82, v82
    v_cvt_pk_bf16_f32 v62, v80, v81
    v_exp_f32 v83, v83
    v_mfma_f32_32x32x16_bf16 v[124:139], v[52:55], v[68:71], 0
    v_exp_f32 v84, v84
    v_cvt_pk_bf16_f32 v63, v82, v83
    v_exp_f32 v85, v85
    v_exp_f32 v86, v86
    v_mfma_f32_32x32x16_bf16 v[124:139], v[56:59], v[72:75], v[124:139]
    v_cvt_pk_bf16_f32 v64, v84, v85
    ds_read_b128 v[52:55], v2 offset:6144
    v_exp_f32 v87, v87
    ds_read_b128 v[56:59], v2 offset:7168
    v_exp_f32 v88, v88
    v_cvt_pk_bf16_f32 v65, v86, v87
    v_exp_f32 v89, v89
    v_smfmac_f32_16x16x64_bf16 v[40:43], v[32:35], v[68:75], v159
    v_exp_f32 v90, v90
    v_cvt_pk_bf16_f32 v66, v88, v89
    v_exp_f32 v91, v91
    v_exp_f32 v92, v92
    v_cvt_pk_bf16_f32 v67, v90, v91
    v_exp_f32 v93, v93
    s_waitcnt lgkmcnt(2)
    v_mfma_f32_32x32x16_bf16 v[76:91], v[44:47], v[16:19], 0
    v_exp_f32 v94, v94
    v_cvt_pk_bf16_f32 v68, v92, v93
    v_exp_f32 v95, v95
    v_exp_f32 v96, v96
    v_mfma_f32_32x32x16_bf16 v[76:91], v[48:51], v[20:23], v[76:91]
    v_cvt_pk_bf16_f32 v69, v94, v95
    v_exp_f32 v97, v97
    v_exp_f32 v98, v98
    v_cvt_pk_bf16_f32 v70, v96, v97
    v_exp_f32 v99, v99
    s_waitcnt lgkmcnt(0)
    v_mfma_f32_32x32x16_bf16 v[108:123], v[52:55], v[60:63], v[108:123]
    v_exp_f32 v100, v100
    v_cvt_pk_bf16_f32 v71, v98, v99
    v_exp_f32 v101, v101
    v_exp_f32 v102, v102
    v_mfma_f32_32x32x16_bf16 v[108:123], v[56:59], v[64:67], v[108:123]
    v_cvt_pk_bf16_f32 v72, v100, v101
    v_exp_f32 v103, v103
    v_exp_f32 v104, v104
    v_cvt_pk_bf16_f32 v73, v102, v103
    v_exp_f32 v105, v105
    v_smfmac_f32_16x16x64_bf16 v[36:39], v[32:35], v[60:67], v159
    v_exp_f32 v106, v106
    v_cvt_pk_bf16_f32 v74, v104, v105
    v_exp_f32 v107, v107
    v_exp_f32 v76, v76
    v_cvt_pk_bf16_f32 v75, v106, v107
    v_exp_f32 v77, v77
    v_mfma_f32_32x32x16_bf16 v[92:107], v[44:47], v[24:27], 0
    v_exp_f32 v78, v78
    v_cvt_pk_bf16_f32 v60, v76, v77
    v_exp_f32 v79, v79
    v_exp_f32 v80, v80
    v_mfma_f32_32x32x16_bf16 v[92:107], v[48:51], v[28:31], v[92:107]
    v_cvt_pk_bf16_f32 v61, v78, v79
    ds_read_b128 v[44:47], v2 offset:20480
    v_exp_f32 v81, v81
    ds_read_b128 v[48:51], v2 offset:21504
    v_exp_f32 v82, v82
    v_cvt_pk_bf16_f32 v62, v80, v81
    v_exp_f32 v83, v83
    v_mfma_f32_32x32x16_bf16 v[124:139], v[52:55], v[68:71], v[124:139]
    v_exp_f32 v84, v84
    v_cvt_pk_bf16_f32 v63, v82, v83
    v_exp_f32 v85, v85
    v_exp_f32 v86, v86
    v_mfma_f32_32x32x16_bf16 v[124:139], v[56:59], v[72:75], v[124:139]
    v_cvt_pk_bf16_f32 v64, v84, v85
    ds_read_b128 v[52:55], v2 offset:18432
    v_exp_f32 v87, v87
    ds_read_b128 v[56:59], v2 offset:19456
    v_exp_f32 v88, v88
    v_cvt_pk_bf16_f32 v65, v86, v87
    v_exp_f32 v89, v89
    v_smfmac_f32_16x16x64_bf16 v[40:43], v[32:35], v[68:75], v159
    v_exp_f32 v90, v90
    v_cvt_pk_bf16_f32 v66, v88, v89
    v_exp_f32 v91, v91
    v_exp_f32 v92, v92
    v_cvt_pk_bf16_f32 v67, v90, v91
    v_exp_f32 v93, v93
    s_waitcnt lgkmcnt(2)
    v_mfma_f32_32x32x16_bf16 v[76:91], v[44:47], v[16:19], 0
    v_exp_f32 v94, v94
    v_cvt_pk_bf16_f32 v68, v92, v93
    v_exp_f32 v95, v95
    v_exp_f32 v96, v96
    v_mfma_f32_32x32x16_bf16 v[76:91], v[48:51], v[20:23], v[76:91]
    v_cvt_pk_bf16_f32 v69, v94, v95
    v_exp_f32 v97, v97
    v_exp_f32 v98, v98
    v_cvt_pk_bf16_f32 v70, v96, v97
    v_exp_f32 v99, v99
    s_waitcnt lgkmcnt(0)
    v_mfma_f32_32x32x16_bf16 v[108:123], v[52:55], v[60:63], v[108:123]
    v_exp_f32 v100, v100
    v_cvt_pk_bf16_f32 v71, v98, v99
    v_exp_f32 v101, v101
    v_exp_f32 v102, v102
    v_mfma_f32_32x32x16_bf16 v[108:123], v[56:59], v[64:67], v[108:123]
    v_cvt_pk_bf16_f32 v72, v100, v101
    v_exp_f32 v103, v103
    v_exp_f32 v104, v104
    v_cvt_pk_bf16_f32 v73, v102, v103
    v_exp_f32 v105, v105
    v_smfmac_f32_16x16x64_bf16 v[36:39], v[32:35], v[60:67], v159
    v_exp_f32 v106, v106
    v_cvt_pk_bf16_f32 v74, v104, v105
    v_exp_f32 v107, v107
    s_barrier
    v_and_b32 v152, 31, v0
    v_lshlrev_b32 v152, 4, v152
    v_add_u32 v152, 161792, v152
    ds_read_b64 v[144:145], v152
    s_lshl_b32 s6, s3, 9
    s_add_u32 s6, s6, 151552
    v_lshl_add_u32 v152, v0, 3, s6
    ds_read_b64 v[150:151], v152
    s_lshl_b32 s6, s3, 13
    s_add_u32 s6, s6, 65536
    v_lshrrev_b32 v146, 5, v0
    v_lshlrev_b32 v152, 12, v146
    v_bfe_u32 v147, v0, 2, 3
    v_lshl_add_u32 v152, v147, 8, v152
    v_and_b32 v149, 3, v0
    v_lshl_add_u32 v152, v149, 4, v152
    v_add_u32 v152, s6, v152
    v_and_b32 v147, 1, v147
    v_lshl_add_u32 v153, v147, 6, v152
    v_xor_b32 v154, 64, v153
    v_lshlrev_b32 v155, 9, v146
    v_bfe_u32 v147, v0, 2, 2
    v_lshl_add_u32 v155, v147, 4, v155
    v_and_b32 v147, 1, v0
    v_lshl_add_u32 v155, v147, 3, v155
    v_bfe_u32 v147, v0, 4, 1
    v_lshl_add_u32 v155, v147, 7, v155
    v_add_u32 v155, s6, v155
    v_bfe_u32 v147, v0, 1, 1
    v_lshl_add_u32 v156, v147, 6, v155
    v_xor_b32 v157, 64, v156
    s_lshl_b32 s6, s4, 3
    s_lshl_b32 s7, s3, 1
    s_add_u32 s6, s6, s7
    s_lshl_b32 s6, s6, 17
    s_lshl_b32 s7, s5, 12
    s_add_u32 s6, s6, s7
    s_add_u32 s12, s6, 12582912
    s_add_u32 s13, s12, 131072
    s_waitcnt lgkmcnt(0)
    v_sub_f32 v148, 0, v145
    v_fmac_f32 v160, v144, v150
    v_fmac_f32 v224, v144, v151
    v_fmac_f32 v160, v145, v151
    v_fmac_f32 v224, v148, v150
    v_fmac_f32 v161, v144, v160
    v_fmac_f32 v225, v144, v224
    v_fmac_f32 v161, v145, v224
    v_fmac_f32 v225, v148, v160
    v_cvt_pk_bf16_f32 v192, v160, v161
    v_cvt_pk_bf16_f32 v208, v224, v225
    v_fmac_f32 v162, v144, v161
    v_fmac_f32 v226, v144, v225
    v_fmac_f32 v162, v145, v225
    v_fmac_f32 v226, v148, v161
    v_fmac_f32 v163, v144, v162
    v_fmac_f32 v227, v144, v226
    v_fmac_f32 v163, v145, v226
    v_fmac_f32 v227, v148, v162
    v_cvt_pk_bf16_f32 v193, v162, v163
    v_cvt_pk_bf16_f32 v209, v226, v227
    v_fmac_f32 v164, v144, v163
    v_fmac_f32 v228, v144, v227
    v_fmac_f32 v164, v145, v227
    v_fmac_f32 v228, v148, v163
    v_fmac_f32 v165, v144, v164
    v_fmac_f32 v229, v144, v228
    v_fmac_f32 v165, v145, v228
    v_fmac_f32 v229, v148, v164
    v_cvt_pk_bf16_f32 v194, v164, v165
    v_cvt_pk_bf16_f32 v210, v228, v229
    v_fmac_f32 v166, v144, v165
    v_fmac_f32 v230, v144, v229
    v_fmac_f32 v166, v145, v229
    v_fmac_f32 v230, v148, v165
    v_fmac_f32 v167, v144, v166
    v_fmac_f32 v231, v144, v230
    v_fmac_f32 v167, v145, v230
    v_fmac_f32 v231, v148, v166
    v_cvt_pk_bf16_f32 v195, v166, v167
    v_cvt_pk_bf16_f32 v211, v230, v231
    ds_write_b128 v153, v[192:195] offset:0
    ds_write_b128 v153, v[208:211] offset:2048
    v_fmac_f32 v168, v144, v167
    v_fmac_f32 v232, v144, v231
    v_fmac_f32 v168, v145, v231
    v_fmac_f32 v232, v148, v167
    v_fmac_f32 v169, v144, v168
    v_fmac_f32 v233, v144, v232
    v_fmac_f32 v169, v145, v232
    v_fmac_f32 v233, v148, v168
    v_cvt_pk_bf16_f32 v196, v168, v169
    v_cvt_pk_bf16_f32 v212, v232, v233
    v_fmac_f32 v170, v144, v169
    v_fmac_f32 v234, v144, v233
    v_fmac_f32 v170, v145, v233
    v_fmac_f32 v234, v148, v169
    v_fmac_f32 v171, v144, v170
    v_fmac_f32 v235, v144, v234
    v_fmac_f32 v171, v145, v234
    v_fmac_f32 v235, v148, v170
    v_cvt_pk_bf16_f32 v197, v170, v171
    v_cvt_pk_bf16_f32 v213, v234, v235
    v_fmac_f32 v172, v144, v171
    v_fmac_f32 v236, v144, v235
    v_fmac_f32 v172, v145, v235
    v_fmac_f32 v236, v148, v171
    v_fmac_f32 v173, v144, v172
    v_fmac_f32 v237, v144, v236
    v_fmac_f32 v173, v145, v236
    v_fmac_f32 v237, v148, v172
    v_cvt_pk_bf16_f32 v198, v172, v173
    v_cvt_pk_bf16_f32 v214, v236, v237
    v_fmac_f32 v174, v144, v173
    v_fmac_f32 v238, v144, v237
    v_fmac_f32 v174, v145, v237
    v_fmac_f32 v238, v148, v173
    v_fmac_f32 v175, v144, v174
    v_fmac_f32 v239, v144, v238
    v_fmac_f32 v175, v145, v238
    v_fmac_f32 v239, v148, v174
    v_cvt_pk_bf16_f32 v199, v174, v175
    v_cvt_pk_bf16_f32 v215, v238, v239
    ds_write_b128 v154, v[196:199] offset:0
    ds_write_b128 v154, v[212:215] offset:2048
    v_fmac_f32 v176, v144, v175
    v_fmac_f32 v240, v144, v239
    v_fmac_f32 v176, v145, v239
    v_fmac_f32 v240, v148, v175
    v_fmac_f32 v177, v144, v176
    v_fmac_f32 v241, v144, v240
    v_fmac_f32 v177, v145, v240
    v_fmac_f32 v241, v148, v176
    v_cvt_pk_bf16_f32 v200, v176, v177
    v_cvt_pk_bf16_f32 v216, v240, v241
    v_fmac_f32 v178, v144, v177
    v_fmac_f32 v242, v144, v241
    v_fmac_f32 v178, v145, v241
    v_fmac_f32 v242, v148, v177
    v_fmac_f32 v179, v144, v178
    v_fmac_f32 v243, v144, v242
    v_fmac_f32 v179, v145, v242
    v_fmac_f32 v243, v148, v178
    v_cvt_pk_bf16_f32 v201, v178, v179
    v_cvt_pk_bf16_f32 v217, v242, v243
    v_fmac_f32 v180, v144, v179
    v_fmac_f32 v244, v144, v243
    v_fmac_f32 v180, v145, v243
    v_fmac_f32 v244, v148, v179
    v_fmac_f32 v181, v144, v180
    v_fmac_f32 v245, v144, v244
    v_fmac_f32 v181, v145, v244
    v_fmac_f32 v245, v148, v180
    v_cvt_pk_bf16_f32 v202, v180, v181
    v_cvt_pk_bf16_f32 v218, v244, v245
    v_fmac_f32 v182, v144, v181
    v_fmac_f32 v246, v144, v245
    v_fmac_f32 v182, v145, v245
    v_fmac_f32 v246, v148, v181
    v_fmac_f32 v183, v144, v182
    v_fmac_f32 v247, v144, v246
    v_fmac_f32 v183, v145, v246
    v_fmac_f32 v247, v148, v182
    v_cvt_pk_bf16_f32 v203, v182, v183
    v_cvt_pk_bf16_f32 v219, v246, v247
    ds_write_b128 v153, v[200:203] offset:128
    ds_write_b128 v153, v[216:219] offset:2176
    v_fmac_f32 v184, v144, v183
    v_fmac_f32 v248, v144, v247
    v_fmac_f32 v184, v145, v247
    v_fmac_f32 v248, v148, v183
    v_fmac_f32 v185, v144, v184
    v_fmac_f32 v249, v144, v248
    v_fmac_f32 v185, v145, v248
    v_fmac_f32 v249, v148, v184
    v_cvt_pk_bf16_f32 v204, v184, v185
    v_cvt_pk_bf16_f32 v220, v248, v249
    v_fmac_f32 v186, v144, v185
    v_fmac_f32 v250, v144, v249
    v_fmac_f32 v186, v145, v249
    v_fmac_f32 v250, v148, v185
    v_fmac_f32 v187, v144, v186
    v_fmac_f32 v251, v144, v250
    v_fmac_f32 v187, v145, v250
    v_fmac_f32 v251, v148, v186
    v_cvt_pk_bf16_f32 v205, v186, v187
    v_cvt_pk_bf16_f32 v221, v250, v251
    v_fmac_f32 v188, v144, v187
    v_fmac_f32 v252, v144, v251
    v_fmac_f32 v188, v145, v251
    v_fmac_f32 v252, v148, v187
    v_fmac_f32 v189, v144, v188
    v_fmac_f32 v253, v144, v252
    v_fmac_f32 v189, v145, v252
    v_fmac_f32 v253, v148, v188
    v_cvt_pk_bf16_f32 v206, v188, v189
    v_cvt_pk_bf16_f32 v222, v252, v253
    v_fmac_f32 v190, v144, v189
    v_fmac_f32 v254, v144, v253
    v_fmac_f32 v190, v145, v253
    v_fmac_f32 v254, v148, v189
    v_fmac_f32 v191, v144, v190
    v_fmac_f32 v255, v144, v254
    v_fmac_f32 v191, v145, v254
    v_fmac_f32 v255, v148, v190
    v_cvt_pk_bf16_f32 v207, v190, v191
    v_cvt_pk_bf16_f32 v223, v254, v255
    ds_write_b128 v154, v[204:207] offset:128
    ds_write_b128 v154, v[220:223] offset:2176
    s_waitcnt lgkmcnt(0)
    ds_read_b64_tr_b16 v[160:161], v156 offset:0
    ds_read_b64_tr_b16 v[162:163], v157 offset:256
    ds_read_b64_tr_b16 v[164:165], v156 offset:1024
    ds_read_b64_tr_b16 v[166:167], v157 offset:1280
    ds_read_b64_tr_b16 v[168:169], v156 offset:2048
    ds_read_b64_tr_b16 v[170:171], v157 offset:2304
    ds_read_b64_tr_b16 v[172:173], v156 offset:3072
    ds_read_b64_tr_b16 v[174:175], v157 offset:3328
    ds_read_b64_tr_b16 v[176:177], v156 offset:4096
    ds_read_b64_tr_b16 v[178:179], v157 offset:4352
    ds_read_b64_tr_b16 v[180:181], v156 offset:5120
    ds_read_b64_tr_b16 v[182:183], v157 offset:5376
    ds_read_b64_tr_b16 v[184:185], v156 offset:6144
    ds_read_b64_tr_b16 v[186:187], v157 offset:6400
    ds_read_b64_tr_b16 v[188:189], v156 offset:7168
    ds_read_b64_tr_b16 v[190:191], v157 offset:7424
    s_waitcnt lgkmcnt(14)
    buffer_store_dwordx4 v[160:163], v4, s[52:55], s12 offen offset:0 sc1
    s_waitcnt lgkmcnt(12)
    buffer_store_dwordx4 v[164:167], v4, s[52:55], s12 offen offset:1024 sc1
    s_waitcnt lgkmcnt(10)
    buffer_store_dwordx4 v[168:171], v4, s[52:55], s12 offen offset:2048 sc1
    s_waitcnt lgkmcnt(8)
    buffer_store_dwordx4 v[172:175], v4, s[52:55], s12 offen offset:3072 sc1
    s_waitcnt lgkmcnt(6)
    buffer_store_dwordx4 v[176:179], v4, s[52:55], s13 offen offset:0 sc1
    s_waitcnt lgkmcnt(4)
    buffer_store_dwordx4 v[180:183], v4, s[52:55], s13 offen offset:1024 sc1
    s_waitcnt lgkmcnt(2)
    buffer_store_dwordx4 v[184:187], v4, s[52:55], s13 offen offset:2048 sc1
    s_waitcnt lgkmcnt(0)
    buffer_store_dwordx4 v[188:191], v4, s[52:55], s13 offen offset:3072 sc1
    v_exp_f32 v76, v76
    v_cvt_pk_bf16_f32 v75, v106, v107
    v_exp_f32 v77, v77
    v_mfma_f32_32x32x16_bf16 v[92:107], v[44:47], v[24:27], 0
    v_exp_f32 v78, v78
    v_cvt_pk_bf16_f32 v60, v76, v77
    v_exp_f32 v79, v79
    v_exp_f32 v80, v80
    v_mfma_f32_32x32x16_bf16 v[92:107], v[48:51], v[28:31], v[92:107]
    v_cvt_pk_bf16_f32 v61, v78, v79
    s_barrier
    ds_read_b128 v[44:47], v2 offset:32768
    v_exp_f32 v81, v81
    ds_read_b128 v[48:51], v2 offset:33792
    v_exp_f32 v82, v82
    s_add_u32 m0, s76, 0
    s_nop 0
    buffer_load_dwordx4 v4, s[40:43], s77 offen offset:0 sc1 lds
    v_cvt_pk_bf16_f32 v62, v80, v81
    v_exp_f32 v83, v83
    v_mfma_f32_32x32x16_bf16 v[124:139], v[52:55], v[68:71], v[124:139]
    v_exp_f32 v84, v84
    v_cvt_pk_bf16_f32 v63, v82, v83
    v_exp_f32 v85, v85
    v_exp_f32 v86, v86
    v_mfma_f32_32x32x16_bf16 v[124:139], v[56:59], v[72:75], v[124:139]
    v_cvt_pk_bf16_f32 v64, v84, v85
    ds_read_b128 v[52:55], v2 offset:22528
    v_exp_f32 v87, v87
    ds_read_b128 v[56:59], v2 offset:23552
    v_exp_f32 v88, v88
    v_cvt_pk_bf16_f32 v65, v86, v87
    v_exp_f32 v89, v89
    v_smfmac_f32_16x16x64_bf16 v[40:43], v[32:35], v[68:75], v159
    v_exp_f32 v90, v90
    v_cvt_pk_bf16_f32 v66, v88, v89
    v_exp_f32 v91, v91
    v_exp_f32 v92, v92
    v_cvt_pk_bf16_f32 v67, v90, v91
    v_exp_f32 v93, v93
    s_waitcnt lgkmcnt(2)
    v_mfma_f32_32x32x16_bf16 v[76:91], v[44:47], v[16:19], 0
    v_exp_f32 v94, v94
    s_add_u32 m0, s76, 0
    s_nop 0
    buffer_load_dwordx4 v4, s[40:43], s77 offen offset:1024 sc1 lds
    s_add_u32 s77, s77, 16384
    s_and_b32 s77, s77, 262143
    v_cvt_pk_bf16_f32 v68, v92, v93
    v_exp_f32 v95, v95
    v_exp_f32 v96, v96
    v_mfma_f32_32x32x16_bf16 v[76:91], v[48:51], v[20:23], v[76:91]
    v_cvt_pk_bf16_f32 v69, v94, v95
    v_exp_f32 v97, v97
    v_exp_f32 v98, v98
    v_cvt_pk_bf16_f32 v70, v96, v97
    v_exp_f32 v99, v99
    s_waitcnt lgkmcnt(0)
    v_mfma_f32_32x32x16_bf16 v[108:123], v[52:55], v[60:63], v[108:123]
    v_exp_f32 v100, v100
    v_cvt_pk_bf16_f32 v71, v98, v99
    v_exp_f32 v101, v101
    v_exp_f32 v102, v102
    v_mfma_f32_32x32x16_bf16 v[108:123], v[56:59], v[64:67], v[108:123]
    v_cvt_pk_bf16_f32 v72, v100, v101
    v_exp_f32 v103, v103
    v_exp_f32 v104, v104
    v_cvt_pk_bf16_f32 v73, v102, v103
    v_exp_f32 v105, v105
    v_smfmac_f32_16x16x64_bf16 v[36:39], v[32:35], v[60:67], v159
    v_exp_f32 v106, v106
    v_cvt_pk_bf16_f32 v74, v104, v105
    v_exp_f32 v107, v107
    s_lshl_b32 s6, s4, 2
    s_add_u32 s6, s6, s3
    s_lshl_b32 s6, s6, 5
    s_add_u32 s6, s6, s5
    s_lshl_b32 s6, s6, 3
    s_add_u32 s6, s6, 27394048
    s_waitcnt vmcnt(2)
    v_mov_b32 v144, s26
    v_mov_b32 v145, s27
    v_mov_b32 v146, 0
    s_mov_b64 exec, 1
    buffer_store_dwordx2 v[144:145], v146, s[52:55], s6 offen sc1
    s_mov_b64 exec, -1
    v_exp_f32 v76, v76
    v_cvt_pk_bf16_f32 v75, v106, v107
    v_exp_f32 v77, v77
    v_mfma_f32_32x32x16_bf16 v[92:107], v[44:47], v[24:27], 0
    v_exp_f32 v78, v78
    v_cvt_pk_bf16_f32 v60, v76, v77
    v_exp_f32 v79, v79
    v_exp_f32 v80, v80
    v_mfma_f32_32x32x16_bf16 v[92:107], v[48:51], v[28:31], v[92:107]
    v_cvt_pk_bf16_f32 v61, v78, v79
    ds_read_b128 v[44:47], v2 offset:36864
    v_exp_f32 v81, v81
    ds_read_b128 v[48:51], v2 offset:37888
    v_exp_f32 v82, v82
    v_cvt_pk_bf16_f32 v62, v80, v81
    v_exp_f32 v83, v83
    v_mfma_f32_32x32x16_bf16 v[124:139], v[52:55], v[68:71], v[124:139]
    v_exp_f32 v84, v84
    v_cvt_pk_bf16_f32 v63, v82, v83
    v_exp_f32 v85, v85
    v_exp_f32 v86, v86
    v_mfma_f32_32x32x16_bf16 v[124:139], v[56:59], v[72:75], v[124:139]
    v_cvt_pk_bf16_f32 v64, v84, v85
    ds_read_b128 v[52:55], v2 offset:34816
    v_exp_f32 v87, v87
    ds_read_b128 v[56:59], v2 offset:35840
    v_exp_f32 v88, v88
    v_cvt_pk_bf16_f32 v65, v86, v87
    v_exp_f32 v89, v89
    v_smfmac_f32_16x16x64_bf16 v[40:43], v[32:35], v[68:75], v159
    v_exp_f32 v90, v90
    v_cvt_pk_bf16_f32 v66, v88, v89
    v_exp_f32 v91, v91
    v_exp_f32 v92, v92
    v_cvt_pk_bf16_f32 v67, v90, v91
    v_exp_f32 v93, v93
    s_waitcnt lgkmcnt(2)
    v_mfma_f32_32x32x16_bf16 v[76:91], v[44:47], v[16:19], 0
    v_exp_f32 v94, v94
    v_cvt_pk_bf16_f32 v68, v92, v93
    v_exp_f32 v95, v95
    v_exp_f32 v96, v96
    v_mfma_f32_32x32x16_bf16 v[76:91], v[48:51], v[20:23], v[76:91]
    v_cvt_pk_bf16_f32 v69, v94, v95
    v_exp_f32 v97, v97
    v_exp_f32 v98, v98
    v_cvt_pk_bf16_f32 v70, v96, v97
    v_exp_f32 v99, v99
    s_waitcnt lgkmcnt(0)
    v_mfma_f32_32x32x16_bf16 v[108:123], v[52:55], v[60:63], v[108:123]
    v_exp_f32 v100, v100
    v_cvt_pk_bf16_f32 v71, v98, v99
    v_exp_f32 v101, v101
    v_exp_f32 v102, v102
    v_mfma_f32_32x32x16_bf16 v[108:123], v[56:59], v[64:67], v[108:123]
    v_cvt_pk_bf16_f32 v72, v100, v101
    v_exp_f32 v103, v103
    v_exp_f32 v104, v104
    v_cvt_pk_bf16_f32 v73, v102, v103
    v_exp_f32 v105, v105
    v_smfmac_f32_16x16x64_bf16 v[36:39], v[32:35], v[60:67], v159
    v_exp_f32 v106, v106
    v_cvt_pk_bf16_f32 v74, v104, v105
    v_exp_f32 v107, v107
    s_branch L_join
L_loader:
    s_lshr_b32 s64, s3, 2
    s_and_b32 s65, s3, 3
    s_lshr_b32 s66, s3, 1
    s_and_b32 s67, s3, 1
    v_lshlrev_b32 v4, 4, v0
    s_lshl_b32 s76, s3, 11
    s_lshl_b32 s75, s3, 10
    s_add_u32 s77, s4, 2
    s_and_b32 s77, s77, 7
    s_lshl_b32 s77, s77, 15
    s_add_u32 s77, s77, s76
    s_mov_b32 s78, s76
    s_lshr_b32 s6, s2, 3
    s_and_b32 s7, s6, 3
    s_lshr_b32 s6, s6, 2
    s_lshl_b32 s82, s7, 1
    s_add_u32 s82, s82, s6
    s_and_b32 s82, s82, 7
    s_lshl_b32 s79, s82, 14
    s_lshl_b32 s80, s82, 8
    s_mov_b32 s81, 0
    s_and_b32 s68, s2, 6
    s_lshl_b32 s68, s68, 1
    s_add_u32 s68, s68, s7
    s_and_b32 s69, s2, 1
    s_lshl_b32 s69, s69, 3
    s_add_u32 s69, s69, s6
    s_mov_b32 s79, 0
    s_mov_b32 s80, 0
    v_lshrrev_b32 v144, 3, v0
    s_lshl_b32 s6, s69, 6
    s_lshl_b32 s7, s3, 3
    s_add_u32 s6, s6, s7
    v_add_u32 v145, s6, v144
    v_lshlrev_b32 v145, 11, v145
    v_lshrrev_b32 v146, 4, v0
    s_lshl_b32 s7, s3, 2
    v_add_u32 v146, s7, v146
    v_xor_b32 v146, v146, v0
    v_and_b32 v146, 7, v146
    v_lshl_add_u32 v5, v146, 4, v145
    s_lshl_b32 s7, s3, 4
    v_add_u32 v145, s7, v144
    v_lshlrev_b32 v145, 11, v145
    v_bfe_u32 v146, v0, 4, 1
    v_lshlrev_b32 v146, 2, v146
    v_xor_b32 v146, v146, v0
    v_and_b32 v146, 7, v146
    v_lshl_add_u32 v145, v146, 4, v145
    s_lshl_b32 s7, s69, 7
    v_add_u32 v6, s7, v145
    v_add_u32 v7, 16384, v6
    s_lshl_b32 s6, s68, 2
    s_lshl_b32 s7, s67, 1
    s_add_u32 s6, s6, s7
    s_lshr_b32 s7, s66, 1
    s_add_u32 s70, s6, s7
    s_xor_b32 s7, s70, 1
    s_lshl_b32 s6, s66, 11
    s_lshl_b32 s71, s70, 17
    s_lshl_b32 s72, s7, 17
    s_lshl_b32 s73, s70, 16
    s_lshl_b32 s74, s7, 16
    s_add_u32 s7, s6, 12582912
    s_add_u32 s71, s71, s7
    s_add_u32 s72, s72, s7
    s_add_u32 s7, s6, 20971520
    s_add_u32 s73, s73, s7
    s_add_u32 s74, s74, s7
    v_and_b32 v144, 31, v0
    v_lshrrev_b32 v145, 5, v0
    s_lshr_b32 s6, s66, 1
    s_lshl_b32 s6, s6, 2
    v_add_u32 v146, s6, v145
    v_bfe_u32 v147, v0, 1, 3
    v_xor_b32 v146, v146, v147
    v_lshlrev_b32 v147, 7, v144
    s_and_b32 s6, s66, 1
    s_mul_i32 s6, s6, 12288
    s_add_u32 s6, s6, 65536
    v_add_u32 v147, s6, v147
    v_lshl_add_u32 v8, v146, 4, v147
    v_xor_b32 v9, 32, v8
    v_xor_b32 v10, 4096, v8
    v_xor_b32 v11, 4096, v9
    v_bfe_u32 v146, v0, 2, 2
    v_lshl_add_u32 v146, v145, 2, v146
    s_lshl_b32 s6, s66, 5
    v_add_u32 v146, s6, v146
    v_lshlrev_b32 v146, 7, v146
    v_bfe_u32 v147, v0, 4, 1
    v_lshl_add_u32 v146, v147, 5, v146
    v_and_b32 v147, 3, v0
    v_lshl_add_u32 v146, v147, 3, v146
    v_bfe_u32 v147, v0, 3, 1
    s_and_b32 s6, s66, 1
    v_xor_b32 v147, s6, v147
    v_lshl_add_u32 v12, v147, 6, v146
    v_xor_b32 v13, 64, v12
    s_and_b32 s6, s66, 1
    s_lshl_b32 s6, s6, 5
    s_lshl_b32 s7, s69, 6
    s_add_u32 s6, s6, s7
    v_add_u32 v146, s6, v144
    s_lshl_b32 s6, s70, 5
    v_lshl_add_u32 v148, v145, 2, s6
    v_lshl_add_u32 v14, v148, 10, v146
    v_lshlrev_b32 v14, 2, v14
    s_lshl_b32 s6, s64, 13
    v_add_u32 v2, s6, v4
    v_add_u32 v3, 32768, v2
    s_add_u32 m0, s28, 0
    s_nop 0
    buffer_load_dwordx4 v30, s[48:51], s15 offen lds
    s_add_u32 m0, s28, 4096
    s_nop 0
    buffer_load_dwordx4 v31, s[48:51], s15 offen lds
    s_add_u32 m0, s28, 8192
    s_nop 0
    buffer_load_dwordx4 v32, s[48:51], s15 offen lds
    s_add_u32 m0, s16, 0
    s_nop 0
    buffer_load_dwordx4 v20, s[40:43], s14 offen lds
    s_add_u32 m0, s16, 1024
    s_nop 0
    buffer_load_dwordx4 v21, s[40:43], s14 offen lds
    s_add_u32 m0, s16, 2048
    s_nop 0
    buffer_load_dwordx4 v22, s[40:43], s14 offen lds
    s_add_u32 m0, s16, 3072
    s_nop 0
    buffer_load_dwordx4 v23, s[40:43], s14 offen lds
    s_add_u32 m0, s16, 4096
    s_nop 0
    buffer_load_dwordx4 v24, s[40:43], s14 offen lds
    s_add_u32 m0, s16, 5120
    s_nop 0
    buffer_load_dwordx4 v25, s[40:43], s14 offen lds
    s_add_u32 m0, s16, 6144
    s_nop 0
    buffer_load_dwordx4 v26, s[40:43], s14 offen lds
    s_add_u32 m0, s16, 7168
    s_nop 0
    buffer_load_dwordx4 v27, s[40:43], s14 offen lds
    s_add_u32 m0, s17, 0
    s_nop 0
    buffer_load_dwordx4 v28, s[44:47], s14 offen lds
    s_add_u32 m0, s17, 1024
    s_nop 0
    buffer_load_dwordx4 v29, s[44:47], s14 offen lds
    s_add_u32 s14, s14, 128
    s_and_b32 s14, s14, 2047
    s_mul_i32 s15, s14, 3072
    s_waitcnt vmcnt(13)
    s_barrier
    s_add_u32 m0, s28, 12288
    s_nop 0
    buffer_load_dwordx4 v30, s[48:51], s15 offen lds
    s_add_u32 m0, s28, 16384
    s_nop 0
    buffer_load_dwordx4 v31, s[48:51], s15 offen lds
    s_add_u32 m0, s28, 20480
    s_nop 0
    buffer_load_dwordx4 v32, s[48:51], s15 offen lds
    s_add_u32 m0, s16, 32768
    s_nop 0
    buffer_load_dwordx4 v20, s[40:43], s14 offen lds
    s_add_u32 m0, s16, 33792
    s_nop 0
    buffer_load_dwordx4 v21, s[40:43], s14 offen lds
    s_add_u32 m0, s16, 34816
    s_nop 0
    buffer_load_dwordx4 v22, s[40:43], s14 offen lds
    s_add_u32 m0, s16, 35840
    s_nop 0
    buffer_load_dwordx4 v23, s[40:43], s14 offen lds
    s_add_u32 m0, s16, 36864
    s_nop 0
    buffer_load_dwordx4 v24, s[40:43], s14 offen lds
    s_add_u32 m0, s16, 37888
    s_nop 0
    buffer_load_dwordx4 v25, s[40:43], s14 offen lds
    s_add_u32 m0, s16, 38912
    s_nop 0
    buffer_load_dwordx4 v26, s[40:43], s14 offen lds
    s_add_u32 m0, s16, 39936
    s_nop 0
    buffer_load_dwordx4 v27, s[40:43], s14 offen lds
    s_add_u32 m0, s17, 8192
    s_nop 0
    buffer_load_dwordx4 v28, s[44:47], s14 offen lds
    s_add_u32 m0, s17, 9216
    s_nop 0
    buffer_load_dwordx4 v29, s[44:47], s14 offen lds
    s_add_u32 s14, s14, 128
    s_and_b32 s14, s14, 2047
    s_mul_i32 s15, s14, 3072
    v_and_b32 v1, 31, v0
    s_lshl_b32 s7, s5, 6
    v_lshl_add_u32 v34, v1, 1, s7
    s_mov_b32 s56, s10
    s_mov_b32 s57, s11
    s_mov_b32 s58, 2048
    s_mov_b32 s59, 0x20000
    buffer_load_ushort v40, v34, s[56:59], 0 offen
    s_mov_b32 s56, s12
    s_mov_b32 s57, s13
    s_mov_b32 s58, 2048
    s_mov_b32 s59, 0x20000
    buffer_load_ushort v41, v34, s[56:59], 0 offen
    s_mov_b32 s56, s22
    s_mov_b32 s57, s23
    s_mov_b32 s58, 2048
    s_mov_b32 s59, 0x20000
    buffer_load_ushort v42, v34, s[56:59], 0 offen
    s_mov_b32 s56, s32
    s_mov_b32 s57, s33
    s_mov_b32 s58, 2048
    s_mov_b32 s59, 0x20000
    s_lshl_b32 s7, s5, 3
    s_lshl_b32 s100, s101, 1
    s_add_u32 s100, s100, s7
    s_lshl_b32 s7, s100, 11
    buffer_load_dwordx4 v[64:67], v4, s[40:43], s7 offen
    buffer_load_dwordx4 v[68:71], v4, s[40:43], s7 offen offset:1024
    buffer_load_dwordx4 v[72:75], v4, s[40:43], s7 offen offset:2048
    buffer_load_dwordx4 v[76:79], v4, s[40:43], s7 offen offset:3072
    buffer_load_dwordx4 v[80:83], v4, s[56:59], 0 offen
    buffer_load_dwordx4 v[84:87], v4, s[56:59], 0 offen offset:1024
    s_waitcnt vmcnt(22)
    s_barrier
    s_add_u32 m0, s28, 24576
    s_nop 0
    buffer_load_dwordx4 v30, s[48:51], s15 offen lds
    s_add_u32 m0, s28, 28672
    s_nop 0
    buffer_load_dwordx4 v31, s[48:51], s15 offen lds
    s_add_u32 m0, s28, 32768
    s_nop 0
    buffer_load_dwordx4 v32, s[48:51], s15 offen lds
    s_add_u32 m0, s16, 65536
    s_nop 0
    buffer_load_dwordx4 v20, s[40:43], s14 offen lds
    s_add_u32 m0, s16, 66560
    s_nop 0
    buffer_load_dwordx4 v21, s[40:43], s14 offen lds
    s_add_u32 m0, s16, 67584
    s_nop 0
    buffer_load_dwordx4 v22, s[40:43], s14 offen lds
    s_add_u32 m0, s16, 68608
    s_nop 0
    buffer_load_dwordx4 v23, s[40:43], s14 offen lds
    s_add_u32 m0, s16, 69632
    s_nop 0
    buffer_load_dwordx4 v24, s[40:43], s14 offen lds
    s_add_u32 m0, s16, 70656
    s_nop 0
    buffer_load_dwordx4 v25, s[40:43], s14 offen lds
    s_add_u32 m0, s16, 71680
    s_nop 0
    buffer_load_dwordx4 v26, s[40:43], s14 offen lds
    s_add_u32 m0, s16, 72704
    s_nop 0
    buffer_load_dwordx4 v27, s[40:43], s14 offen lds
    s_add_u32 m0, s17, 16384
    s_nop 0
    buffer_load_dwordx4 v28, s[44:47], s14 offen lds
    s_add_u32 m0, s17, 17408
    s_nop 0
    buffer_load_dwordx4 v29, s[44:47], s14 offen lds
    s_add_u32 s14, s14, 128
    s_and_b32 s14, s14, 2047
    s_mul_i32 s15, s14, 3072
    s_waitcnt vmcnt(13)
    s_barrier
    s_add_u32 m0, s28, 0
    s_nop 0
    buffer_load_dwordx4 v30, s[48:51], s15 offen lds
    s_add_u32 m0, s28, 4096
    s_nop 0
    buffer_load_dwordx4 v31, s[48:51], s15 offen lds
    s_add_u32 m0, s28, 8192
    s_nop 0
    buffer_load_dwordx4 v32, s[48:51], s15 offen lds
    s_add_u32 m0, s16, 0
    s_nop 0
    buffer_load_dwordx4 v20, s[40:43], s14 offen lds
    s_add_u32 m0, s16, 1024
    s_nop 0
    buffer_load_dwordx4 v21, s[40:43], s14 offen lds
    s_add_u32 m0, s16, 2048
    s_nop 0
    buffer_load_dwordx4 v22, s[40:43], s14 offen lds
    s_add_u32 m0, s16, 3072
    s_nop 0
    buffer_load_dwordx4 v23, s[40:43], s14 offen lds
    s_add_u32 m0, s16, 4096
    s_nop 0
    buffer_load_dwordx4 v24, s[40:43], s14 offen lds
    s_add_u32 m0, s16, 5120
    s_nop 0
    buffer_load_dwordx4 v25, s[40:43], s14 offen lds
    s_add_u32 m0, s16, 6144
    s_nop 0
    buffer_load_dwordx4 v26, s[40:43], s14 offen lds
    s_add_u32 m0, s16, 7168
    s_nop 0
    buffer_load_dwordx4 v27, s[40:43], s14 offen lds
    s_add_u32 m0, s17, 0
    s_nop 0
    buffer_load_dwordx4 v28, s[44:47], s14 offen lds
    s_add_u32 m0, s17, 1024
    s_nop 0
    buffer_load_dwordx4 v29, s[44:47], s14 offen lds
    s_add_u32 s14, s14, 128
    s_and_b32 s14, s14, 2047
    s_mul_i32 s15, s14, 3072
    v_lshlrev_b32 v40, 16, v40
    v_lshlrev_b32 v41, 16, v41
    v_lshlrev_b32 v42, 16, v42
    v_mul_f32 v42, 0x3fb8aa3b, v42
    v_exp_f32 v42, v42
    s_nop 0
    v_cvt_pk_bf16_f32 v42, v42, v42
    v_lshlrev_b32 v42, 16, v42
    v_mul_f32 v43, v42, v40
    v_mul_f32 v52, v42, v41
    v_mul_f32 v43, 0x3fb8aa3b, v43
    v_exp_f32 v43, v43
    v_mul_f32 v52, 0.15915494, v52
    v_rndne_f32 v53, v52
    v_sub_f32 v52, v52, v53
    v_cos_f32 v160, v52
    v_sin_f32 v161, v52
    v_mul_f32 v53, v40, v40
    v_fmac_f32 v53, v41, v41
    v_rcp_f32 v53, v53
    v_mul_f32 v160, v43, v160
    v_mul_f32 v161, v43, v161
    v_add_f32 v53, v53, v53
    v_add_f32 v54, -1.0, v160
    v_mul_f32 v162, v54, v40
    v_fmac_f32 v162, v161, v41
    v_mul_f32 v163, v161, v40
    v_fma_f32 v163, -v54, v41, v163
    v_mul_f32 v162, v162, v53
    v_mul_f32 v163, v163, v53
    v_lshlrev_b32 v35, 4, v1
    v_add_u32 v35, 161792, v35
    ds_write_b128 v35, v[160:163]
    v_mov_b32 v164, v160
    v_mov_b32 v165, v161
    v_mul_f32 v53, v165, v165
    v_mul_f32 v165, v164, v165
    v_fma_f32 v164, v164, v164, -v53
    v_add_f32 v165, v165, v165
    v_mul_f32 v53, v165, v165
    v_mul_f32 v165, v164, v165
    v_fma_f32 v164, v164, v164, -v53
    v_add_f32 v165, v165, v165
    v_mul_f32 v53, v165, v165
    v_mul_f32 v165, v164, v165
    v_fma_f32 v164, v164, v164, -v53
    v_add_f32 v165, v165, v165
    v_mul_f32 v53, v165, v165
    v_mul_f32 v165, v164, v165
    v_fma_f32 v164, v164, v164, -v53
    v_add_f32 v165, v165, v165
    v_mul_f32 v53, v165, v165
    v_mul_f32 v165, v164, v165
    v_fma_f32 v164, v164, v164, -v53
    v_add_f32 v165, v165, v165
    v_mov_b32 v166, v164
    v_mov_b32 v167, v165
    v_mul_f32 v53, v167, v167
    v_mul_f32 v167, v166, v167
    v_fma_f32 v166, v166, v166, -v53
    v_add_f32 v167, v167, v167
    v_mul_f32 v53, v167, v167
    v_mul_f32 v167, v166, v167
    v_fma_f32 v166, v166, v166, -v53
    v_add_f32 v167, v167, v167
    v_cmp_lt_u32 vcc, 31, v0
    v_mov_b32 v54, 1.0
    v_mov_b32 v55, 0
    v_cndmask_b32 v54, v54, v166, vcc
    v_cndmask_b32 v55, v55, v167, vcc
    v_mul_f32 v240, v162, v54
    v_mul_f32 v241, v162, v55
    v_fma_f32 v240, -v163, v55, v240
    v_fmac_f32 v241, v163, v54
    v_mul_f32 v242, v240, v164
    v_mul_f32 v243, v240, v165
    v_fma_f32 v242, -v241, v165, v242
    v_fmac_f32 v243, v241, v164
    v_mul_f32 v244, v242, v164
    v_mul_f32 v245, v242, v165
    v_fma_f32 v244, -v243, v165, v244
    v_fmac_f32 v245, v243, v164
    v_mul_f32 v246, v244, v164
    v_mul_f32 v247, v244, v165
    v_fma_f32 v246, -v245, v165, v246
    v_fmac_f32 v247, v245, v164
    v_mul_f32 v53, v167, v167
    v_mul_f32 v167, v166, v167
    v_fma_f32 v166, v166, v166, -v53
    v_add_f32 v167, v167, v167
    s_mov_b32 s7, 0xffff0000
    v_mov_b32 v60, 0
    v_mov_b32 v61, 0
    v_lshlrev_b32 v54, 16, v80
    v_and_b32 v55, s7, v80
    v_lshlrev_b32 v56, 16, v64
    v_and_b32 v57, s7, v64
    v_mul_f32 v56, v56, v54
    v_mul_f32 v57, v57, v55
    v_cvt_pk_bf16_f32 v56, v56, v57
    v_and_b32 v57, s7, v56
    v_lshlrev_b32 v56, 16, v56
    v_add_f32 v60, v60, v57
    v_add_f32 v60, v60, v56
    v_lshlrev_b32 v56, 16, v72
    v_and_b32 v57, s7, v72
    v_mul_f32 v56, v56, v54
    v_mul_f32 v57, v57, v55
    v_cvt_pk_bf16_f32 v56, v56, v57
    v_and_b32 v57, s7, v56
    v_lshlrev_b32 v56, 16, v56
    v_add_f32 v61, v61, v57
    v_add_f32 v61, v61, v56
    v_lshlrev_b32 v54, 16, v81
    v_and_b32 v55, s7, v81
    v_lshlrev_b32 v56, 16, v65
    v_and_b32 v57, s7, v65
    v_mul_f32 v56, v56, v54
    v_mul_f32 v57, v57, v55
    v_cvt_pk_bf16_f32 v56, v56, v57
    v_and_b32 v57, s7, v56
    v_lshlrev_b32 v56, 16, v56
    v_add_f32 v60, v60, v57
    v_add_f32 v60, v60, v56
    v_lshlrev_b32 v56, 16, v73
    v_and_b32 v57, s7, v73
    v_mul_f32 v56, v56, v54
    v_mul_f32 v57, v57, v55
    v_cvt_pk_bf16_f32 v56, v56, v57
    v_and_b32 v57, s7, v56
    v_lshlrev_b32 v56, 16, v56
    v_add_f32 v61, v61, v57
    v_add_f32 v61, v61, v56
    v_lshlrev_b32 v54, 16, v82
    v_and_b32 v55, s7, v82
    v_lshlrev_b32 v56, 16, v66
    v_and_b32 v57, s7, v66
    v_mul_f32 v56, v56, v54
    v_mul_f32 v57, v57, v55
    v_cvt_pk_bf16_f32 v56, v56, v57
    v_and_b32 v57, s7, v56
    v_lshlrev_b32 v56, 16, v56
    v_add_f32 v60, v60, v57
    v_add_f32 v60, v60, v56
    v_lshlrev_b32 v56, 16, v74
    v_and_b32 v57, s7, v74
    v_mul_f32 v56, v56, v54
    v_mul_f32 v57, v57, v55
    v_cvt_pk_bf16_f32 v56, v56, v57
    v_and_b32 v57, s7, v56
    v_lshlrev_b32 v56, 16, v56
    v_add_f32 v61, v61, v57
    v_add_f32 v61, v61, v56
    s_waitcnt vmcnt(13)
    s_barrier
    s_add_u32 m0, s28, 12288
    s_nop 0
    buffer_load_dwordx4 v30, s[48:51], s15 offen lds
    s_add_u32 m0, s28, 16384
    s_nop 0
    buffer_load_dwordx4 v31, s[48:51], s15 offen lds
    s_add_u32 m0, s28, 20480
    s_nop 0
    buffer_load_dwordx4 v32, s[48:51], s15 offen lds
    s_add_u32 m0, s16, 32768
    s_nop 0
    buffer_load_dwordx4 v20, s[40:43], s14 offen lds
    s_add_u32 m0, s16, 33792
    s_nop 0
    buffer_load_dwordx4 v21, s[40:43], s14 offen lds
    s_add_u32 m0, s16, 34816
    s_nop 0
    buffer_load_dwordx4 v22, s[40:43], s14 offen lds
    s_add_u32 m0, s16, 35840
    s_nop 0
    buffer_load_dwordx4 v23, s[40:43], s14 offen lds
    s_add_u32 m0, s16, 36864
    s_nop 0
    buffer_load_dwordx4 v24, s[40:43], s14 offen lds
    s_add_u32 m0, s16, 37888
    s_nop 0
    buffer_load_dwordx4 v25, s[40:43], s14 offen lds
    s_add_u32 m0, s16, 38912
    s_nop 0
    buffer_load_dwordx4 v26, s[40:43], s14 offen lds
    s_add_u32 m0, s16, 39936
    s_nop 0
    buffer_load_dwordx4 v27, s[40:43], s14 offen lds
    s_add_u32 m0, s17, 8192
    s_nop 0
    buffer_load_dwordx4 v28, s[44:47], s14 offen lds
    s_add_u32 m0, s17, 9216
    s_nop 0
    buffer_load_dwordx4 v29, s[44:47], s14 offen lds
    s_add_u32 s14, s14, 128
    s_and_b32 s14, s14, 2047
    s_mul_i32 s15, s14, 3072
    v_lshlrev_b32 v54, 16, v83
    v_and_b32 v55, s7, v83
    v_lshlrev_b32 v56, 16, v67
    v_and_b32 v57, s7, v67
    v_mul_f32 v56, v56, v54
    v_mul_f32 v57, v57, v55
    v_cvt_pk_bf16_f32 v56, v56, v57
    v_and_b32 v57, s7, v56
    v_lshlrev_b32 v56, 16, v56
    v_add_f32 v60, v60, v57
    v_add_f32 v60, v60, v56
    v_lshlrev_b32 v56, 16, v75
    v_and_b32 v57, s7, v75
    v_mul_f32 v56, v56, v54
    v_mul_f32 v57, v57, v55
    v_cvt_pk_bf16_f32 v56, v56, v57
    v_and_b32 v57, s7, v56
    v_lshlrev_b32 v56, 16, v56
    v_add_f32 v61, v61, v57
    v_add_f32 v61, v61, v56
    v_lshlrev_b32 v54, 16, v84
    v_and_b32 v55, s7, v84
    v_lshlrev_b32 v56, 16, v68
    v_and_b32 v57, s7, v68
    v_mul_f32 v56, v56, v54
    v_mul_f32 v57, v57, v55
    v_cvt_pk_bf16_f32 v56, v56, v57
    v_and_b32 v57, s7, v56
    v_lshlrev_b32 v56, 16, v56
    v_add_f32 v60, v60, v57
    v_add_f32 v60, v60, v56
    v_lshlrev_b32 v56, 16, v76
    v_and_b32 v57, s7, v76
    v_mul_f32 v56, v56, v54
    v_mul_f32 v57, v57, v55
    v_cvt_pk_bf16_f32 v56, v56, v57
    v_and_b32 v57, s7, v56
    v_lshlrev_b32 v56, 16, v56
    v_add_f32 v61, v61, v57
    v_add_f32 v61, v61, v56
    v_lshlrev_b32 v54, 16, v85
    v_and_b32 v55, s7, v85
    v_lshlrev_b32 v56, 16, v69
    v_and_b32 v57, s7, v69
    v_mul_f32 v56, v56, v54
    v_mul_f32 v57, v57, v55
    v_cvt_pk_bf16_f32 v56, v56, v57
    v_and_b32 v57, s7, v56
    v_lshlrev_b32 v56, 16, v56
    v_add_f32 v60, v60, v57
    v_add_f32 v60, v60, v56
    v_lshlrev_b32 v56, 16, v77
    v_and_b32 v57, s7, v77
    v_mul_f32 v56, v56, v54
    v_mul_f32 v57, v57, v55
    v_cvt_pk_bf16_f32 v56, v56, v57
    v_and_b32 v57, s7, v56
    v_lshlrev_b32 v56, 16, v56
    v_add_f32 v61, v61, v57
    v_add_f32 v61, v61, v56
    v_lshlrev_b32 v54, 16, v86
    v_and_b32 v55, s7, v86
    v_lshlrev_b32 v56, 16, v70
    v_and_b32 v57, s7, v70
    v_mul_f32 v56, v56, v54
    v_mul_f32 v57, v57, v55
    v_cvt_pk_bf16_f32 v56, v56, v57
    v_and_b32 v57, s7, v56
    v_lshlrev_b32 v56, 16, v56
    v_add_f32 v60, v60, v57
    v_add_f32 v60, v60, v56
    v_lshlrev_b32 v56, 16, v78
    v_and_b32 v57, s7, v78
    v_mul_f32 v56, v56, v54
    v_mul_f32 v57, v57, v55
    v_cvt_pk_bf16_f32 v56, v56, v57
    v_and_b32 v57, s7, v56
    v_lshlrev_b32 v56, 16, v56
    v_add_f32 v61, v61, v57
    v_add_f32 v61, v61, v56
    v_lshlrev_b32 v54, 16, v87
    v_and_b32 v55, s7, v87
    v_lshlrev_b32 v56, 16, v71
    v_and_b32 v57, s7, v71
    v_mul_f32 v56, v56, v54
    v_mul_f32 v57, v57, v55
    v_cvt_pk_bf16_f32 v56, v56, v57
    v_and_b32 v57, s7, v56
    v_lshlrev_b32 v56, 16, v56
    v_add_f32 v60, v60, v57
    v_add_f32 v60, v60, v56
    v_lshlrev_b32 v56, 16, v79
    v_and_b32 v57, s7, v79
    v_mul_f32 v56, v56, v54
    v_mul_f32 v57, v57, v55
    v_cvt_pk_bf16_f32 v56, v56, v57
    v_and_b32 v57, s7, v56
    v_lshlrev_b32 v56, 16, v56
    v_add_f32 v61, v61, v57
    v_add_f32 v61, v61, v56
    s_nop 1
    v_add_f32_dpp v60, v60, v60 quad_perm:[1,0,3,2] row_mask:0xf bank_mask:0xf
    v_add_f32_dpp v61, v61, v61 quad_perm:[1,0,3,2] row_mask:0xf bank_mask:0xf
    s_nop 1
    v_add_f32_dpp v60, v60, v60 quad_perm:[2,3,0,1] row_mask:0xf bank_mask:0xf
    v_add_f32_dpp v61, v61, v61 quad_perm:[2,3,0,1] row_mask:0xf bank_mask:0xf
    s_nop 1
    v_add_f32_dpp v60, v60, v60 row_half_mirror row_mask:0xf bank_mask:0xf
    v_add_f32_dpp v61, v61, v61 row_half_mirror row_mask:0xf bank_mask:0xf
    s_nop 1
    v_add_f32_dpp v60, v60, v60 row_mirror row_mask:0xf bank_mask:0xf
    v_add_f32_dpp v61, v61, v61 row_mirror row_mask:0xf bank_mask:0xf
    v_mov_b32 v62, v60
    v_mov_b32 v63, v61
    s_nop 1
    v_permlane16_swap_b32 v60, v62
    v_permlane16_swap_b32 v61, v63
    s_nop 1
    v_add_f32 v60, v60, v62
    v_add_f32 v61, v61, v63
    v_mov_b32 v62, v60
    v_mov_b32 v63, v61
    s_nop 1
    v_permlane32_swap_b32 v60, v62
    v_permlane32_swap_b32 v61, v63
    s_nop 1
    v_add_f32 v60, v60, v62
    v_add_f32 v61, v61, v63
    v_cvt_pk_bf16_f32 v60, v60, v61
    v_and_b32 v61, s7, v60
    v_lshlrev_b32 v60, 16, v60
    v_mul_f32 v60, 0xbfb8aa3b, v60
    v_mul_f32 v61, 0xbfb8aa3b, v61
    v_exp_f32 v60, v60
    v_exp_f32 v61, v61
    s_nop 0
    v_add_f32 v60, 1.0, v60
    v_add_f32 v61, 1.0, v61
    v_rcp_f32 v60, v60
    v_rcp_f32 v61, v61
    s_nop 0
    v_cvt_pk_bf16_f32 v60, v60, v61
    v_and_b32 v61, s7, v60
    v_lshlrev_b32 v60, 16, v60
    s_lshl_b32 s7, s4, 8
    s_add_u32 s7, s7, s100
    s_lshl_b32 s7, s7, 2
    s_add_u32 s7, s7, 25165824
    v_mov_b32 v1, 0
    s_mov_b64 exec, 1
    buffer_store_dwordx2 v[60:61], v1, s[52:55], s7 offen sc1
    s_mov_b64 exec, -1
    s_waitcnt vmcnt(14) lgkmcnt(0)
    s_mov_b32 s29, 3
    s_branch L_p1_lmid
L_p1_lloop:
    s_waitcnt vmcnt(13)
L_p1_lmid:
    s_barrier
    s_add_u32 m0, s28, 24576
    s_nop 0
    buffer_load_dwordx4 v30, s[48:51], s15 offen lds
    s_add_u32 m0, s28, 28672
    s_nop 0
    buffer_load_dwordx4 v31, s[48:51], s15 offen lds
    s_add_u32 m0, s28, 32768
    s_nop 0
    buffer_load_dwordx4 v32, s[48:51], s15 offen lds
    s_add_u32 m0, s16, 65536
    s_nop 0
    buffer_load_dwordx4 v20, s[40:43], s14 offen lds
    s_add_u32 m0, s16, 66560
    s_nop 0
    buffer_load_dwordx4 v21, s[40:43], s14 offen lds
    s_add_u32 m0, s16, 67584
    s_nop 0
    buffer_load_dwordx4 v22, s[40:43], s14 offen lds
    s_add_u32 m0, s16, 68608
    s_nop 0
    buffer_load_dwordx4 v23, s[40:43], s14 offen lds
    s_add_u32 m0, s16, 69632
    s_nop 0
    buffer_load_dwordx4 v24, s[40:43], s14 offen lds
    s_add_u32 m0, s16, 70656
    s_nop 0
    buffer_load_dwordx4 v25, s[40:43], s14 offen lds
    s_add_u32 m0, s16, 71680
    s_nop 0
    buffer_load_dwordx4 v26, s[40:43], s14 offen lds
    s_add_u32 m0, s16, 72704
    s_nop 0
    buffer_load_dwordx4 v27, s[40:43], s14 offen lds
    s_add_u32 m0, s17, 16384
    s_nop 0
    buffer_load_dwordx4 v28, s[44:47], s14 offen lds
    s_add_u32 m0, s17, 17408
    s_nop 0
    buffer_load_dwordx4 v29, s[44:47], s14 offen lds
    s_add_u32 s14, s14, 128
    s_and_b32 s14, s14, 2047
    s_mul_i32 s15, s14, 3072
    s_waitcnt vmcnt(13)
    s_barrier
    s_add_u32 m0, s28, 0
    s_nop 0
    buffer_load_dwordx4 v30, s[48:51], s15 offen lds
    s_add_u32 m0, s28, 4096
    s_nop 0
    buffer_load_dwordx4 v31, s[48:51], s15 offen lds
    s_add_u32 m0, s28, 8192
    s_nop 0
    buffer_load_dwordx4 v32, s[48:51], s15 offen lds
    s_add_u32 m0, s16, 0
    s_nop 0
    buffer_load_dwordx4 v20, s[40:43], s14 offen lds
    s_add_u32 m0, s16, 1024
    s_nop 0
    buffer_load_dwordx4 v21, s[40:43], s14 offen lds
    s_add_u32 m0, s16, 2048
    s_nop 0
    buffer_load_dwordx4 v22, s[40:43], s14 offen lds
    s_add_u32 m0, s16, 3072
    s_nop 0
    buffer_load_dwordx4 v23, s[40:43], s14 offen lds
    s_add_u32 m0, s16, 4096
    s_nop 0
    buffer_load_dwordx4 v24, s[40:43], s14 offen lds
    s_add_u32 m0, s16, 5120
    s_nop 0
    buffer_load_dwordx4 v25, s[40:43], s14 offen lds
    s_add_u32 m0, s16, 6144
    s_nop 0
    buffer_load_dwordx4 v26, s[40:43], s14 offen lds
    s_add_u32 m0, s16, 7168
    s_nop 0
    buffer_load_dwordx4 v27, s[40:43], s14 offen lds
    s_add_u32 m0, s17, 0
    s_nop 0
    buffer_load_dwordx4 v28, s[44:47], s14 offen lds
    s_add_u32 m0, s17, 1024
    s_nop 0
    buffer_load_dwordx4 v29, s[44:47], s14 offen lds
    s_add_u32 s14, s14, 128
    s_and_b32 s14, s14, 2047
    s_mul_i32 s15, s14, 3072
    s_waitcnt vmcnt(13)
    s_barrier
    s_add_u32 m0, s28, 12288
    s_nop 0
    buffer_load_dwordx4 v30, s[48:51], s15 offen lds
    s_add_u32 m0, s28, 16384
    s_nop 0
    buffer_load_dwordx4 v31, s[48:51], s15 offen lds
    s_add_u32 m0, s28, 20480
    s_nop 0
    buffer_load_dwordx4 v32, s[48:51], s15 offen lds
    s_add_u32 m0, s16, 32768
    s_nop 0
    buffer_load_dwordx4 v20, s[40:43], s14 offen lds
    s_add_u32 m0, s16, 33792
    s_nop 0
    buffer_load_dwordx4 v21, s[40:43], s14 offen lds
    s_add_u32 m0, s16, 34816
    s_nop 0
    buffer_load_dwordx4 v22, s[40:43], s14 offen lds
    s_add_u32 m0, s16, 35840
    s_nop 0
    buffer_load_dwordx4 v23, s[40:43], s14 offen lds
    s_add_u32 m0, s16, 36864
    s_nop 0
    buffer_load_dwordx4 v24, s[40:43], s14 offen lds
    s_add_u32 m0, s16, 37888
    s_nop 0
    buffer_load_dwordx4 v25, s[40:43], s14 offen lds
    s_add_u32 m0, s16, 38912
    s_nop 0
    buffer_load_dwordx4 v26, s[40:43], s14 offen lds
    s_add_u32 m0, s16, 39936
    s_nop 0
    buffer_load_dwordx4 v27, s[40:43], s14 offen lds
    s_add_u32 m0, s17, 8192
    s_nop 0
    buffer_load_dwordx4 v28, s[44:47], s14 offen lds
    s_add_u32 m0, s17, 9216
    s_nop 0
    buffer_load_dwordx4 v29, s[44:47], s14 offen lds
    s_add_u32 s14, s14, 128
    s_and_b32 s14, s14, 2047
    s_mul_i32 s15, s14, 3072
    s_sub_u32 s29, s29, 1
    s_cmp_lg_u32 s29, 0
    s_cbranch_scc1 L_p1_lloop
    s_waitcnt vmcnt(13)
    s_barrier
    s_add_u32 m0, s28, 24576
    s_nop 0
    buffer_load_dwordx4 v30, s[48:51], s15 offen lds
    s_add_u32 m0, s28, 28672
    s_nop 0
    buffer_load_dwordx4 v31, s[48:51], s15 offen lds
    s_add_u32 m0, s28, 32768
    s_nop 0
    buffer_load_dwordx4 v32, s[48:51], s15 offen lds
    s_add_u32 m0, s16, 65536
    s_nop 0
    buffer_load_dwordx4 v20, s[40:43], s14 offen lds
    s_add_u32 m0, s16, 66560
    s_nop 0
    buffer_load_dwordx4 v21, s[40:43], s14 offen lds
    s_add_u32 m0, s16, 67584
    s_nop 0
    buffer_load_dwordx4 v22, s[40:43], s14 offen lds
    s_add_u32 m0, s16, 68608
    s_nop 0
    buffer_load_dwordx4 v23, s[40:43], s14 offen lds
    s_add_u32 m0, s16, 69632
    s_nop 0
    buffer_load_dwordx4 v24, s[40:43], s14 offen lds
    s_add_u32 m0, s16, 70656
    s_nop 0
    buffer_load_dwordx4 v25, s[40:43], s14 offen lds
    s_add_u32 m0, s16, 71680
    s_nop 0
    buffer_load_dwordx4 v26, s[40:43], s14 offen lds
    s_add_u32 m0, s16, 72704
    s_nop 0
    buffer_load_dwordx4 v27, s[40:43], s14 offen lds
    s_add_u32 m0, s17, 16384
    s_nop 0
    buffer_load_dwordx4 v28, s[44:47], s14 offen lds
    s_add_u32 m0, s17, 17408
    s_nop 0
    buffer_load_dwordx4 v29, s[44:47], s14 offen lds
    s_add_u32 s14, s14, 128
    s_and_b32 s14, s14, 2047
    s_mul_i32 s15, s14, 3072
    s_mov_b32 s60, s36
    s_mov_b32 s61, s37
    s_mov_b32 s62, 256
    s_mov_b32 s63, 0x20000
    buffer_load_dwordx2 v[88:89], v1, s[60:63], 0 offen sc1
    s_lshl_b32 s6, s5, 18
    s_add_u32 s6, s6, 4194304
    s_add_u32 s40, s38, s6
    s_addc_u32 s41, s39, 0
    s_mov_b32 s42, 262144
    s_mov_b32 s43, 0x20000
    s_mov_b32 s44, s18
    s_mov_b32 s45, s19
    s_mov_b32 s46, 2097152
    s_mov_b32 s47, 0x20000
    s_mov_b32 s48, s20
    s_mov_b32 s49, s21
    s_mov_b32 s50, 2097152
    s_mov_b32 s51, 0x20000
    s_mov_b32 s56, s30
    s_mov_b32 s57, s31
    s_mov_b32 s58, 2097152
    s_mov_b32 s59, 0x20000
    v_and_b32 v62, 1, v0
    v_cmp_eq_u32 vcc, 0, v62
    v_mov_b32 v62, 0xeeeeeeee
    v_mov_b32 v63, 0x44444444
    v_cndmask_b32 v159, v62, v63, vcc
    v_and_b32 v62, 6, v0
    v_mov_b32 v63, 0x3f803f80
    v_cmp_eq_u32 vcc, 0, v62
    v_cndmask_b32 v32, 0, v63, vcc
    v_cmp_eq_u32 vcc, 4, v62
    v_cndmask_b32 v34, 0, v63, vcc
    v_mov_b32 v33, v32
    v_mov_b32 v35, v34
    v_mov_b32 v36, 0
    v_mov_b32 v37, 0
    v_mov_b32 v38, 0
    v_mov_b32 v39, 0
    v_mov_b32 v40, 0
    v_mov_b32 v41, 0
    v_mov_b32 v42, 0
    v_mov_b32 v43, 0
    s_waitcnt vmcnt(14)
    s_barrier
    s_waitcnt vmcnt(0)
    s_barrier
    s_mov_b32 s83, 0
L_ln:
    v_readfirstlane_b32 s26, v88
    v_readfirstlane_b32 s27, v89
    s_add_u32 s83, s83, 1
    s_cmp_lg_u32 s26, 0
    s_cbranch_scc1 L_lnk
    s_cmp_ge_u32 s83, 65536
    s_cbranch_scc1 L_lnk
    buffer_load_dwordx2 v[88:89], v1, s[60:63], 0 offen sc1
    s_waitcnt vmcnt(0)
    s_branch L_ln
L_lnk:
    s_barrier
    s_lshl_b32 s6, s65, 12
    s_add_u32 s6, s6, 98304
    v_add_u32 v144, s6, v4
    ds_read_b128 v[16:19], v144 offset:2048
    ds_read_b128 v[20:23], v144 offset:3072
    ds_read_b128 v[24:27], v144 offset:0
    ds_read_b128 v[28:31], v144 offset:1024
    ds_read_b128 v[44:47], v2
    ds_read_b128 v[48:51], v2 offset:1024
    s_waitcnt lgkmcnt(0)
    v_mfma_f32_32x32x16_bf16 v[76:91], v[44:47], v[16:19], 0
    v_mfma_f32_32x32x16_bf16 v[76:91], v[48:51], v[20:23], v[76:91]
    s_lshl_b32 s12, s5, 13
    s_add_u32 s12, s12, 26214400
    s_add_u32 s13, s12, 4096
    v_and_b32 v190, 31, v0
    v_lshlrev_b32 v191, 3, v190
    v_lshlrev_b32 v190, 4, v190
    s_cmp_lg_u32 s3, 4
    s_cbranch_scc1 L_h1skip
    s_setprio 3
    v_add_u32 v144, 159744, v191
    ds_read_b64 v[168:169], v144 offset:0
    ds_read_b64 v[170:171], v144 offset:256
    ds_read_b64 v[172:173], v144 offset:512
    ds_read_b64 v[174:175], v144 offset:768
    ds_read_b64 v[176:177], v144 offset:1024
    ds_read_b64 v[178:179], v144 offset:1280
    ds_read_b64 v[180:181], v144 offset:1536
    ds_read_b64 v[182:183], v144 offset:1792
    v_sub_f32 v186, 0, v165
    v_sub_f32 v187, 0, v167
    v_sub_f32 v188, 0, v162
    v_sub_f32 v189, 0, v163
    s_waitcnt lgkmcnt(0)
    v_fmac_f32 v170, v164, v168
    v_fmac_f32 v171, v164, v169
    v_fmac_f32 v170, v186, v169
    v_fmac_f32 v171, v165, v168
    v_fmac_f32 v172, v164, v170
    v_fmac_f32 v173, v164, v171
    v_fmac_f32 v172, v186, v171
    v_fmac_f32 v173, v165, v170
    v_fmac_f32 v174, v164, v172
    v_fmac_f32 v175, v164, v173
    v_fmac_f32 v174, v186, v173
    v_fmac_f32 v175, v165, v172
    v_fmac_f32 v176, v164, v174
    v_fmac_f32 v177, v164, v175
    v_fmac_f32 v176, v186, v175
    v_fmac_f32 v177, v165, v174
    v_fmac_f32 v178, v164, v176
    v_fmac_f32 v179, v164, v177
    v_fmac_f32 v178, v186, v177
    v_fmac_f32 v179, v165, v176
    v_fmac_f32 v180, v164, v178
    v_fmac_f32 v181, v164, v179
    v_fmac_f32 v180, v186, v179
    v_fmac_f32 v181, v165, v178
    v_fmac_f32 v182, v164, v180
    v_fmac_f32 v183, v164, v181
    v_fmac_f32 v182, v186, v181
    v_fmac_f32 v183, v165, v180
    v_mov_b32 v144, v182
    v_mov_b32 v145, s26
    v_mov_b32 v146, v183
    v_mov_b32 v147, s26
    s_lshl_b32 s7, s4, 10
    s_add_u32 s7, s7, s12
    buffer_store_dwordx4 v[144:147], v190, s[52:55], s7 offen sc1
    v_cmp_lt_u32 vcc, 31, v0
    v_cndmask_b32 v232, 0, v174, vcc
    v_cndmask_b32 v233, 0, v175, vcc
    v_cndmask_b32 v234, v168, v176, vcc
    v_cndmask_b32 v235, v169, v177, vcc
    v_cndmask_b32 v236, v170, v178, vcc
    v_cndmask_b32 v237, v171, v179, vcc
    v_cndmask_b32 v238, v172, v180, vcc
    v_cndmask_b32 v239, v173, v181, vcc
    v_mul_f32 v224, v162, v232
    v_mul_f32 v225, v188, v233
    v_fmac_f32 v224, v189, v233
    v_fmac_f32 v225, v189, v232
    v_mul_f32 v226, v162, v234
    v_mul_f32 v227, v188, v235
    v_fmac_f32 v226, v189, v235
    v_fmac_f32 v227, v189, v234
    v_mul_f32 v228, v162, v236
    v_mul_f32 v229, v188, v237
    v_fmac_f32 v228, v189, v237
    v_fmac_f32 v229, v189, v236
    v_mul_f32 v230, v162, v238
    v_mul_f32 v231, v188, v239
    v_fmac_f32 v230, v189, v239
    v_fmac_f32 v231, v189, v238
    v_lshrrev_b32 v232, 5, v0
    v_lshl_add_u32 v232, v232, 10, v191
    v_add_u32 v232, 151552, v232
L_h1skip:
    s_lshl_b32 s14, s5, 8
    s_add_u32 s14, s14, 27328512
    s_add_u32 s15, s4, 1
    s_and_b32 s15, s15, 7
    v_bfe_u32 v148, v0, 2, 3
    v_cmp_eq_u32 s[10:11], s15, v148
    s_nop 7
    v_exp_f32 v76, v76
    v_exp_f32 v77, v77
    v_mfma_f32_32x32x16_bf16 v[92:107], v[44:47], v[24:27], 0
    v_exp_f32 v78, v78
    v_cvt_pk_bf16_f32 v60, v76, v77
    v_exp_f32 v79, v79
    v_exp_f32 v80, v80
    v_mfma_f32_32x32x16_bf16 v[92:107], v[48:51], v[28:31], v[92:107]
    v_cvt_pk_bf16_f32 v61, v78, v79
    ds_read_b128 v[44:47], v2 offset:4096
    v_exp_f32 v81, v81
    ds_read_b128 v[48:51], v2 offset:5120
    v_exp_f32 v82, v82
    v_cvt_pk_bf16_f32 v62, v80, v81
    v_exp_f32 v83, v83
    v_exp_f32 v84, v84
    v_cvt_pk_bf16_f32 v63, v82, v83
    v_exp_f32 v85, v85
    v_exp_f32 v86, v86
    v_cvt_pk_bf16_f32 v64, v84, v85
    ds_read_b128 v[52:55], v2 offset:2048
    v_exp_f32 v87, v87
    ds_read_b128 v[56:59], v2 offset:3072
    v_exp_f32 v88, v88
    v_cvt_pk_bf16_f32 v65, v86, v87
    v_exp_f32 v89, v89
    v_exp_f32 v90, v90
    v_cvt_pk_bf16_f32 v66, v88, v89
    v_exp_f32 v91, v91
    buffer_load_dwordx2 v[148:149], v191, s[52:55], s14 offen sc1
    v_exp_f32 v92, v92
    v_cvt_pk_bf16_f32 v67, v90, v91
    v_exp_f32 v93, v93
    s_waitcnt lgkmcnt(2)
    v_mfma_f32_32x32x16_bf16 v[76:91], v[44:47], v[16:19], 0
    v_exp_f32 v94, v94
    v_cvt_pk_bf16_f32 v68, v92, v93
    v_exp_f32 v95, v95
    v_exp_f32 v96, v96
    v_mfma_f32_32x32x16_bf16 v[76:91], v[48:51], v[20:23], v[76:91]
    v_cvt_pk_bf16_f32 v69, v94, v95
    v_exp_f32 v97, v97
    v_exp_f32 v98, v98
    v_cvt_pk_bf16_f32 v70, v96, v97
    v_exp_f32 v99, v99
    s_waitcnt lgkmcnt(0)
    v_mfma_f32_32x32x16_bf16 v[108:123], v[52:55], v[60:63], 0
    v_exp_f32 v100, v100
    v_cvt_pk_bf16_f32 v71, v98, v99
    v_exp_f32 v101, v101
    v_exp_f32 v102, v102
    v_mfma_f32_32x32x16_bf16 v[108:123], v[56:59], v[64:67], v[108:123]
    v_cvt_pk_bf16_f32 v72, v100, v101
    v_exp_f32 v103, v103
    v_exp_f32 v104, v104
    v_cvt_pk_bf16_f32 v73, v102, v103
    v_exp_f32 v105, v105
    v_smfmac_f32_16x16x64_bf16 v[36:39], v[32:35], v[60:67], v159
    v_exp_f32 v106, v106
    v_cvt_pk_bf16_f32 v74, v104, v105
    v_exp_f32 v107, v107
    s_waitcnt vmcnt(0)
    s_mov_b32 s83, 0
L_p1:
    v_cmp_ne_u64 vcc, s[26:27], v[148:149]
    s_and_b64 vcc, vcc, s[10:11]
    s_cbranch_vccz L_p1k
    s_add_u32 s83, s83, 1
    s_cmp_ge_u32 s83, 65536
    s_cbranch_scc1 L_p1k
    buffer_load_dwordx2 v[148:149], v191, s[52:55], s14 offen sc1
    s_waitcnt vmcnt(0)
    s_branch L_p1
L_p1k:
    s_cmp_lg_u32 s3, 4
    s_cbranch_scc1 L_h2pre
    buffer_load_dwordx4 v[192:195], v190, s[52:55], s12 offen offset:0 sc1
    buffer_load_dwordx4 v[196:199], v190, s[52:55], s12 offen offset:1024 sc1
    buffer_load_dwordx4 v[200:203], v190, s[52:55], s12 offen offset:2048 sc1
    buffer_load_dwordx4 v[204:207], v190, s[52:55], s12 offen offset:3072 sc1
    buffer_load_dwordx4 v[208:211], v190, s[52:55], s13 offen offset:0 sc1
    buffer_load_dwordx4 v[212:215], v190, s[52:55], s13 offen offset:1024 sc1
    buffer_load_dwordx4 v[216:219], v190, s[52:55], s13 offen offset:2048 sc1
L_h2pre:
    s_lshl_b32 s15, s15, 15
    s_lshl_b32 s6, s65, 12
    s_add_u32 s15, s15, s6
    s_add_u32 m0, s6, 32768
    s_add_u32 s7, s15, 16384
    buffer_load_dwordx4 v4, s[40:43], s15 offen offset:0 sc1 lds
    buffer_load_dwordx4 v4, s[40:43], s15 offen offset:1024 sc1 lds
    buffer_load_dwordx4 v4, s[40:43], s15 offen offset:2048 sc1 lds
    buffer_load_dwordx4 v4, s[40:43], s15 offen offset:3072 sc1 lds
    s_add_u32 m0, s6, 49152
    s_nop 0
    buffer_load_dwordx4 v4, s[40:43], s7 offen offset:0 sc1 lds
    buffer_load_dwordx4 v4, s[40:43], s7 offen offset:1024 sc1 lds
    buffer_load_dwordx4 v4, s[40:43], s7 offen offset:2048 sc1 lds
    buffer_load_dwordx4 v4, s[40:43], s7 offen offset:3072 sc1 lds
    v_exp_f32 v76, v76
    v_cvt_pk_bf16_f32 v75, v106, v107
    v_exp_f32 v77, v77
    v_mfma_f32_32x32x16_bf16 v[92:107], v[44:47], v[24:27], 0
    v_exp_f32 v78, v78
    v_cvt_pk_bf16_f32 v60, v76, v77
    v_exp_f32 v79, v79
    v_exp_f32 v80, v80
    v_mfma_f32_32x32x16_bf16 v[92:107], v[48:51], v[28:31], v[92:107]
    v_cvt_pk_bf16_f32 v61, v78, v79
    ds_read_b128 v[44:47], v2 offset:16384
    v_exp_f32 v81, v81
    ds_read_b128 v[48:51], v2 offset:17408
    v_exp_f32 v82, v82
    v_cvt_pk_bf16_f32 v62, v80, v81
    v_exp_f32 v83, v83
    v_mfma_f32_32x32x16_bf16 v[124:139], v[52:55], v[68:71], 0
    v_exp_f32 v84, v84
    v_cvt_pk_bf16_f32 v63, v82, v83
    v_exp_f32 v85, v85
    v_exp_f32 v86, v86
    v_mfma_f32_32x32x16_bf16 v[124:139], v[56:59], v[72:75], v[124:139]
    v_cvt_pk_bf16_f32 v64, v84, v85
    ds_read_b128 v[52:55], v2 offset:6144
    v_exp_f32 v87, v87
    ds_read_b128 v[56:59], v2 offset:7168
    v_exp_f32 v88, v88
    v_cvt_pk_bf16_f32 v65, v86, v87
    v_exp_f32 v89, v89
    v_smfmac_f32_16x16x64_bf16 v[40:43], v[32:35], v[68:75], v159
    v_exp_f32 v90, v90
    v_cvt_pk_bf16_f32 v66, v88, v89
    v_exp_f32 v91, v91
    v_exp_f32 v92, v92
    v_cvt_pk_bf16_f32 v67, v90, v91
    v_exp_f32 v93, v93
    s_waitcnt lgkmcnt(2)
    v_mfma_f32_32x32x16_bf16 v[76:91], v[44:47], v[16:19], 0
    v_exp_f32 v94, v94
    v_cvt_pk_bf16_f32 v68, v92, v93
    v_exp_f32 v95, v95
    v_exp_f32 v96, v96
    v_mfma_f32_32x32x16_bf16 v[76:91], v[48:51], v[20:23], v[76:91]
    v_cvt_pk_bf16_f32 v69, v94, v95
    v_exp_f32 v97, v97
    v_exp_f32 v98, v98
    v_cvt_pk_bf16_f32 v70, v96, v97
    v_exp_f32 v99, v99
    s_waitcnt lgkmcnt(0)
    v_mfma_f32_32x32x16_bf16 v[108:123], v[52:55], v[60:63], v[108:123]
    v_exp_f32 v100, v100
    v_cvt_pk_bf16_f32 v71, v98, v99
    v_exp_f32 v101, v101
    v_exp_f32 v102, v102
    v_mfma_f32_32x32x16_bf16 v[108:123], v[56:59], v[64:67], v[108:123]
    v_cvt_pk_bf16_f32 v72, v100, v101
    v_exp_f32 v103, v103
    v_exp_f32 v104, v104
    v_cvt_pk_bf16_f32 v73, v102, v103
    v_exp_f32 v105, v105
    v_smfmac_f32_16x16x64_bf16 v[36:39], v[32:35], v[60:67], v159
    v_exp_f32 v106, v106
    v_cvt_pk_bf16_f32 v74, v104, v105
    v_exp_f32 v107, v107
    s_waitcnt vmcnt(8)
    s_cmp_lg_u32 s3, 4
    s_cbranch_scc1 L_h2skip
    v_mov_b32 v184, 0
    v_mov_b32 v185, 0
    s_cmp_eq_u32 s4, 0
    s_cbranch_scc1 L_havecarry
    s_mov_b32 s83, 0
L_h2chk:
    v_mov_b32 v144, 0
    v_xor_b32 v145, s26, v193
    v_xor_b32 v146, s26, v195
    v_or3_b32 v144, v144, v145, v146
    s_cmp_eq_u32 s4, 1
    s_cbranch_scc1 L_tags
    v_xor_b32 v145, s26, v197
    v_xor_b32 v146, s26, v199
    v_or3_b32 v144, v144, v145, v146
    s_cmp_eq_u32 s4, 2
    s_cbranch_scc1 L_tags
    v_xor_b32 v145, s26, v201
    v_xor_b32 v146, s26, v203
    v_or3_b32 v144, v144, v145, v146
    s_cmp_eq_u32 s4, 3
    s_cbranch_scc1 L_tags
    v_xor_b32 v145, s26, v205
    v_xor_b32 v146, s26, v207
    v_or3_b32 v144, v144, v145, v146
    s_cmp_eq_u32 s4, 4
    s_cbranch_scc1 L_tags
    v_xor_b32 v145, s26, v209
    v_xor_b32 v146, s26, v211
    v_or3_b32 v144, v144, v145, v146
    s_cmp_eq_u32 s4, 5
    s_cbranch_scc1 L_tags
    v_xor_b32 v145, s26, v213
    v_xor_b32 v146, s26, v215
    v_or3_b32 v144, v144, v145, v146
    s_cmp_eq_u32 s4, 6
    s_cbranch_scc1 L_tags
    v_xor_b32 v145, s26, v217
    v_xor_b32 v146, s26, v219
    v_or3_b32 v144, v144, v145, v146
L_tags:
    v_cmp_ne_u32 vcc, 0, v144
    s_add_u32 s83, s83, 1
    s_cmp_ge_u32 s83, 65536
    s_cbranch_scc1 L_comb
    s_cbranch_vccz L_comb
    buffer_load_dwordx4 v[192:195], v190, s[52:55], s12 offen offset:0 sc1
    buffer_load_dwordx4 v[196:199], v190, s[52:55], s12 offen offset:1024 sc1
    buffer_load_dwordx4 v[200:203], v190, s[52:55], s12 offen offset:2048 sc1
    buffer_load_dwordx4 v[204:207], v190, s[52:55], s12 offen offset:3072 sc1
    buffer_load_dwordx4 v[208:211], v190, s[52:55], s13 offen offset:0 sc1
    buffer_load_dwordx4 v[212:215], v190, s[52:55], s13 offen offset:1024 sc1
    buffer_load_dwordx4 v[216:219], v190, s[52:55], s13 offen offset:2048 sc1
    s_waitcnt vmcnt(0)
    s_branch L_h2chk
L_comb:
    v_mov_b32 v184, v192
    v_mov_b32 v185, v194
    s_cmp_eq_u32 s4, 1
    s_cbranch_scc1 L_hc1
    v_fmac_f32 v196, v187, v185
    v_fmac_f32 v198, v167, v184
    v_fma_f32 v184, v166, v184, v196
    v_fma_f32 v185, v166, v185, v198
    s_cmp_eq_u32 s4, 2
    s_cbranch_scc1 L_hc1
    v_fmac_f32 v200, v187, v185
    v_fmac_f32 v202, v167, v184
    v_fma_f32 v184, v166, v184, v200
    v_fma_f32 v185, v166, v185, v202
    s_cmp_eq_u32 s4, 3
    s_cbranch_scc1 L_hc1
    v_fmac_f32 v204, v187, v185
    v_fmac_f32 v206, v167, v184
    v_fma_f32 v184, v166, v184, v204
    v_fma_f32 v185, v166, v185, v206
    s_cmp_eq_u32 s4, 4
    s_cbranch_scc1 L_hc1
    v_fmac_f32 v208, v187, v185
    v_fmac_f32 v210, v167, v184
    v_fma_f32 v184, v166, v184, v208
    v_fma_f32 v185, v166, v185, v210
    s_cmp_eq_u32 s4, 5
    s_cbranch_scc1 L_hc1
    v_fmac_f32 v212, v187, v185
    v_fmac_f32 v214, v167, v184
    v_fma_f32 v184, v166, v184, v212
    v_fma_f32 v185, v166, v185, v214
    s_cmp_eq_u32 s4, 6
    s_cbranch_scc1 L_hc1
    v_fmac_f32 v216, v187, v185
    v_fmac_f32 v218, v167, v184
    v_fma_f32 v184, v166, v184, v216
    v_fma_f32 v185, v166, v185, v218
L_hc1:
    v_fmac_f32 v224, v240, v184
    v_fma_f32 v225, -v240, v185, v225
    v_fmac_f32 v226, v242, v184
    v_fma_f32 v227, -v242, v185, v227
    v_fmac_f32 v228, v244, v184
    v_fma_f32 v229, -v244, v185, v229
    v_fmac_f32 v230, v246, v184
    v_fma_f32 v231, -v246, v185, v231
    v_fma_f32 v224, -v241, v185, v224
    v_fma_f32 v225, -v241, v184, v225
    v_fma_f32 v226, -v243, v185, v226
    v_fma_f32 v227, -v243, v184, v227
    v_fma_f32 v228, -v245, v185, v228
    v_fma_f32 v229, -v245, v184, v229
    v_fma_f32 v230, -v247, v185, v230
    v_fma_f32 v231, -v247, v184, v231
L_havecarry:
    ds_write_b64 v232, v[224:225] offset:0
    ds_write_b64 v232, v[226:227] offset:256
    ds_write_b64 v232, v[228:229] offset:512
    ds_write_b64 v232, v[230:231] offset:768
    s_setprio 0
    s_waitcnt lgkmcnt(0)
L_h2skip:
    s_barrier
    buffer_load_dwordx2 v[148:149], v191, s[52:55], s14 offen sc1
    v_exp_f32 v76, v76
    v_cvt_pk_bf16_f32 v75, v106, v107
    v_exp_f32 v77, v77
    v_mfma_f32_32x32x16_bf16 v[92:107], v[44:47], v[24:27], 0
    v_exp_f32 v78, v78
    v_cvt_pk_bf16_f32 v60, v76, v77
    v_exp_f32 v79, v79
    v_exp_f32 v80, v80
    v_mfma_f32_32x32x16_bf16 v[92:107], v[48:51], v[28:31], v[92:107]
    v_cvt_pk_bf16_f32 v61, v78, v79
    ds_read_b128 v[44:47], v2 offset:20480
    v_exp_f32 v81, v81
    ds_read_b128 v[48:51], v2 offset:21504
    v_exp_f32 v82, v82
    v_cvt_pk_bf16_f32 v62, v80, v81
    v_exp_f32 v83, v83
    v_mfma_f32_32x32x16_bf16 v[124:139], v[52:55], v[68:71], v[124:139]
    v_exp_f32 v84, v84
    v_cvt_pk_bf16_f32 v63, v82, v83
    v_exp_f32 v85, v85
    v_exp_f32 v86, v86
    v_mfma_f32_32x32x16_bf16 v[124:139], v[56:59], v[72:75], v[124:139]
    v_cvt_pk_bf16_f32 v64, v84, v85
    ds_read_b128 v[52:55], v2 offset:18432
    v_exp_f32 v87, v87
    ds_read_b128 v[56:59], v2 offset:19456
    v_exp_f32 v88, v88
    v_cvt_pk_bf16_f32 v65, v86, v87
    v_exp_f32 v89, v89
    v_smfmac_f32_16x16x64_bf16 v[40:43], v[32:35], v[68:75], v159
    v_exp_f32 v90, v90
    v_cvt_pk_bf16_f32 v66, v88, v89
    v_exp_f32 v91, v91
    v_exp_f32 v92, v92
    v_cvt_pk_bf16_f32 v67, v90, v91
    v_exp_f32 v93, v93
    s_waitcnt lgkmcnt(2)
    v_mfma_f32_32x32x16_bf16 v[76:91], v[44:47], v[16:19], 0
    v_exp_f32 v94, v94
    v_cvt_pk_bf16_f32 v68, v92, v93
    v_exp_f32 v95, v95
    v_exp_f32 v96, v96
    v_mfma_f32_32x32x16_bf16 v[76:91], v[48:51], v[20:23], v[76:91]
    v_cvt_pk_bf16_f32 v69, v94, v95
    v_exp_f32 v97, v97
    v_exp_f32 v98, v98
    v_cvt_pk_bf16_f32 v70, v96, v97
    v_exp_f32 v99, v99
    s_waitcnt lgkmcnt(0)
    v_mfma_f32_32x32x16_bf16 v[108:123], v[52:55], v[60:63], v[108:123]
    v_exp_f32 v100, v100
    v_cvt_pk_bf16_f32 v71, v98, v99
    v_exp_f32 v101, v101
    v_exp_f32 v102, v102
    v_mfma_f32_32x32x16_bf16 v[108:123], v[56:59], v[64:67], v[108:123]
    v_cvt_pk_bf16_f32 v72, v100, v101
    v_exp_f32 v103, v103
    v_exp_f32 v104, v104
    v_cvt_pk_bf16_f32 v73, v102, v103
    v_exp_f32 v105, v105
    v_smfmac_f32_16x16x64_bf16 v[36:39], v[32:35], v[60:67], v159
    v_exp_f32 v106, v106
    v_cvt_pk_bf16_f32 v74, v104, v105
    v_exp_f32 v107, v107
    v_exp_f32 v76, v76
    v_cvt_pk_bf16_f32 v75, v106, v107
    v_exp_f32 v77, v77
    v_mfma_f32_32x32x16_bf16 v[92:107], v[44:47], v[24:27], 0
    v_exp_f32 v78, v78
    v_cvt_pk_bf16_f32 v60, v76, v77
    v_exp_f32 v79, v79
    v_exp_f32 v80, v80
    v_mfma_f32_32x32x16_bf16 v[92:107], v[48:51], v[28:31], v[92:107]
    v_cvt_pk_bf16_f32 v61, v78, v79
    s_waitcnt vmcnt(0)
    s_mov_b32 s83, 0
L_p2:
    v_cmp_ne_u64 vcc, s[26:27], v[148:149]
    s_and_b64 vcc, vcc, exec
    s_cbranch_vccz L_p2k
    s_add_u32 s83, s83, 1
    s_cmp_ge_u32 s83, 65536
    s_cbranch_scc1 L_p2k
    buffer_load_dwordx2 v[148:149], v191, s[52:55], s14 offen sc1
    s_waitcnt vmcnt(0)
    s_branch L_p2
L_p2k:
    s_barrier
    ds_read_b128 v[44:47], v2 offset:32768
    v_exp_f32 v81, v81
    ds_read_b128 v[48:51], v2 offset:33792
    v_exp_f32 v82, v82
    s_add_u32 m0, s76, 0
    s_nop 0
    buffer_load_dwordx4 v4, s[40:43], s77 offen offset:0 sc1 lds
    v_cvt_pk_bf16_f32 v62, v80, v81
    v_exp_f32 v83, v83
    v_mfma_f32_32x32x16_bf16 v[124:139], v[52:55], v[68:71], v[124:139]
    v_exp_f32 v84, v84
    v_cvt_pk_bf16_f32 v63, v82, v83
    v_exp_f32 v85, v85
    v_exp_f32 v86, v86
    v_mfma_f32_32x32x16_bf16 v[124:139], v[56:59], v[72:75], v[124:139]
    v_cvt_pk_bf16_f32 v64, v84, v85
    ds_read_b128 v[52:55], v2 offset:22528
    v_exp_f32 v87, v87
    ds_read_b128 v[56:59], v2 offset:23552
    v_exp_f32 v88, v88
    v_cvt_pk_bf16_f32 v65, v86, v87
    v_exp_f32 v89, v89
    v_smfmac_f32_16x16x64_bf16 v[40:43], v[32:35], v[68:75], v159
    v_exp_f32 v90, v90
    v_cvt_pk_bf16_f32 v66, v88, v89
    v_exp_f32 v91, v91
    v_exp_f32 v92, v92
    v_cvt_pk_bf16_f32 v67, v90, v91
    v_exp_f32 v93, v93
    s_waitcnt lgkmcnt(2)
    v_mfma_f32_32x32x16_bf16 v[76:91], v[44:47], v[16:19], 0
    v_exp_f32 v94, v94
    s_add_u32 m0, s76, 0
    s_nop 0
    buffer_load_dwordx4 v4, s[40:43], s77 offen offset:1024 sc1 lds
    s_add_u32 s77, s77, 16384
    s_and_b32 s77, s77, 262143
    v_cvt_pk_bf16_f32 v68, v92, v93
    v_exp_f32 v95, v95
    v_exp_f32 v96, v96
    v_mfma_f32_32x32x16_bf16 v[76:91], v[48:51], v[20:23], v[76:91]
    v_cvt_pk_bf16_f32 v69, v94, v95
    v_exp_f32 v97, v97
    v_exp_f32 v98, v98
    v_cvt_pk_bf16_f32 v70, v96, v97
    v_exp_f32 v99, v99
    s_waitcnt lgkmcnt(0)
    v_mfma_f32_32x32x16_bf16 v[108:123], v[52:55], v[60:63], v[108:123]
    v_exp_f32 v100, v100
    v_cvt_pk_bf16_f32 v71, v98, v99
    v_exp_f32 v101, v101
    v_exp_f32 v102, v102
    v_mfma_f32_32x32x16_bf16 v[108:123], v[56:59], v[64:67], v[108:123]
    v_cvt_pk_bf16_f32 v72, v100, v101
    v_exp_f32 v103, v103
    v_exp_f32 v104, v104
    v_cvt_pk_bf16_f32 v73, v102, v103
    v_exp_f32 v105, v105
    v_smfmac_f32_16x16x64_bf16 v[36:39], v[32:35], v[60:67], v159
    v_exp_f32 v106, v106
    v_cvt_pk_bf16_f32 v74, v104, v105
    v_exp_f32 v107, v107
    v_exp_f32 v76, v76
    v_cvt_pk_bf16_f32 v75, v106, v107
    v_exp_f32 v77, v77
    v_mfma_f32_32x32x16_bf16 v[92:107], v[44:47], v[24:27], 0
    v_exp_f32 v78, v78
    v_cvt_pk_bf16_f32 v60, v76, v77
    v_exp_f32 v79, v79
    v_exp_f32 v80, v80
    v_mfma_f32_32x32x16_bf16 v[92:107], v[48:51], v[28:31], v[92:107]
    v_cvt_pk_bf16_f32 v61, v78, v79
    ds_read_b128 v[44:47], v2 offset:36864
    v_exp_f32 v81, v81
    ds_read_b128 v[48:51], v2 offset:37888
    v_exp_f32 v82, v82
    v_cvt_pk_bf16_f32 v62, v80, v81
    v_exp_f32 v83, v83
    v_mfma_f32_32x32x16_bf16 v[124:139], v[52:55], v[68:71], v[124:139]
    v_exp_f32 v84, v84
    v_cvt_pk_bf16_f32 v63, v82, v83
    v_exp_f32 v85, v85
    v_exp_f32 v86, v86
    v_mfma_f32_32x32x16_bf16 v[124:139], v[56:59], v[72:75], v[124:139]
    v_cvt_pk_bf16_f32 v64, v84, v85
    ds_read_b128 v[52:55], v2 offset:34816
    v_exp_f32 v87, v87
    ds_read_b128 v[56:59], v2 offset:35840
    v_exp_f32 v88, v88
    v_cvt_pk_bf16_f32 v65, v86, v87
    v_exp_f32 v89, v89
    v_smfmac_f32_16x16x64_bf16 v[40:43], v[32:35], v[68:75], v159
    v_exp_f32 v90, v90
    v_cvt_pk_bf16_f32 v66, v88, v89
    v_exp_f32 v91, v91
    v_exp_f32 v92, v92
    v_cvt_pk_bf16_f32 v67, v90, v91
    v_exp_f32 v93, v93
    s_waitcnt lgkmcnt(2)
    v_mfma_f32_32x32x16_bf16 v[76:91], v[44:47], v[16:19], 0
    v_exp_f32 v94, v94
    v_cvt_pk_bf16_f32 v68, v92, v93
    v_exp_f32 v95, v95
    v_exp_f32 v96, v96
    v_mfma_f32_32x32x16_bf16 v[76:91], v[48:51], v[20:23], v[76:91]
    v_cvt_pk_bf16_f32 v69, v94, v95
    v_exp_f32 v97, v97
    v_exp_f32 v98, v98
    v_cvt_pk_bf16_f32 v70, v96, v97
    v_exp_f32 v99, v99
    s_waitcnt lgkmcnt(0)
    v_mfma_f32_32x32x16_bf16 v[108:123], v[52:55], v[60:63], v[108:123]
    v_exp_f32 v100, v100
    v_cvt_pk_bf16_f32 v71, v98, v99
    v_exp_f32 v101, v101
    v_exp_f32 v102, v102
    v_mfma_f32_32x32x16_bf16 v[108:123], v[56:59], v[64:67], v[108:123]
    v_cvt_pk_bf16_f32 v72, v100, v101
    v_exp_f32 v103, v103
    v_exp_f32 v104, v104
    v_cvt_pk_bf16_f32 v73, v102, v103
    v_exp_f32 v105, v105
    v_smfmac_f32_16x16x64_bf16 v[36:39], v[32:35], v[60:67], v159
    v_exp_f32 v106, v106
    v_cvt_pk_bf16_f32 v74, v104, v105
    v_exp_f32 v107, v107
L_join:
    v_exp_f32 v76, v76
    v_cvt_pk_bf16_f32 v75, v106, v107
    v_exp_f32 v77, v77
    v_mfma_f32_32x32x16_bf16 v[92:107], v[44:47], v[24:27], 0
    v_exp_f32 v78, v78
    v_cvt_pk_bf16_f32 v60, v76, v77
    v_exp_f32 v79, v79
    v_exp_f32 v80, v80
    v_mfma_f32_32x32x16_bf16 v[92:107], v[48:51], v[28:31], v[92:107]
    v_cvt_pk_bf16_f32 v61, v78, v79
    s_barrier
    ds_read_b128 v[44:47], v2 offset:49152
    v_exp_f32 v81, v81
    ds_read_b128 v[48:51], v2 offset:50176
    v_exp_f32 v82, v82
    s_add_u32 m0, s76, 16384
    s_nop 0
    buffer_load_dwordx4 v4, s[40:43], s77 offen offset:0 sc1 lds
    v_cvt_pk_bf16_f32 v62, v80, v81
    v_exp_f32 v83, v83
    v_mfma_f32_32x32x16_bf16 v[124:139], v[52:55], v[68:71], v[124:139]
    v_exp_f32 v84, v84
    v_cvt_pk_bf16_f32 v63, v82, v83
    v_exp_f32 v85, v85
    v_exp_f32 v86, v86
    v_mfma_f32_32x32x16_bf16 v[124:139], v[56:59], v[72:75], v[124:139]
    v_cvt_pk_bf16_f32 v64, v84, v85
    ds_read_b128 v[52:55], v2 offset:38912
    v_exp_f32 v87, v87
    ds_read_b128 v[56:59], v2 offset:39936
    v_exp_f32 v88, v88
    v_cvt_pk_bf16_f32 v65, v86, v87
    v_exp_f32 v89, v89
    v_smfmac_f32_16x16x64_bf16 v[40:43], v[32:35], v[68:75], v159
    v_exp_f32 v90, v90
    v_cvt_pk_bf16_f32 v66, v88, v89
    v_exp_f32 v91, v91
    v_exp_f32 v92, v92
    v_cvt_pk_bf16_f32 v67, v90, v91
    s_mov_b32 s60, s24
    s_mov_b32 s61, s25
    s_mov_b32 s62, 2048
    s_mov_b32 s63, 0x20000
    v_lshrrev_b32 v158, 1, v14
    v_and_b32 v157, 2047, v158
    buffer_load_ushort v208, v157, s[60:63], 0 offen
    s_mov_b32 s60, s8
    s_mov_b32 s61, s9
    s_mov_b32 s62, 4194304
    s_mov_b32 s63, 0x20000
    s_mov_b32 s6, 0
    buffer_load_ushort v192, v158, s[60:63], s6 offen offset:0
    v_exp_f32 v93, v93
    s_waitcnt lgkmcnt(2)
    v_mfma_f32_32x32x16_bf16 v[76:91], v[44:47], v[16:19], 0
    v_exp_f32 v94, v94
    s_add_u32 m0, s76, 16384
    s_nop 0
    buffer_load_dwordx4 v4, s[40:43], s77 offen offset:1024 sc1 lds
    s_add_u32 s77, s77, 16384
    s_and_b32 s77, s77, 262143
    v_cvt_pk_bf16_f32 v68, v92, v93
    v_exp_f32 v95, v95
    v_exp_f32 v96, v96
    v_mfma_f32_32x32x16_bf16 v[76:91], v[48:51], v[20:23], v[76:91]
    v_cvt_pk_bf16_f32 v69, v94, v95
    v_exp_f32 v97, v97
    v_exp_f32 v98, v98
    s_mov_b32 s6, 0
    buffer_load_ushort v193, v158, s[60:63], s6 offen offset:2048
    v_cvt_pk_bf16_f32 v70, v96, v97
    v_exp_f32 v99, v99
    s_waitcnt lgkmcnt(0)
    v_mfma_f32_32x32x16_bf16 v[108:123], v[52:55], v[60:63], v[108:123]
    v_exp_f32 v100, v100
    v_cvt_pk_bf16_f32 v71, v98, v99
    v_exp_f32 v101, v101
    s_mov_b32 s6, 4096
    buffer_load_ushort v194, v158, s[60:63], s6 offen offset:0
    v_exp_f32 v102, v102
    v_mfma_f32_32x32x16_bf16 v[108:123], v[56:59], v[64:67], v[108:123]
    v_cvt_pk_bf16_f32 v72, v100, v101
    v_exp_f32 v103, v103
    v_exp_f32 v104, v104
    v_cvt_pk_bf16_f32 v73, v102, v103
    v_exp_f32 v105, v105
    v_smfmac_f32_16x16x64_bf16 v[36:39], v[32:35], v[60:67], v159
    v_exp_f32 v106, v106
    v_cvt_pk_bf16_f32 v74, v104, v105
    s_mov_b32 s6, 4096
    buffer_load_ushort v195, v158, s[60:63], s6 offen offset:2048
    v_exp_f32 v107, v107
    v_exp_f32 v76, v76
    v_cvt_pk_bf16_f32 v75, v106, v107
    s_mov_b32 s6, 16384
    buffer_load_ushort v196, v158, s[60:63], s6 offen offset:0
    v_exp_f32 v77, v77
    v_mfma_f32_32x32x16_bf16 v[92:107], v[44:47], v[24:27], 0
    v_exp_f32 v78, v78
    s_add_u32 m0, s75, 65536
    s_nop 0
    buffer_load_dwordx4 v5, s[44:47], s80 offen lds
    v_cvt_pk_bf16_f32 v60, v76, v77
    v_exp_f32 v79, v79
    v_exp_f32 v80, v80
    v_mfma_f32_32x32x16_bf16 v[92:107], v[48:51], v[28:31], v[92:107]
    v_cvt_pk_bf16_f32 v61, v78, v79
    ds_read_b128 v[44:47], v2 offset:53248
    v_exp_f32 v81, v81
    ds_read_b128 v[48:51], v2 offset:54272
    v_exp_f32 v82, v82
    s_mov_b32 s6, 16384
    buffer_load_ushort v197, v158, s[60:63], s6 offen offset:2048
    v_cvt_pk_bf16_f32 v62, v80, v81
    v_exp_f32 v83, v83
    v_mfma_f32_32x32x16_bf16 v[124:139], v[52:55], v[68:71], v[124:139]
    v_exp_f32 v84, v84
    v_cvt_pk_bf16_f32 v63, v82, v83
    v_exp_f32 v85, v85
    s_mov_b32 s6, 20480
    buffer_load_ushort v198, v158, s[60:63], s6 offen offset:0
    v_exp_f32 v86, v86
    v_mfma_f32_32x32x16_bf16 v[124:139], v[56:59], v[72:75], v[124:139]
    v_cvt_pk_bf16_f32 v64, v84, v85
    ds_read_b128 v[52:55], v2 offset:51200
    v_exp_f32 v87, v87
    ds_read_b128 v[56:59], v2 offset:52224
    v_exp_f32 v88, v88
    v_cvt_pk_bf16_f32 v65, v86, v87
    v_exp_f32 v89, v89
    v_smfmac_f32_16x16x64_bf16 v[40:43], v[32:35], v[68:75], v159
    v_exp_f32 v90, v90
    v_cvt_pk_bf16_f32 v66, v88, v89
    s_mov_b32 s6, 20480
    buffer_load_ushort v199, v158, s[60:63], s6 offen offset:2048
    v_exp_f32 v91, v91
    v_exp_f32 v92, v92
    v_cvt_pk_bf16_f32 v67, v90, v91
    s_mov_b32 s6, 32768
    buffer_load_ushort v200, v158, s[60:63], s6 offen offset:0
    v_exp_f32 v93, v93
    s_waitcnt lgkmcnt(2)
    v_mfma_f32_32x32x16_bf16 v[76:91], v[44:47], v[16:19], 0
    v_exp_f32 v94, v94
    s_add_u32 m0, s75, 73728
    s_nop 0
    buffer_load_dwordx4 v5, s[48:51], s80 offen lds
    s_add_u32 s80, s80, 128
    s_and_b32 s80, s80, 2047
    v_cvt_pk_bf16_f32 v68, v92, v93
    v_exp_f32 v95, v95
    v_exp_f32 v96, v96
    v_mfma_f32_32x32x16_bf16 v[76:91], v[48:51], v[20:23], v[76:91]
    v_cvt_pk_bf16_f32 v69, v94, v95
    v_exp_f32 v97, v97
    v_exp_f32 v98, v98
    s_mov_b32 s6, 32768
    buffer_load_ushort v201, v158, s[60:63], s6 offen offset:2048
    v_cvt_pk_bf16_f32 v70, v96, v97
    v_exp_f32 v99, v99
    s_waitcnt lgkmcnt(0)
    v_mfma_f32_32x32x16_bf16 v[108:123], v[52:55], v[60:63], v[108:123]
    v_exp_f32 v100, v100
    v_cvt_pk_bf16_f32 v71, v98, v99
    v_exp_f32 v101, v101
    s_mov_b32 s6, 36864
    buffer_load_ushort v202, v158, s[60:63], s6 offen offset:0
    v_exp_f32 v102, v102
    v_mfma_f32_32x32x16_bf16 v[108:123], v[56:59], v[64:67], v[108:123]
    v_cvt_pk_bf16_f32 v72, v100, v101
    v_exp_f32 v103, v103
    v_exp_f32 v104, v104
    v_cvt_pk_bf16_f32 v73, v102, v103
    v_exp_f32 v105, v105
    v_smfmac_f32_16x16x64_bf16 v[36:39], v[32:35], v[60:67], v159
    v_exp_f32 v106, v106
    v_cvt_pk_bf16_f32 v74, v104, v105
    s_mov_b32 s6, 36864
    buffer_load_ushort v203, v158, s[60:63], s6 offen offset:2048
    v_exp_f32 v107, v107
    v_exp_f32 v76, v76
    v_cvt_pk_bf16_f32 v75, v106, v107
    s_mov_b32 s6, 49152
    buffer_load_ushort v204, v158, s[60:63], s6 offen offset:0
    v_exp_f32 v77, v77
    v_mfma_f32_32x32x16_bf16 v[92:107], v[44:47], v[24:27], 0
    v_exp_f32 v78, v78
    v_cvt_pk_bf16_f32 v60, v76, v77
    v_exp_f32 v79, v79
    v_exp_f32 v80, v80
    v_mfma_f32_32x32x16_bf16 v[92:107], v[48:51], v[28:31], v[92:107]
    v_cvt_pk_bf16_f32 v61, v78, v79
    s_waitcnt vmcnt(18)
    s_barrier
    ds_read_b128 v[44:47], v2 offset:0
    v_exp_f32 v81, v81
    ds_read_b128 v[48:51], v2 offset:1024
    v_exp_f32 v82, v82
    s_add_u32 m0, s76, 32768
    s_nop 0
    buffer_load_dwordx4 v4, s[40:43], s77 offen offset:0 sc1 lds
    s_mov_b32 s6, 49152
    buffer_load_ushort v205, v158, s[60:63], s6 offen offset:2048
    v_cvt_pk_bf16_f32 v62, v80, v81
    v_exp_f32 v83, v83
    v_mfma_f32_32x32x16_bf16 v[124:139], v[52:55], v[68:71], v[124:139]
    v_exp_f32 v84, v84
    v_cvt_pk_bf16_f32 v63, v82, v83
    v_exp_f32 v85, v85
    s_mov_b32 s6, 53248
    buffer_load_ushort v206, v158, s[60:63], s6 offen offset:0
    v_exp_f32 v86, v86
    v_mfma_f32_32x32x16_bf16 v[124:139], v[56:59], v[72:75], v[124:139]
    v_cvt_pk_bf16_f32 v64, v84, v85
    ds_read_b128 v[52:55], v2 offset:55296
    v_exp_f32 v87, v87
    ds_read_b128 v[56:59], v2 offset:56320
    v_exp_f32 v88, v88
    v_cvt_pk_bf16_f32 v65, v86, v87
    v_exp_f32 v89, v89
    v_smfmac_f32_16x16x64_bf16 v[40:43], v[32:35], v[68:75], v159
    v_exp_f32 v90, v90
    v_cvt_pk_bf16_f32 v66, v88, v89
    s_mov_b32 s6, 53248
    buffer_load_ushort v207, v158, s[60:63], s6 offen offset:2048
    v_exp_f32 v91, v91
    s_lshl_b32 s6, s68, 1
    s_add_u32 s6, s6, s67
    s_lshl_b32 s6, s6, 8
    s_lshl_b32 s7, s4, 10
    s_sub_u32 s7, s7, 256
    v_mov_b32 v146, s6
    v_mov_b32 v147, s7
    v_cmp_gt_u32 vcc, 32, v0
    v_cndmask_b32 v146, v147, v146, vcc
    v_lshl_add_u32 v146, v0, 3, v146
    s_mov_b32 s14, 27394048
    buffer_load_dwordx2 v[148:149], v146, s[52:55], s14 offen sc1
    v_exp_f32 v92, v92
    v_cvt_pk_bf16_f32 v67, v90, v91
    v_exp_f32 v93, v93
    s_waitcnt lgkmcnt(2)
    v_mfma_f32_32x32x16_bf16 v[76:91], v[44:47], v[16:19], 0
    v_exp_f32 v94, v94
    s_add_u32 m0, s76, 32768
    s_nop 0
    buffer_load_dwordx4 v4, s[40:43], s77 offen offset:1024 sc1 lds
    s_add_u32 s77, s77, 16384
    s_and_b32 s77, s77, 262143
    v_cvt_pk_bf16_f32 v68, v92, v93
    v_exp_f32 v95, v95
    v_exp_f32 v96, v96
    v_mfma_f32_32x32x16_bf16 v[76:91], v[48:51], v[20:23], v[76:91]
    v_cvt_pk_bf16_f32 v69, v94, v95
    v_exp_f32 v97, v97
    v_exp_f32 v98, v98
    v_cvt_pk_bf16_f32 v70, v96, v97
    v_exp_f32 v99, v99
    s_waitcnt lgkmcnt(0)
    v_mfma_f32_32x32x16_bf16 v[108:123], v[52:55], v[60:63], v[108:123]
    v_exp_f32 v100, v100
    v_cvt_pk_bf16_f32 v71, v98, v99
    v_exp_f32 v101, v101
    v_exp_f32 v102, v102
    v_mfma_f32_32x32x16_bf16 v[108:123], v[56:59], v[64:67], v[108:123]
    v_cvt_pk_bf16_f32 v72, v100, v101
    v_exp_f32 v103, v103
    v_exp_f32 v104, v104
    v_cvt_pk_bf16_f32 v73, v102, v103
    v_exp_f32 v105, v105
    v_smfmac_f32_16x16x64_bf16 v[36:39], v[32:35], v[60:67], v159
    v_exp_f32 v106, v106
    v_cvt_pk_bf16_f32 v74, v104, v105
    v_exp_f32 v107, v107
    s_waitcnt vmcnt(1)
    s_mov_b32 s83, 0
L_p3:
    v_cmp_ne_u64 vcc, s[26:27], v[148:149]
    s_and_b64 vcc, vcc, exec
    s_cbranch_vccz L_p3k
    s_add_u32 s83, s83, 1
    s_cmp_ge_u32 s83, 65536
    s_cbranch_scc1 L_p3k
    buffer_load_dwordx2 v[148:149], v146, s[52:55], s14 offen sc1
    s_waitcnt vmcnt(0)
    s_branch L_p3
L_p3k:
    v_bfe_u32 v146, v0, 2, 1
    v_lshlrev_b32 v146, 7, v146
    v_bfe_u32 v147, v0, 3, 2
    v_lshl_add_u32 v146, v147, 4, v146
    v_and_b32 v147, 3, v0
    v_lshl_add_u32 v146, v147, 2, v146
    s_lshl_b32 s6, s4, 10
    s_lshl_b32 s7, s65, 8
    s_add_u32 s6, s6, s7
    s_lshl_b32 s7, s64, 6
    s_add_u32 s6, s6, s7
    s_add_u32 s6, s6, 25165824
    buffer_load_dword v15, v146, s[52:55], s6 offen sc1
    s_lshl_b32 s6, s68, 9
    s_add_u32 s6, s6, 25165824
    s_mov_b32 m0, 149504
    v_lshlrev_b32 v146, 2, v0
    buffer_load_dword v146, s[52:55], s6 offen sc1 lds
    buffer_load_dword v146, s[52:55], s6 offen offset:256 sc1 lds
    v_exp_f32 v76, v76
    v_cvt_pk_bf16_f32 v75, v106, v107
    v_exp_f32 v77, v77
    v_mfma_f32_32x32x16_bf16 v[92:107], v[44:47], v[24:27], 0
    v_exp_f32 v78, v78
    s_add_u32 s6, s79, s71
    buffer_load_dwordx4 v[160:163], v4, s[52:55], s6 offen offset:0 sc1
    v_cvt_pk_bf16_f32 v60, v76, v77
    v_exp_f32 v79, v79
    v_exp_f32 v80, v80
    v_mfma_f32_32x32x16_bf16 v[92:107], v[48:51], v[28:31], v[92:107]
    v_cvt_pk_bf16_f32 v61, v78, v79
    ds_read_b128 v[44:47], v2 offset:4096
    v_exp_f32 v81, v81
    ds_read_b128 v[48:51], v2 offset:5120
    v_exp_f32 v82, v82
    v_cvt_pk_bf16_f32 v62, v80, v81
    v_exp_f32 v83, v83
    v_mfma_f32_32x32x16_bf16 v[124:139], v[52:55], v[68:71], v[124:139]
    v_exp_f32 v84, v84
    v_cvt_pk_bf16_f32 v63, v82, v83
    s_add_u32 s6, s79, s72
    buffer_load_dwordx4 v[164:167], v4, s[52:55], s6 offen offset:0 sc1
    v_exp_f32 v85, v85
    v_exp_f32 v86, v86
    v_mfma_f32_32x32x16_bf16 v[124:139], v[56:59], v[72:75], v[124:139]
    v_cvt_pk_bf16_f32 v64, v84, v85
    ds_read_b128 v[52:55], v2 offset:2048
    v_exp_f32 v87, v87
    ds_read_b128 v[56:59], v2 offset:3072
    v_exp_f32 v88, v88
    v_cvt_pk_bf16_f32 v65, v86, v87
    s_add_u32 m0, s75, 81920
    s_nop 0
    buffer_load_dwordx4 v5, s[44:47], s80 offen lds
    v_exp_f32 v89, v89
    v_smfmac_f32_16x16x64_bf16 v[40:43], v[32:35], v[68:75], v159
    v_exp_f32 v90, v90
    v_cvt_pk_bf16_f32 v66, v88, v89
    v_exp_f32 v91, v91
    v_exp_f32 v92, v92
    v_cvt_pk_bf16_f32 v67, v90, v91
    v_exp_f32 v93, v93
    s_waitcnt lgkmcnt(2)
    v_mfma_f32_32x32x16_bf16 v[76:91], v[44:47], v[16:19], 0
    v_exp_f32 v94, v94
    s_add_u32 s6, s79, s71
    buffer_load_dwordx4 v[168:171], v4, s[52:55], s6 offen offset:1024 sc1
    v_cvt_pk_bf16_f32 v68, v92, v93
    v_exp_f32 v95, v95
    v_exp_f32 v96, v96
    v_mfma_f32_32x32x16_bf16 v[76:91], v[48:51], v[20:23], v[76:91]
    v_cvt_pk_bf16_f32 v69, v94, v95
    v_exp_f32 v97, v97
    v_exp_f32 v98, v98
    v_cvt_pk_bf16_f32 v70, v96, v97
    v_exp_f32 v99, v99
    s_waitcnt lgkmcnt(0)
    v_mfma_f32_32x32x16_bf16 v[108:123], v[52:55], v[60:63], v[108:123]
    v_exp_f32 v100, v100
    v_cvt_pk_bf16_f32 v71, v98, v99
    s_add_u32 s6, s79, s72
    buffer_load_dwordx4 v[172:175], v4, s[52:55], s6 offen offset:1024 sc1
    s_add_u32 s79, s79, 8192
    s_and_b32 s79, s79, 131071
    v_exp_f32 v101, v101
    v_exp_f32 v102, v102
    v_mfma_f32_32x32x16_bf16 v[108:123], v[56:59], v[64:67], v[108:123]
    v_cvt_pk_bf16_f32 v72, v100, v101
    v_exp_f32 v103, v103
    v_exp_f32 v104, v104
    v_cvt_pk_bf16_f32 v73, v102, v103
    s_add_u32 m0, s75, 90112
    s_nop 0
    buffer_load_dwordx4 v5, s[48:51], s80 offen lds
    s_add_u32 s80, s80, 128
    s_and_b32 s80, s80, 2047
    v_exp_f32 v105, v105
    v_smfmac_f32_16x16x64_bf16 v[36:39], v[32:35], v[60:67], v159
    v_exp_f32 v106, v106
    v_cvt_pk_bf16_f32 v74, v104, v105
    v_exp_f32 v107, v107
    v_exp_f32 v76, v76
    v_cvt_pk_bf16_f32 v75, v106, v107
    v_exp_f32 v77, v77
    v_mfma_f32_32x32x16_bf16 v[92:107], v[44:47], v[24:27], 0
    v_exp_f32 v78, v78
    v_cvt_pk_bf16_f32 v60, v76, v77
    v_exp_f32 v79, v79
    v_exp_f32 v80, v80
    v_mfma_f32_32x32x16_bf16 v[92:107], v[48:51], v[28:31], v[92:107]
    v_cvt_pk_bf16_f32 v61, v78, v79
    s_waitcnt vmcnt(19)
    s_barrier
    ds_read_b128 v[44:47], v2 offset:16384
    v_exp_f32 v81, v81
    ds_read_b128 v[48:51], v2 offset:17408
    v_exp_f32 v82, v82
    s_add_u32 m0, s76, 49152
    s_nop 0
    buffer_load_dwordx4 v4, s[40:43], s77 offen offset:0 sc1 lds
    v_cvt_pk_bf16_f32 v62, v80, v81
    v_exp_f32 v83, v83
    v_mfma_f32_32x32x16_bf16 v[124:139], v[52:55], v[68:71], v[124:139]
    v_exp_f32 v84, v84
    v_cvt_pk_bf16_f32 v63, v82, v83
    s_add_u32 s6, s79, s71
    buffer_load_dwordx4 v[176:179], v4, s[52:55], s6 offen offset:0 sc1
    v_exp_f32 v85, v85
    v_exp_f32 v86, v86
    v_mfma_f32_32x32x16_bf16 v[124:139], v[56:59], v[72:75], v[124:139]
    v_cvt_pk_bf16_f32 v64, v84, v85
    ds_read_b128 v[52:55], v2 offset:6144
    v_exp_f32 v87, v87
    ds_read_b128 v[56:59], v2 offset:7168
    v_exp_f32 v88, v88
    v_cvt_pk_bf16_f32 v65, v86, v87
    s_add_u32 s6, s79, s72
    buffer_load_dwordx4 v[180:183], v4, s[52:55], s6 offen offset:0 sc1
    v_exp_f32 v89, v89
    v_smfmac_f32_16x16x64_bf16 v[40:43], v[32:35], v[68:75], v159
    v_exp_f32 v90, v90
    v_cvt_pk_bf16_f32 v66, v88, v89
    v_exp_f32 v91, v91
    v_exp_f32 v92, v92
    v_cvt_pk_bf16_f32 v67, v90, v91
    v_exp_f32 v93, v93
    s_waitcnt lgkmcnt(2)
    v_mfma_f32_32x32x16_bf16 v[76:91], v[44:47], v[16:19], 0
    v_exp_f32 v94, v94
    s_add_u32 m0, s76, 49152
    s_nop 0
    buffer_load_dwordx4 v4, s[40:43], s77 offen offset:1024 sc1 lds
    s_add_u32 s77, s77, 16384
    s_and_b32 s77, s77, 262143
    v_cvt_pk_bf16_f32 v68, v92, v93
    v_exp_f32 v95, v95
    v_exp_f32 v96, v96
    v_mfma_f32_32x32x16_bf16 v[76:91], v[48:51], v[20:23], v[76:91]
    v_cvt_pk_bf16_f32 v69, v94, v95
    v_exp_f32 v97, v97
    v_exp_f32 v98, v98
    v_cvt_pk_bf16_f32 v70, v96, v97
    v_exp_f32 v99, v99
    s_waitcnt lgkmcnt(0)
    v_mfma_f32_32x32x16_bf16 v[108:123], v[52:55], v[60:63], v[108:123]
    v_exp_f32 v100, v100
    v_cvt_pk_bf16_f32 v71, v98, v99
    s_add_u32 s6, s79, s71
    buffer_load_dwordx4 v[184:187], v4, s[52:55], s6 offen offset:1024 sc1
    v_exp_f32 v101, v101
    v_exp_f32 v102, v102
    v_mfma_f32_32x32x16_bf16 v[108:123], v[56:59], v[64:67], v[108:123]
    v_cvt_pk_bf16_f32 v72, v100, v101
    v_exp_f32 v103, v103
    v_exp_f32 v104, v104
    v_cvt_pk_bf16_f32 v73, v102, v103
    s_add_u32 s6, s79, s72
    buffer_load_dwordx4 v[188:191], v4, s[52:55], s6 offen offset:1024 sc1
    s_add_u32 s79, s79, 8192
    s_and_b32 s79, s79, 131071
    v_exp_f32 v105, v105
    v_smfmac_f32_16x16x64_bf16 v[36:39], v[32:35], v[60:67], v159
    v_exp_f32 v106, v106
    v_cvt_pk_bf16_f32 v74, v104, v105
    v_exp_f32 v107, v107
    ds_read_b128 v[140:143], v8
    s_waitcnt vmcnt(17)
    v_lshlrev_b32 v208, 16, v208
    v_lshlrev_b32 v192, 16, v192
    v_lshlrev_b32 v193, 16, v193
    v_mul_f32 v192, v192, v208
    v_mul_f32 v193, v193, v208
    v_cvt_pk_bf16_f32 v192, v192, v193
    v_and_b32 v193, 0xffff0000, v192
    v_lshlrev_b32 v192, 16, v192
    v_lshlrev_b32 v194, 16, v194
    v_lshlrev_b32 v195, 16, v195
    v_mul_f32 v194, v194, v208
    v_mul_f32 v195, v195, v208
    v_cvt_pk_bf16_f32 v194, v194, v195
    v_and_b32 v195, 0xffff0000, v194
    v_lshlrev_b32 v194, 16, v194
    v_lshlrev_b32 v196, 16, v196
    v_lshlrev_b32 v197, 16, v197
    v_mul_f32 v196, v196, v208
    v_mul_f32 v197, v197, v208
    v_cvt_pk_bf16_f32 v196, v196, v197
    v_and_b32 v197, 0xffff0000, v196
    v_lshlrev_b32 v196, 16, v196
    v_lshlrev_b32 v198, 16, v198
    v_lshlrev_b32 v199, 16, v199
    v_mul_f32 v198, v198, v208
    v_mul_f32 v199, v199, v208
    v_cvt_pk_bf16_f32 v198, v198, v199
    v_and_b32 v199, 0xffff0000, v198
    v_lshlrev_b32 v198, 16, v198
    v_lshlrev_b32 v200, 16, v200
    v_lshlrev_b32 v201, 16, v201
    v_mul_f32 v200, v200, v208
    v_mul_f32 v201, v201, v208
    v_cvt_pk_bf16_f32 v200, v200, v201
    v_and_b32 v201, 0xffff0000, v200
    v_lshlrev_b32 v200, 16, v200
    v_lshlrev_b32 v202, 16, v202
    v_lshlrev_b32 v203, 16, v203
    v_mul_f32 v202, v202, v208
    v_mul_f32 v203, v203, v208
    v_cvt_pk_bf16_f32 v202, v202, v203
    v_and_b32 v203, 0xffff0000, v202
    v_lshlrev_b32 v202, 16, v202
    v_lshlrev_b32 v204, 16, v204
    v_lshlrev_b32 v205, 16, v205
    v_mul_f32 v204, v204, v208
    v_mul_f32 v205, v205, v208
    v_cvt_pk_bf16_f32 v204, v204, v205
    v_and_b32 v205, 0xffff0000, v204
    v_lshlrev_b32 v204, 16, v204
    v_lshlrev_b32 v206, 16, v206
    v_lshlrev_b32 v207, 16, v207
    v_mul_f32 v206, v206, v208
    v_mul_f32 v207, v207, v208
    v_cvt_pk_bf16_f32 v206, v206, v207
    v_and_b32 v207, 0xffff0000, v206
    v_lshlrev_b32 v206, 16, v206
    v_mov_b32 v208, 0
    v_mov_b32 v209, 0
    v_mov_b32 v210, 0
    v_mov_b32 v211, 0
    v_mov_b32 v212, 0
    v_mov_b32 v213, 0
    v_mov_b32 v214, 0
    v_mov_b32 v215, 0
    v_mov_b32 v216, 0
    v_mov_b32 v217, 0
    v_mov_b32 v218, 0
    v_mov_b32 v219, 0
    v_mov_b32 v220, 0
    v_mov_b32 v221, 0
    v_mov_b32 v222, 0
    v_mov_b32 v223, 0
    v_mov_b32 v224, 0
    v_mov_b32 v225, 0
    v_mov_b32 v226, 0
    v_mov_b32 v227, 0
    v_mov_b32 v228, 0
    v_mov_b32 v229, 0
    v_mov_b32 v230, 0
    v_mov_b32 v231, 0
    v_mov_b32 v232, 0
    v_mov_b32 v233, 0
    v_mov_b32 v234, 0
    v_mov_b32 v235, 0
    v_mov_b32 v236, 0
    v_mov_b32 v237, 0
    v_mov_b32 v238, 0
    v_mov_b32 v239, 0
    v_mov_b32 v240, 0
    v_mov_b32 v241, 0
    v_mov_b32 v242, 0
    v_mov_b32 v243, 0
    v_mov_b32 v244, 0
    v_mov_b32 v245, 0
    v_mov_b32 v246, 0
    v_mov_b32 v247, 0
    v_mov_b32 v248, 0
    v_mov_b32 v249, 0
    v_mov_b32 v250, 0
    v_mov_b32 v251, 0
    v_mov_b32 v252, 0
    v_mov_b32 v253, 0
    v_mov_b32 v254, 0
    v_mov_b32 v255, 0
    v_exp_f32 v76, v76
    v_cvt_pk_bf16_f32 v75, v106, v107
    v_mfma_f32_32x32x16_bf16 v[92:107], v[44:47], v[24:27], 0
    v_exp_f32 v77, v77
    v_exp_f32 v78, v78
    s_add_u32 m0, s75, 98304
    s_nop 0
    buffer_load_dwordx4 v5, s[44:47], s80 offen lds
    v_cvt_pk_bf16_f32 v60, v76, v77
    v_mfma_f32_32x32x16_bf16 v[92:107], v[48:51], v[28:31], v[92:107]
    v_exp_f32 v79, v79
    ds_read_b128 v[44:47], v2 offset:20480
    v_exp_f32 v80, v80
    ds_read_b128 v[48:51], v2 offset:21504
    v_cvt_pk_bf16_f32 v61, v78, v79
    v_exp_f32 v81, v81
    s_waitcnt vmcnt(11)
    s_waitcnt lgkmcnt(2)
    v_mfma_f32_32x32x16_bf16 v[192:207], v[160:163], v[140:143], v[192:207]
    v_exp_f32 v82, v82
    v_cvt_pk_bf16_f32 v62, v80, v81
    v_exp_f32 v83, v83
    v_mfma_f32_32x32x16_bf16 v[224:239], v[164:167], v[140:143], v[224:239]
    v_exp_f32 v84, v84
    ds_read_b128 v[140:143], v10 offset:0
    v_cvt_pk_bf16_f32 v63, v82, v83
    v_exp_f32 v85, v85
    v_exp_f32 v86, v86
    v_mfma_f32_32x32x16_bf16 v[124:139], v[52:55], v[68:71], v[124:139]
    v_cvt_pk_bf16_f32 v64, v84, v85
    v_exp_f32 v87, v87
    v_exp_f32 v88, v88
    v_mfma_f32_32x32x16_bf16 v[124:139], v[56:59], v[72:75], v[124:139]
    v_cvt_pk_bf16_f32 v65, v86, v87
    ds_read_b128 v[52:55], v2 offset:18432
    v_exp_f32 v89, v89
    ds_read_b128 v[56:59], v2 offset:19456
    v_exp_f32 v90, v90
    v_smfmac_f32_16x16x64_bf16 v[40:43], v[32:35], v[68:75], v159
    v_cvt_pk_bf16_f32 v66, v88, v89
    v_exp_f32 v91, v91
    v_exp_f32 v92, v92
    v_cvt_pk_bf16_f32 v67, v90, v91
    s_waitcnt lgkmcnt(3)
    v_mfma_f32_32x32x16_bf16 v[76:91], v[44:47], v[16:19], 0
    v_exp_f32 v93, v93
    v_exp_f32 v94, v94
    s_add_u32 m0, s75, 106496
    s_nop 0
    buffer_load_dwordx4 v5, s[48:51], s80 offen lds
    s_add_u32 s80, s80, 128
    s_and_b32 s80, s80, 2047
    v_cvt_pk_bf16_f32 v68, v92, v93
    v_mfma_f32_32x32x16_bf16 v[76:91], v[48:51], v[20:23], v[76:91]
    v_exp_f32 v95, v95
    v_exp_f32 v96, v96
    v_cvt_pk_bf16_f32 v69, v94, v95
    v_exp_f32 v97, v97
    s_waitcnt lgkmcnt(2)
    v_mfma_f32_32x32x16_bf16 v[208:223], v[160:163], v[140:143], v[208:223]
    v_exp_f32 v98, v98
    v_cvt_pk_bf16_f32 v70, v96, v97
    v_exp_f32 v99, v99
    v_mfma_f32_32x32x16_bf16 v[240:255], v[164:167], v[140:143], v[240:255]
    v_exp_f32 v100, v100
    ds_read_b128 v[140:143], v9 offset:0
    v_cvt_pk_bf16_f32 v71, v98, v99
    s_add_u32 s6, s79, s71
    buffer_load_dwordx4 v[160:163], v4, s[52:55], s6 offen offset:0 sc1
    v_exp_f32 v101, v101
    v_exp_f32 v102, v102
    s_waitcnt lgkmcnt(1)
    v_mfma_f32_32x32x16_bf16 v[108:123], v[52:55], v[60:63], v[108:123]
    v_cvt_pk_bf16_f32 v72, v100, v101
    v_exp_f32 v103, v103
    v_exp_f32 v104, v104
    v_mfma_f32_32x32x16_bf16 v[108:123], v[56:59], v[64:67], v[108:123]
    v_cvt_pk_bf16_f32 v73, v102, v103
    v_exp_f32 v105, v105
    v_exp_f32 v106, v106
    v_smfmac_f32_16x16x64_bf16 v[36:39], v[32:35], v[60:67], v159
    v_cvt_pk_bf16_f32 v74, v104, v105
    v_exp_f32 v107, v107
    v_exp_f32 v76, v76
    v_cvt_pk_bf16_f32 v75, v106, v107
    v_mfma_f32_32x32x16_bf16 v[92:107], v[44:47], v[24:27], 0
    v_exp_f32 v77, v77
    v_exp_f32 v78, v78
    v_cvt_pk_bf16_f32 v60, v76, v77
    v_mfma_f32_32x32x16_bf16 v[92:107], v[48:51], v[28:31], v[92:107]
    v_exp_f32 v79, v79
    s_waitcnt vmcnt(9)
    s_barrier
    ds_read_b128 v[44:47], v2 offset:32768
    v_exp_f32 v80, v80
    ds_read_b128 v[48:51], v2 offset:33792
    v_cvt_pk_bf16_f32 v61, v78, v79
    s_add_u32 m0, s76, 0
    s_nop 0
    buffer_load_dwordx4 v4, s[40:43], s77 offen offset:0 sc1 lds
    v_exp_f32 v81, v81
    s_waitcnt lgkmcnt(2)
    v_mfma_f32_32x32x16_bf16 v[192:207], v[168:171], v[140:143], v[192:207]
    v_exp_f32 v82, v82
    v_cvt_pk_bf16_f32 v62, v80, v81
    v_exp_f32 v83, v83
    v_mfma_f32_32x32x16_bf16 v[224:239], v[172:175], v[140:143], v[224:239]
    v_exp_f32 v84, v84
    ds_read_b128 v[140:143], v11 offset:0
    v_cvt_pk_bf16_f32 v63, v82, v83
    s_add_u32 s6, s79, s72
    buffer_load_dwordx4 v[164:167], v4, s[52:55], s6 offen offset:0 sc1
    v_exp_f32 v85, v85
    v_exp_f32 v86, v86
    v_mfma_f32_32x32x16_bf16 v[124:139], v[52:55], v[68:71], v[124:139]
    v_cvt_pk_bf16_f32 v64, v84, v85
    v_exp_f32 v87, v87
    v_exp_f32 v88, v88
    v_mfma_f32_32x32x16_bf16 v[124:139], v[56:59], v[72:75], v[124:139]
    v_cvt_pk_bf16_f32 v65, v86, v87
    ds_read_b128 v[52:55], v2 offset:22528
    v_exp_f32 v89, v89
    ds_read_b128 v[56:59], v2 offset:23552
    v_exp_f32 v90, v90
    v_smfmac_f32_16x16x64_bf16 v[40:43], v[32:35], v[68:75], v159
    v_cvt_pk_bf16_f32 v66, v88, v89
    v_exp_f32 v91, v91
    v_exp_f32 v92, v92
    v_cvt_pk_bf16_f32 v67, v90, v91
    s_waitcnt lgkmcnt(3)
    v_mfma_f32_32x32x16_bf16 v[76:91], v[44:47], v[16:19], 0
    v_exp_f32 v93, v93
    v_exp_f32 v94, v94
    s_add_u32 m0, s76, 0
    s_nop 0
    buffer_load_dwordx4 v4, s[40:43], s77 offen offset:1024 sc1 lds
    s_add_u32 s77, s77, 16384
    s_and_b32 s77, s77, 262143
    v_cvt_pk_bf16_f32 v68, v92, v93
    v_mfma_f32_32x32x16_bf16 v[76:91], v[48:51], v[20:23], v[76:91]
    v_exp_f32 v95, v95
    v_exp_f32 v96, v96
    v_cvt_pk_bf16_f32 v69, v94, v95
    v_exp_f32 v97, v97
    s_waitcnt lgkmcnt(2)
    v_mfma_f32_32x32x16_bf16 v[208:223], v[168:171], v[140:143], v[208:223]
    v_exp_f32 v98, v98
    v_cvt_pk_bf16_f32 v70, v96, v97
    v_exp_f32 v99, v99
    v_mfma_f32_32x32x16_bf16 v[240:255], v[172:175], v[140:143], v[240:255]
    v_exp_f32 v100, v100
    ds_read_b128 v[140:143], v8 offset:16384
    v_cvt_pk_bf16_f32 v71, v98, v99
    s_add_u32 s6, s79, s71
    buffer_load_dwordx4 v[168:171], v4, s[52:55], s6 offen offset:1024 sc1
    v_exp_f32 v101, v101
    v_exp_f32 v102, v102
    s_waitcnt lgkmcnt(1)
    v_mfma_f32_32x32x16_bf16 v[108:123], v[52:55], v[60:63], v[108:123]
    v_cvt_pk_bf16_f32 v72, v100, v101
    v_exp_f32 v103, v103
    v_exp_f32 v104, v104
    v_mfma_f32_32x32x16_bf16 v[108:123], v[56:59], v[64:67], v[108:123]
    v_cvt_pk_bf16_f32 v73, v102, v103
    v_exp_f32 v105, v105
    v_exp_f32 v106, v106
    v_smfmac_f32_16x16x64_bf16 v[36:39], v[32:35], v[60:67], v159
    v_cvt_pk_bf16_f32 v74, v104, v105
    v_exp_f32 v107, v107
    v_exp_f32 v76, v76
    v_cvt_pk_bf16_f32 v75, v106, v107
    v_mfma_f32_32x32x16_bf16 v[92:107], v[44:47], v[24:27], 0
    v_exp_f32 v77, v77
    v_exp_f32 v78, v78
    s_add_u32 m0, s75, 114688
    s_nop 0
    buffer_load_dwordx4 v5, s[44:47], s80 offen lds
    v_cvt_pk_bf16_f32 v60, v76, v77
    v_mfma_f32_32x32x16_bf16 v[92:107], v[48:51], v[28:31], v[92:107]
    v_exp_f32 v79, v79
    ds_read_b128 v[44:47], v2 offset:36864
    v_exp_f32 v80, v80
    ds_read_b128 v[48:51], v2 offset:37888
    v_cvt_pk_bf16_f32 v61, v78, v79
    v_exp_f32 v81, v81
    s_waitcnt vmcnt(11)
    s_waitcnt lgkmcnt(2)
    v_mfma_f32_32x32x16_bf16 v[192:207], v[176:179], v[140:143], v[192:207]
    v_exp_f32 v82, v82
    v_cvt_pk_bf16_f32 v62, v80, v81
    v_exp_f32 v83, v83
    v_mfma_f32_32x32x16_bf16 v[224:239], v[180:183], v[140:143], v[224:239]
    v_exp_f32 v84, v84
    ds_read_b128 v[140:143], v10 offset:16384
    v_cvt_pk_bf16_f32 v63, v82, v83
    s_add_u32 s6, s79, s72
    buffer_load_dwordx4 v[172:175], v4, s[52:55], s6 offen offset:1024 sc1
    s_add_u32 s79, s79, 8192
    s_and_b32 s79, s79, 131071
    v_exp_f32 v85, v85
    v_exp_f32 v86, v86
    v_mfma_f32_32x32x16_bf16 v[124:139], v[52:55], v[68:71], v[124:139]
    v_cvt_pk_bf16_f32 v64, v84, v85
    v_exp_f32 v87, v87
    v_exp_f32 v88, v88
    v_mfma_f32_32x32x16_bf16 v[124:139], v[56:59], v[72:75], v[124:139]
    v_cvt_pk_bf16_f32 v65, v86, v87
    ds_read_b128 v[52:55], v2 offset:34816
    v_exp_f32 v89, v89
    ds_read_b128 v[56:59], v2 offset:35840
    v_exp_f32 v90, v90
    v_smfmac_f32_16x16x64_bf16 v[40:43], v[32:35], v[68:75], v159
    v_cvt_pk_bf16_f32 v66, v88, v89
    v_exp_f32 v91, v91
    v_exp_f32 v92, v92
    v_cvt_pk_bf16_f32 v67, v90, v91
    s_waitcnt lgkmcnt(3)
    v_mfma_f32_32x32x16_bf16 v[76:91], v[44:47], v[16:19], 0
    v_exp_f32 v93, v93
    v_exp_f32 v94, v94
    s_add_u32 m0, s75, 122880
    s_nop 0
    buffer_load_dwordx4 v5, s[48:51], s80 offen lds
    s_add_u32 s80, s80, 128
    s_and_b32 s80, s80, 2047
    v_cvt_pk_bf16_f32 v68, v92, v93
    v_mfma_f32_32x32x16_bf16 v[76:91], v[48:51], v[20:23], v[76:91]
    v_exp_f32 v95, v95
    v_exp_f32 v96, v96
    v_cvt_pk_bf16_f32 v69, v94, v95
    v_exp_f32 v97, v97
    s_waitcnt lgkmcnt(2)
    v_mfma_f32_32x32x16_bf16 v[208:223], v[176:179], v[140:143], v[208:223]
    v_exp_f32 v98, v98
    v_cvt_pk_bf16_f32 v70, v96, v97
    v_exp_f32 v99, v99
    v_mfma_f32_32x32x16_bf16 v[240:255], v[180:183], v[140:143], v[240:255]
    v_exp_f32 v100, v100
    ds_read_b128 v[140:143], v9 offset:16384
    v_cvt_pk_bf16_f32 v71, v98, v99
    s_add_u32 s6, s79, s71
    buffer_load_dwordx4 v[176:179], v4, s[52:55], s6 offen offset:0 sc1
    v_exp_f32 v101, v101
    v_exp_f32 v102, v102
    s_waitcnt lgkmcnt(1)
    v_mfma_f32_32x32x16_bf16 v[108:123], v[52:55], v[60:63], v[108:123]
    v_cvt_pk_bf16_f32 v72, v100, v101
    v_exp_f32 v103, v103
    v_exp_f32 v104, v104
    v_mfma_f32_32x32x16_bf16 v[108:123], v[56:59], v[64:67], v[108:123]
    v_cvt_pk_bf16_f32 v73, v102, v103
    v_exp_f32 v105, v105
    v_exp_f32 v106, v106
    v_smfmac_f32_16x16x64_bf16 v[36:39], v[32:35], v[60:67], v159
    v_cvt_pk_bf16_f32 v74, v104, v105
    v_exp_f32 v107, v107
    v_exp_f32 v76, v76
    v_cvt_pk_bf16_f32 v75, v106, v107
    v_mfma_f32_32x32x16_bf16 v[92:107], v[44:47], v[24:27], 0
    v_exp_f32 v77, v77
    v_exp_f32 v78, v78
    v_cvt_pk_bf16_f32 v60, v76, v77
    v_mfma_f32_32x32x16_bf16 v[92:107], v[48:51], v[28:31], v[92:107]
    v_exp_f32 v79, v79
    s_waitcnt vmcnt(9)
    s_barrier
    ds_read_b128 v[44:47], v2 offset:49152
    v_exp_f32 v80, v80
    ds_read_b128 v[48:51], v2 offset:50176
    v_cvt_pk_bf16_f32 v61, v78, v79
    s_add_u32 m0, s76, 16384
    s_nop 0
    buffer_load_dwordx4 v4, s[40:43], s77 offen offset:0 sc1 lds
    v_exp_f32 v81, v81
    s_waitcnt lgkmcnt(2)
    v_mfma_f32_32x32x16_bf16 v[192:207], v[184:187], v[140:143], v[192:207]
    v_exp_f32 v82, v82
    v_cvt_pk_bf16_f32 v62, v80, v81
    v_exp_f32 v83, v83
    v_mfma_f32_32x32x16_bf16 v[224:239], v[188:191], v[140:143], v[224:239]
    v_exp_f32 v84, v84
    ds_read_b128 v[140:143], v11 offset:16384
    v_cvt_pk_bf16_f32 v63, v82, v83
    s_add_u32 s6, s79, s72
    buffer_load_dwordx4 v[180:183], v4, s[52:55], s6 offen offset:0 sc1
    v_exp_f32 v85, v85
    v_exp_f32 v86, v86
    v_mfma_f32_32x32x16_bf16 v[124:139], v[52:55], v[68:71], v[124:139]
    v_cvt_pk_bf16_f32 v64, v84, v85
    v_exp_f32 v87, v87
    v_exp_f32 v88, v88
    v_mfma_f32_32x32x16_bf16 v[124:139], v[56:59], v[72:75], v[124:139]
    v_cvt_pk_bf16_f32 v65, v86, v87
    ds_read_b128 v[52:55], v2 offset:38912
    v_exp_f32 v89, v89
    ds_read_b128 v[56:59], v2 offset:39936
    v_exp_f32 v90, v90
    v_smfmac_f32_16x16x64_bf16 v[40:43], v[32:35], v[68:75], v159
    v_cvt_pk_bf16_f32 v66, v88, v89
    v_exp_f32 v91, v91
    v_exp_f32 v92, v92
    v_cvt_pk_bf16_f32 v67, v90, v91
    s_waitcnt lgkmcnt(3)
    v_mfma_f32_32x32x16_bf16 v[76:91], v[44:47], v[16:19], 0
    v_exp_f32 v93, v93
    v_exp_f32 v94, v94
    s_add_u32 m0, s76, 16384
    s_nop 0
    buffer_load_dwordx4 v4, s[40:43], s77 offen offset:1024 sc1 lds
    s_add_u32 s77, s77, 16384
    s_and_b32 s77, s77, 262143
    v_cvt_pk_bf16_f32 v68, v92, v93
    v_mfma_f32_32x32x16_bf16 v[76:91], v[48:51], v[20:23], v[76:91]
    v_exp_f32 v95, v95
    v_exp_f32 v96, v96
    v_cvt_pk_bf16_f32 v69, v94, v95
    v_exp_f32 v97, v97
    s_waitcnt lgkmcnt(2)
    v_mfma_f32_32x32x16_bf16 v[208:223], v[184:187], v[140:143], v[208:223]
    v_exp_f32 v98, v98
    v_cvt_pk_bf16_f32 v70, v96, v97
    v_exp_f32 v99, v99
    v_mfma_f32_32x32x16_bf16 v[240:255], v[188:191], v[140:143], v[240:255]
    v_exp_f32 v100, v100
    ds_read_b128 v[140:143], v8 offset:32768
    v_cvt_pk_bf16_f32 v71, v98, v99
    s_add_u32 s6, s79, s71
    buffer_load_dwordx4 v[184:187], v4, s[52:55], s6 offen offset:1024 sc1
    v_exp_f32 v101, v101
    v_exp_f32 v102, v102
    s_waitcnt lgkmcnt(1)
    v_mfma_f32_32x32x16_bf16 v[108:123], v[52:55], v[60:63], v[108:123]
    v_cvt_pk_bf16_f32 v72, v100, v101
    v_exp_f32 v103, v103
    v_exp_f32 v104, v104
    v_mfma_f32_32x32x16_bf16 v[108:123], v[56:59], v[64:67], v[108:123]
    v_cvt_pk_bf16_f32 v73, v102, v103
    v_exp_f32 v105, v105
    v_exp_f32 v106, v106
    v_smfmac_f32_16x16x64_bf16 v[36:39], v[32:35], v[60:67], v159
    v_cvt_pk_bf16_f32 v74, v104, v105
    v_exp_f32 v107, v107
    v_exp_f32 v76, v76
    v_cvt_pk_bf16_f32 v75, v106, v107
    v_mfma_f32_32x32x16_bf16 v[92:107], v[44:47], v[24:27], 0
    v_exp_f32 v77, v77
    v_exp_f32 v78, v78
    s_add_u32 m0, s75, 65536
    s_nop 0
    buffer_load_dwordx4 v5, s[44:47], s80 offen lds
    v_cvt_pk_bf16_f32 v60, v76, v77
    v_mfma_f32_32x32x16_bf16 v[92:107], v[48:51], v[28:31], v[92:107]
    v_exp_f32 v79, v79
    ds_read_b128 v[44:47], v2 offset:53248
    v_exp_f32 v80, v80
    ds_read_b128 v[48:51], v2 offset:54272
    v_cvt_pk_bf16_f32 v61, v78, v79
    v_exp_f32 v81, v81
    s_waitcnt vmcnt(11)
    s_waitcnt lgkmcnt(2)
    v_mfma_f32_32x32x16_bf16 v[192:207], v[160:163], v[140:143], v[192:207]
    v_exp_f32 v82, v82
    v_cvt_pk_bf16_f32 v62, v80, v81
    v_exp_f32 v83, v83
    v_mfma_f32_32x32x16_bf16 v[224:239], v[164:167], v[140:143], v[224:239]
    v_exp_f32 v84, v84
    ds_read_b128 v[140:143], v10 offset:32768
    v_cvt_pk_bf16_f32 v63, v82, v83
    s_add_u32 s6, s79, s72
    buffer_load_dwordx4 v[188:191], v4, s[52:55], s6 offen offset:1024 sc1
    s_add_u32 s79, s79, 8192
    s_and_b32 s79, s79, 131071
    v_exp_f32 v85, v85
    v_exp_f32 v86, v86
    v_mfma_f32_32x32x16_bf16 v[124:139], v[52:55], v[68:71], v[124:139]
    v_cvt_pk_bf16_f32 v64, v84, v85
    v_exp_f32 v87, v87
    v_exp_f32 v88, v88
    v_mfma_f32_32x32x16_bf16 v[124:139], v[56:59], v[72:75], v[124:139]
    v_cvt_pk_bf16_f32 v65, v86, v87
    ds_read_b128 v[52:55], v2 offset:51200
    v_exp_f32 v89, v89
    ds_read_b128 v[56:59], v2 offset:52224
    v_exp_f32 v90, v90
    v_smfmac_f32_16x16x64_bf16 v[40:43], v[32:35], v[68:75], v159
    v_cvt_pk_bf16_f32 v66, v88, v89
    v_exp_f32 v91, v91
    v_exp_f32 v92, v92
    v_cvt_pk_bf16_f32 v67, v90, v91
    s_waitcnt lgkmcnt(3)
    v_mfma_f32_32x32x16_bf16 v[76:91], v[44:47], v[16:19], 0
    v_exp_f32 v93, v93
    v_exp_f32 v94, v94
    s_add_u32 m0, s75, 73728
    s_nop 0
    buffer_load_dwordx4 v5, s[48:51], s80 offen lds
    s_add_u32 s80, s80, 128
    s_and_b32 s80, s80, 2047
    v_cvt_pk_bf16_f32 v68, v92, v93
    v_mfma_f32_32x32x16_bf16 v[76:91], v[48:51], v[20:23], v[76:91]
    v_exp_f32 v95, v95
    v_exp_f32 v96, v96
    v_cvt_pk_bf16_f32 v69, v94, v95
    v_exp_f32 v97, v97
    s_waitcnt lgkmcnt(2)
    v_mfma_f32_32x32x16_bf16 v[208:223], v[160:163], v[140:143], v[208:223]
    v_exp_f32 v98, v98
    v_cvt_pk_bf16_f32 v70, v96, v97
    v_exp_f32 v99, v99
    v_mfma_f32_32x32x16_bf16 v[240:255], v[164:167], v[140:143], v[240:255]
    v_exp_f32 v100, v100
    ds_read_b128 v[140:143], v9 offset:32768
    v_cvt_pk_bf16_f32 v71, v98, v99
    s_add_u32 s6, s79, s71
    buffer_load_dwordx4 v[160:163], v4, s[52:55], s6 offen offset:0 sc1
    v_exp_f32 v101, v101
    v_exp_f32 v102, v102
    s_waitcnt lgkmcnt(1)
    v_mfma_f32_32x32x16_bf16 v[108:123], v[52:55], v[60:63], v[108:123]
    v_cvt_pk_bf16_f32 v72, v100, v101
    v_exp_f32 v103, v103
    v_exp_f32 v104, v104
    v_mfma_f32_32x32x16_bf16 v[108:123], v[56:59], v[64:67], v[108:123]
    v_cvt_pk_bf16_f32 v73, v102, v103
    v_exp_f32 v105, v105
    v_exp_f32 v106, v106
    v_smfmac_f32_16x16x64_bf16 v[36:39], v[32:35], v[60:67], v159
    v_cvt_pk_bf16_f32 v74, v104, v105
    v_exp_f32 v107, v107
    v_exp_f32 v76, v76
    v_cvt_pk_bf16_f32 v75, v106, v107
    v_mfma_f32_32x32x16_bf16 v[92:107], v[44:47], v[24:27], 0
    v_exp_f32 v77, v77
    v_exp_f32 v78, v78
    v_cvt_pk_bf16_f32 v60, v76, v77
    v_mfma_f32_32x32x16_bf16 v[92:107], v[48:51], v[28:31], v[92:107]
    v_exp_f32 v79, v79
    s_waitcnt vmcnt(9)
    s_barrier
    ds_read_b128 v[44:47], v2 offset:0
    v_exp_f32 v80, v80
    ds_read_b128 v[48:51], v2 offset:1024
    v_cvt_pk_bf16_f32 v61, v78, v79
    s_add_u32 m0, s76, 32768
    s_nop 0
    buffer_load_dwordx4 v4, s[40:43], s77 offen offset:0 sc1 lds
    v_exp_f32 v81, v81
    s_waitcnt lgkmcnt(2)
    v_mfma_f32_32x32x16_bf16 v[192:207], v[168:171], v[140:143], v[192:207]
    v_exp_f32 v82, v82
    v_cvt_pk_bf16_f32 v62, v80, v81
    v_exp_f32 v83, v83
    v_mfma_f32_32x32x16_bf16 v[224:239], v[172:175], v[140:143], v[224:239]
    v_exp_f32 v84, v84
    ds_read_b128 v[140:143], v11 offset:32768
    v_cvt_pk_bf16_f32 v63, v82, v83
    s_add_u32 s6, s79, s72
    buffer_load_dwordx4 v[164:167], v4, s[52:55], s6 offen offset:0 sc1
    v_exp_f32 v85, v85
    v_exp_f32 v86, v86
    v_mfma_f32_32x32x16_bf16 v[124:139], v[52:55], v[68:71], v[124:139]
    v_cvt_pk_bf16_f32 v64, v84, v85
    v_exp_f32 v87, v87
    v_exp_f32 v88, v88
    v_mfma_f32_32x32x16_bf16 v[124:139], v[56:59], v[72:75], v[124:139]
    v_cvt_pk_bf16_f32 v65, v86, v87
    ds_read_b128 v[52:55], v2 offset:55296
    v_exp_f32 v89, v89
    ds_read_b128 v[56:59], v2 offset:56320
    v_exp_f32 v90, v90
    v_smfmac_f32_16x16x64_bf16 v[40:43], v[32:35], v[68:75], v159
    v_cvt_pk_bf16_f32 v66, v88, v89
    v_exp_f32 v91, v91
    v_exp_f32 v92, v92
    v_cvt_pk_bf16_f32 v67, v90, v91
    s_waitcnt lgkmcnt(3)
    v_mfma_f32_32x32x16_bf16 v[76:91], v[44:47], v[16:19], 0
    v_exp_f32 v93, v93
    v_exp_f32 v94, v94
    s_add_u32 m0, s76, 32768
    s_nop 0
    buffer_load_dwordx4 v4, s[40:43], s77 offen offset:1024 sc1 lds
    s_add_u32 s77, s77, 16384
    s_and_b32 s77, s77, 262143
    v_cvt_pk_bf16_f32 v68, v92, v93
    v_mfma_f32_32x32x16_bf16 v[76:91], v[48:51], v[20:23], v[76:91]
    v_exp_f32 v95, v95
    v_exp_f32 v96, v96
    v_cvt_pk_bf16_f32 v69, v94, v95
    v_exp_f32 v97, v97
    s_waitcnt lgkmcnt(2)
    v_mfma_f32_32x32x16_bf16 v[208:223], v[168:171], v[140:143], v[208:223]
    v_exp_f32 v98, v98
    v_cvt_pk_bf16_f32 v70, v96, v97
    v_exp_f32 v99, v99
    v_mfma_f32_32x32x16_bf16 v[240:255], v[172:175], v[140:143], v[240:255]
    v_exp_f32 v100, v100
    ds_read_b128 v[140:143], v8 offset:49152
    v_cvt_pk_bf16_f32 v71, v98, v99
    s_add_u32 s6, s79, s71
    buffer_load_dwordx4 v[168:171], v4, s[52:55], s6 offen offset:1024 sc1
    v_exp_f32 v101, v101
    v_exp_f32 v102, v102
    s_waitcnt lgkmcnt(1)
    v_mfma_f32_32x32x16_bf16 v[108:123], v[52:55], v[60:63], v[108:123]
    v_cvt_pk_bf16_f32 v72, v100, v101
    v_exp_f32 v103, v103
    v_exp_f32 v104, v104
    v_mfma_f32_32x32x16_bf16 v[108:123], v[56:59], v[64:67], v[108:123]
    v_cvt_pk_bf16_f32 v73, v102, v103
    v_exp_f32 v105, v105
    v_exp_f32 v106, v106
    v_smfmac_f32_16x16x64_bf16 v[36:39], v[32:35], v[60:67], v159
    v_cvt_pk_bf16_f32 v74, v104, v105
    v_exp_f32 v107, v107
    v_exp_f32 v76, v76
    v_cvt_pk_bf16_f32 v75, v106, v107
    v_mfma_f32_32x32x16_bf16 v[92:107], v[44:47], v[24:27], 0
    v_exp_f32 v77, v77
    v_exp_f32 v78, v78
    s_add_u32 m0, s75, 81920
    s_nop 0
    buffer_load_dwordx4 v5, s[44:47], s80 offen lds
    v_cvt_pk_bf16_f32 v60, v76, v77
    v_mfma_f32_32x32x16_bf16 v[92:107], v[48:51], v[28:31], v[92:107]
    v_exp_f32 v79, v79
    ds_read_b128 v[44:47], v2 offset:4096
    v_exp_f32 v80, v80
    ds_read_b128 v[48:51], v2 offset:5120
    v_cvt_pk_bf16_f32 v61, v78, v79
    v_exp_f32 v81, v81
    s_waitcnt vmcnt(11)
    s_waitcnt lgkmcnt(2)
    v_mfma_f32_32x32x16_bf16 v[192:207], v[176:179], v[140:143], v[192:207]
    v_exp_f32 v82, v82
    v_cvt_pk_bf16_f32 v62, v80, v81
    v_exp_f32 v83, v83
    v_mfma_f32_32x32x16_bf16 v[224:239], v[180:183], v[140:143], v[224:239]
    v_exp_f32 v84, v84
    ds_read_b128 v[140:143], v10 offset:49152
    v_cvt_pk_bf16_f32 v63, v82, v83
    s_add_u32 s6, s79, s72
    buffer_load_dwordx4 v[172:175], v4, s[52:55], s6 offen offset:1024 sc1
    s_add_u32 s79, s79, 8192
    s_and_b32 s79, s79, 131071
    v_exp_f32 v85, v85
    v_exp_f32 v86, v86
    v_mfma_f32_32x32x16_bf16 v[124:139], v[52:55], v[68:71], v[124:139]
    v_cvt_pk_bf16_f32 v64, v84, v85
    v_exp_f32 v87, v87
    v_exp_f32 v88, v88
    v_mfma_f32_32x32x16_bf16 v[124:139], v[56:59], v[72:75], v[124:139]
    v_cvt_pk_bf16_f32 v65, v86, v87
    ds_read_b128 v[52:55], v2 offset:2048
    v_exp_f32 v89, v89
    ds_read_b128 v[56:59], v2 offset:3072
    v_exp_f32 v90, v90
    v_smfmac_f32_16x16x64_bf16 v[40:43], v[32:35], v[68:75], v159
    v_cvt_pk_bf16_f32 v66, v88, v89
    v_exp_f32 v91, v91
    v_exp_f32 v92, v92
    v_cvt_pk_bf16_f32 v67, v90, v91
    s_waitcnt lgkmcnt(3)
    v_mfma_f32_32x32x16_bf16 v[76:91], v[44:47], v[16:19], 0
    v_exp_f32 v93, v93
    v_exp_f32 v94, v94
    s_add_u32 m0, s75, 90112
    s_nop 0
    buffer_load_dwordx4 v5, s[48:51], s80 offen lds
    s_add_u32 s80, s80, 128
    s_and_b32 s80, s80, 2047
    v_cvt_pk_bf16_f32 v68, v92, v93
    v_mfma_f32_32x32x16_bf16 v[76:91], v[48:51], v[20:23], v[76:91]
    v_exp_f32 v95, v95
    v_exp_f32 v96, v96
    v_cvt_pk_bf16_f32 v69, v94, v95
    v_exp_f32 v97, v97
    s_waitcnt lgkmcnt(2)
    v_mfma_f32_32x32x16_bf16 v[208:223], v[176:179], v[140:143], v[208:223]
    v_exp_f32 v98, v98
    v_cvt_pk_bf16_f32 v70, v96, v97
    v_exp_f32 v99, v99
    v_mfma_f32_32x32x16_bf16 v[240:255], v[180:183], v[140:143], v[240:255]
    v_exp_f32 v100, v100
    ds_read_b128 v[140:143], v9 offset:49152
    v_cvt_pk_bf16_f32 v71, v98, v99
    s_add_u32 s6, s79, s71
    buffer_load_dwordx4 v[176:179], v4, s[52:55], s6 offen offset:0 sc1
    v_exp_f32 v101, v101
    v_exp_f32 v102, v102
    s_waitcnt lgkmcnt(1)
    v_mfma_f32_32x32x16_bf16 v[108:123], v[52:55], v[60:63], v[108:123]
    v_cvt_pk_bf16_f32 v72, v100, v101
    v_exp_f32 v103, v103
    v_exp_f32 v104, v104
    v_mfma_f32_32x32x16_bf16 v[108:123], v[56:59], v[64:67], v[108:123]
    v_cvt_pk_bf16_f32 v73, v102, v103
    v_exp_f32 v105, v105
    v_exp_f32 v106, v106
    v_smfmac_f32_16x16x64_bf16 v[36:39], v[32:35], v[60:67], v159
    v_cvt_pk_bf16_f32 v74, v104, v105
    v_exp_f32 v107, v107
    v_exp_f32 v76, v76
    v_cvt_pk_bf16_f32 v75, v106, v107
    v_mfma_f32_32x32x16_bf16 v[92:107], v[44:47], v[24:27], 0
    v_exp_f32 v77, v77
    v_exp_f32 v78, v78
    v_cvt_pk_bf16_f32 v60, v76, v77
    v_mfma_f32_32x32x16_bf16 v[92:107], v[48:51], v[28:31], v[92:107]
    v_exp_f32 v79, v79
    s_waitcnt vmcnt(9)
    s_barrier
    ds_read_b128 v[44:47], v2 offset:16384
    v_exp_f32 v80, v80
    ds_read_b128 v[48:51], v2 offset:17408
    v_cvt_pk_bf16_f32 v61, v78, v79
    s_add_u32 m0, s76, 49152
    s_nop 0
    buffer_load_dwordx4 v4, s[40:43], s77 offen offset:0 sc1 lds
    v_exp_f32 v81, v81
    s_waitcnt lgkmcnt(2)
    v_mfma_f32_32x32x16_bf16 v[192:207], v[184:187], v[140:143], v[192:207]
    v_exp_f32 v82, v82
    v_cvt_pk_bf16_f32 v62, v80, v81
    v_exp_f32 v83, v83
    v_mfma_f32_32x32x16_bf16 v[224:239], v[188:191], v[140:143], v[224:239]
    v_exp_f32 v84, v84
    ds_read_b128 v[140:143], v11 offset:49152
    v_cvt_pk_bf16_f32 v63, v82, v83
    s_add_u32 s6, s79, s72
    buffer_load_dwordx4 v[180:183], v4, s[52:55], s6 offen offset:0 sc1
    v_exp_f32 v85, v85
    v_exp_f32 v86, v86
    v_mfma_f32_32x32x16_bf16 v[124:139], v[52:55], v[68:71], v[124:139]
    v_cvt_pk_bf16_f32 v64, v84, v85
    v_exp_f32 v87, v87
    v_exp_f32 v88, v88
    v_mfma_f32_32x32x16_bf16 v[124:139], v[56:59], v[72:75], v[124:139]
    v_cvt_pk_bf16_f32 v65, v86, v87
    ds_read_b128 v[52:55], v2 offset:6144
    v_exp_f32 v89, v89
    ds_read_b128 v[56:59], v2 offset:7168
    v_exp_f32 v90, v90
    v_smfmac_f32_16x16x64_bf16 v[40:43], v[32:35], v[68:75], v159
    v_cvt_pk_bf16_f32 v66, v88, v89
    v_exp_f32 v91, v91
    v_exp_f32 v92, v92
    v_cvt_pk_bf16_f32 v67, v90, v91
    s_waitcnt lgkmcnt(3)
    v_mfma_f32_32x32x16_bf16 v[76:91], v[44:47], v[16:19], 0
    v_exp_f32 v93, v93
    v_exp_f32 v94, v94
    s_add_u32 m0, s76, 49152
    s_nop 0
    buffer_load_dwordx4 v4, s[40:43], s77 offen offset:1024 sc1 lds
    s_add_u32 s77, s77, 16384
    s_and_b32 s77, s77, 262143
    v_cvt_pk_bf16_f32 v68, v92, v93
    v_mfma_f32_32x32x16_bf16 v[76:91], v[48:51], v[20:23], v[76:91]
    v_exp_f32 v95, v95
    v_exp_f32 v96, v96
    v_cvt_pk_bf16_f32 v69, v94, v95
    v_exp_f32 v97, v97
    s_waitcnt lgkmcnt(2)
    v_mfma_f32_32x32x16_bf16 v[208:223], v[184:187], v[140:143], v[208:223]
    v_exp_f32 v98, v98
    v_cvt_pk_bf16_f32 v70, v96, v97
    v_exp_f32 v99, v99
    v_mfma_f32_32x32x16_bf16 v[240:255], v[188:191], v[140:143], v[240:255]
    v_exp_f32 v100, v100
    ds_read_b128 v[140:143], v8 offset:0
    v_cvt_pk_bf16_f32 v71, v98, v99
    s_add_u32 s6, s79, s71
    buffer_load_dwordx4 v[184:187], v4, s[52:55], s6 offen offset:1024 sc1
    v_exp_f32 v101, v101
    v_exp_f32 v102, v102
    s_waitcnt lgkmcnt(1)
    v_mfma_f32_32x32x16_bf16 v[108:123], v[52:55], v[60:63], v[108:123]
    v_cvt_pk_bf16_f32 v72, v100, v101
    v_exp_f32 v103, v103
    v_exp_f32 v104, v104
    v_mfma_f32_32x32x16_bf16 v[108:123], v[56:59], v[64:67], v[108:123]
    v_cvt_pk_bf16_f32 v73, v102, v103
    v_exp_f32 v105, v105
    v_exp_f32 v106, v106
    v_smfmac_f32_16x16x64_bf16 v[36:39], v[32:35], v[60:67], v159
    v_cvt_pk_bf16_f32 v74, v104, v105
    v_exp_f32 v107, v107
    v_exp_f32 v76, v76
    v_cvt_pk_bf16_f32 v75, v106, v107
    v_mfma_f32_32x32x16_bf16 v[92:107], v[44:47], v[24:27], 0
    v_exp_f32 v77, v77
    v_exp_f32 v78, v78
    s_add_u32 m0, s75, 98304
    s_nop 0
    buffer_load_dwordx4 v5, s[44:47], s80 offen lds
    v_cvt_pk_bf16_f32 v60, v76, v77
    v_mfma_f32_32x32x16_bf16 v[92:107], v[48:51], v[28:31], v[92:107]
    v_exp_f32 v79, v79
    ds_read_b128 v[44:47], v2 offset:20480
    v_exp_f32 v80, v80
    ds_read_b128 v[48:51], v2 offset:21504
    v_cvt_pk_bf16_f32 v61, v78, v79
    v_exp_f32 v81, v81
    s_waitcnt vmcnt(11)
    s_waitcnt lgkmcnt(2)
    v_mfma_f32_32x32x16_bf16 v[192:207], v[160:163], v[140:143], v[192:207]
    v_exp_f32 v82, v82
    v_cvt_pk_bf16_f32 v62, v80, v81
    v_exp_f32 v83, v83
    v_mfma_f32_32x32x16_bf16 v[224:239], v[164:167], v[140:143], v[224:239]
    v_exp_f32 v84, v84
    ds_read_b128 v[140:143], v10 offset:0
    v_cvt_pk_bf16_f32 v63, v82, v83
    s_add_u32 s6, s79, s72
    buffer_load_dwordx4 v[188:191], v4, s[52:55], s6 offen offset:1024 sc1
    s_add_u32 s79, s79, 8192
    s_and_b32 s79, s79, 131071
    v_exp_f32 v85, v85
    v_exp_f32 v86, v86
    v_mfma_f32_32x32x16_bf16 v[124:139], v[52:55], v[68:71], v[124:139]
    v_cvt_pk_bf16_f32 v64, v84, v85
    v_exp_f32 v87, v87
    v_exp_f32 v88, v88
    v_mfma_f32_32x32x16_bf16 v[124:139], v[56:59], v[72:75], v[124:139]
    v_cvt_pk_bf16_f32 v65, v86, v87
    ds_read_b128 v[52:55], v2 offset:18432
    v_exp_f32 v89, v89
    ds_read_b128 v[56:59], v2 offset:19456
    v_exp_f32 v90, v90
    v_smfmac_f32_16x16x64_bf16 v[40:43], v[32:35], v[68:75], v159
    v_cvt_pk_bf16_f32 v66, v88, v89
    v_exp_f32 v91, v91
    v_exp_f32 v92, v92
    v_cvt_pk_bf16_f32 v67, v90, v91
    s_waitcnt lgkmcnt(3)
    v_mfma_f32_32x32x16_bf16 v[76:91], v[44:47], v[16:19], 0
    v_exp_f32 v93, v93
    v_exp_f32 v94, v94
    s_add_u32 m0, s75, 106496
    s_nop 0
    buffer_load_dwordx4 v5, s[48:51], s80 offen lds
    s_add_u32 s80, s80, 128
    s_and_b32 s80, s80, 2047
    v_cvt_pk_bf16_f32 v68, v92, v93
    v_mfma_f32_32x32x16_bf16 v[76:91], v[48:51], v[20:23], v[76:91]
    v_exp_f32 v95, v95
    v_exp_f32 v96, v96
    v_cvt_pk_bf16_f32 v69, v94, v95
    v_exp_f32 v97, v97
    s_waitcnt lgkmcnt(2)
    v_mfma_f32_32x32x16_bf16 v[208:223], v[160:163], v[140:143], v[208:223]
    v_exp_f32 v98, v98
    v_cvt_pk_bf16_f32 v70, v96, v97
    v_exp_f32 v99, v99
    v_mfma_f32_32x32x16_bf16 v[240:255], v[164:167], v[140:143], v[240:255]
    v_exp_f32 v100, v100
    ds_read_b128 v[140:143], v9 offset:0
    v_cvt_pk_bf16_f32 v71, v98, v99
    s_add_u32 s6, s79, s71
    buffer_load_dwordx4 v[160:163], v4, s[52:55], s6 offen offset:0 sc1
    v_exp_f32 v101, v101
    v_exp_f32 v102, v102
    s_waitcnt lgkmcnt(1)
    v_mfma_f32_32x32x16_bf16 v[108:123], v[52:55], v[60:63], v[108:123]
    v_cvt_pk_bf16_f32 v72, v100, v101
    v_exp_f32 v103, v103
    v_exp_f32 v104, v104
    v_mfma_f32_32x32x16_bf16 v[108:123], v[56:59], v[64:67], v[108:123]
    v_cvt_pk_bf16_f32 v73, v102, v103
    v_exp_f32 v105, v105
    v_exp_f32 v106, v106
    v_smfmac_f32_16x16x64_bf16 v[36:39], v[32:35], v[60:67], v159
    v_cvt_pk_bf16_f32 v74, v104, v105
    v_exp_f32 v107, v107
    v_exp_f32 v76, v76
    v_cvt_pk_bf16_f32 v75, v106, v107
    v_mfma_f32_32x32x16_bf16 v[92:107], v[44:47], v[24:27], 0
    v_exp_f32 v77, v77
    v_exp_f32 v78, v78
    v_cvt_pk_bf16_f32 v60, v76, v77
    v_mfma_f32_32x32x16_bf16 v[92:107], v[48:51], v[28:31], v[92:107]
    v_exp_f32 v79, v79
    s_waitcnt vmcnt(9)
    s_barrier
    ds_read_b128 v[44:47], v2 offset:32768
    v_exp_f32 v80, v80
    ds_read_b128 v[48:51], v2 offset:33792
    v_cvt_pk_bf16_f32 v61, v78, v79
    s_add_u32 m0, s76, 0
    s_nop 0
    buffer_load_dwordx4 v4, s[40:43], s77 offen offset:0 sc1 lds
    v_exp_f32 v81, v81
    s_waitcnt lgkmcnt(2)
    v_mfma_f32_32x32x16_bf16 v[192:207], v[168:171], v[140:143], v[192:207]
    v_exp_f32 v82, v82
    v_cvt_pk_bf16_f32 v62, v80, v81
    v_exp_f32 v83, v83
    v_mfma_f32_32x32x16_bf16 v[224:239], v[172:175], v[140:143], v[224:239]
    v_exp_f32 v84, v84
    ds_read_b128 v[140:143], v11 offset:0
    v_cvt_pk_bf16_f32 v63, v82, v83
    s_add_u32 s6, s79, s72
    buffer_load_dwordx4 v[164:167], v4, s[52:55], s6 offen offset:0 sc1
    v_exp_f32 v85, v85
    v_exp_f32 v86, v86
    v_mfma_f32_32x32x16_bf16 v[124:139], v[52:55], v[68:71], v[124:139]
    v_cvt_pk_bf16_f32 v64, v84, v85
    v_exp_f32 v87, v87
    v_exp_f32 v88, v88
    v_mfma_f32_32x32x16_bf16 v[124:139], v[56:59], v[72:75], v[124:139]
    v_cvt_pk_bf16_f32 v65, v86, v87
    ds_read_b128 v[52:55], v2 offset:22528
    v_exp_f32 v89, v89
    ds_read_b128 v[56:59], v2 offset:23552
    v_exp_f32 v90, v90
    v_smfmac_f32_16x16x64_bf16 v[40:43], v[32:35], v[68:75], v159
    v_cvt_pk_bf16_f32 v66, v88, v89
    v_exp_f32 v91, v91
    v_exp_f32 v92, v92
    v_cvt_pk_bf16_f32 v67, v90, v91
    s_waitcnt lgkmcnt(3)
    v_mfma_f32_32x32x16_bf16 v[76:91], v[44:47], v[16:19], 0
    v_exp_f32 v93, v93
    v_exp_f32 v94, v94
    s_add_u32 m0, s76, 0
    s_nop 0
    buffer_load_dwordx4 v4, s[40:43], s77 offen offset:1024 sc1 lds
    s_add_u32 s77, s77, 16384
    s_and_b32 s77, s77, 262143
    v_cvt_pk_bf16_f32 v68, v92, v93
    v_mfma_f32_32x32x16_bf16 v[76:91], v[48:51], v[20:23], v[76:91]
    v_exp_f32 v95, v95
    v_exp_f32 v96, v96
    v_cvt_pk_bf16_f32 v69, v94, v95
    v_exp_f32 v97, v97
    s_waitcnt lgkmcnt(2)
    v_mfma_f32_32x32x16_bf16 v[208:223], v[168:171], v[140:143], v[208:223]
    v_exp_f32 v98, v98
    v_cvt_pk_bf16_f32 v70, v96, v97
    v_exp_f32 v99, v99
    v_mfma_f32_32x32x16_bf16 v[240:255], v[172:175], v[140:143], v[240:255]
    v_exp_f32 v100, v100
    ds_read_b128 v[140:143], v8 offset:16384
    v_cvt_pk_bf16_f32 v71, v98, v99
    s_add_u32 s6, s79, s71
    buffer_load_dwordx4 v[168:171], v4, s[52:55], s6 offen offset:1024 sc1
    v_exp_f32 v101, v101
    v_exp_f32 v102, v102
    s_waitcnt lgkmcnt(1)
    v_mfma_f32_32x32x16_bf16 v[108:123], v[52:55], v[60:63], v[108:123]
    v_cvt_pk_bf16_f32 v72, v100, v101
    v_exp_f32 v103, v103
    v_exp_f32 v104, v104
    v_mfma_f32_32x32x16_bf16 v[108:123], v[56:59], v[64:67], v[108:123]
    v_cvt_pk_bf16_f32 v73, v102, v103
    v_exp_f32 v105, v105
    v_exp_f32 v106, v106
    v_smfmac_f32_16x16x64_bf16 v[36:39], v[32:35], v[60:67], v159
    v_cvt_pk_bf16_f32 v74, v104, v105
    v_exp_f32 v107, v107
    v_exp_f32 v76, v76
    v_cvt_pk_bf16_f32 v75, v106, v107
    v_mfma_f32_32x32x16_bf16 v[92:107], v[44:47], v[24:27], 0
    v_exp_f32 v77, v77
    v_exp_f32 v78, v78
    s_add_u32 m0, s75, 114688
    s_nop 0
    buffer_load_dwordx4 v5, s[44:47], s80 offen lds
    v_cvt_pk_bf16_f32 v60, v76, v77
    v_mfma_f32_32x32x16_bf16 v[92:107], v[48:51], v[28:31], v[92:107]
    v_exp_f32 v79, v79
    ds_read_b128 v[44:47], v2 offset:36864
    v_exp_f32 v80, v80
    ds_read_b128 v[48:51], v2 offset:37888
    v_cvt_pk_bf16_f32 v61, v78, v79
    v_exp_f32 v81, v81
    s_waitcnt vmcnt(11)
    s_waitcnt lgkmcnt(2)
    v_mfma_f32_32x32x16_bf16 v[192:207], v[176:179], v[140:143], v[192:207]
    v_exp_f32 v82, v82
    v_cvt_pk_bf16_f32 v62, v80, v81
    v_exp_f32 v83, v83
    v_mfma_f32_32x32x16_bf16 v[224:239], v[180:183], v[140:143], v[224:239]
    v_exp_f32 v84, v84
    ds_read_b128 v[140:143], v10 offset:16384
    v_cvt_pk_bf16_f32 v63, v82, v83
    s_add_u32 s6, s79, s72
    buffer_load_dwordx4 v[172:175], v4, s[52:55], s6 offen offset:1024 sc1
    s_add_u32 s79, s79, 8192
    s_and_b32 s79, s79, 131071
    v_exp_f32 v85, v85
    v_exp_f32 v86, v86
    v_mfma_f32_32x32x16_bf16 v[124:139], v[52:55], v[68:71], v[124:139]
    v_cvt_pk_bf16_f32 v64, v84, v85
    v_exp_f32 v87, v87
    v_exp_f32 v88, v88
    v_mfma_f32_32x32x16_bf16 v[124:139], v[56:59], v[72:75], v[124:139]
    v_cvt_pk_bf16_f32 v65, v86, v87
    ds_read_b128 v[52:55], v2 offset:34816
    v_exp_f32 v89, v89
    ds_read_b128 v[56:59], v2 offset:35840
    v_exp_f32 v90, v90
    v_smfmac_f32_16x16x64_bf16 v[40:43], v[32:35], v[68:75], v159
    v_cvt_pk_bf16_f32 v66, v88, v89
    v_exp_f32 v91, v91
    v_exp_f32 v92, v92
    v_cvt_pk_bf16_f32 v67, v90, v91
    s_waitcnt lgkmcnt(3)
    v_mfma_f32_32x32x16_bf16 v[76:91], v[44:47], v[16:19], 0
    v_exp_f32 v93, v93
    v_exp_f32 v94, v94
    s_add_u32 m0, s75, 122880
    s_nop 0
    buffer_load_dwordx4 v5, s[48:51], s80 offen lds
    s_add_u32 s80, s80, 128
    s_and_b32 s80, s80, 2047
    v_cvt_pk_bf16_f32 v68, v92, v93
    v_mfma_f32_32x32x16_bf16 v[76:91], v[48:51], v[20:23], v[76:91]
    v_exp_f32 v95, v95
    v_exp_f32 v96, v96
    v_cvt_pk_bf16_f32 v69, v94, v95
    v_exp_f32 v97, v97
    s_waitcnt lgkmcnt(2)
    v_mfma_f32_32x32x16_bf16 v[208:223], v[176:179], v[140:143], v[208:223]
    v_exp_f32 v98, v98
    v_cvt_pk_bf16_f32 v70, v96, v97
    v_exp_f32 v99, v99
    v_mfma_f32_32x32x16_bf16 v[240:255], v[180:183], v[140:143], v[240:255]
    v_exp_f32 v100, v100
    ds_read_b128 v[140:143], v9 offset:16384
    v_cvt_pk_bf16_f32 v71, v98, v99
    s_add_u32 s6, s79, s71
    buffer_load_dwordx4 v[176:179], v4, s[52:55], s6 offen offset:0 sc1
    v_exp_f32 v101, v101
    v_exp_f32 v102, v102
    s_waitcnt lgkmcnt(1)
    v_mfma_f32_32x32x16_bf16 v[108:123], v[52:55], v[60:63], v[108:123]
    v_cvt_pk_bf16_f32 v72, v100, v101
    v_exp_f32 v103, v103
    v_exp_f32 v104, v104
    v_mfma_f32_32x32x16_bf16 v[108:123], v[56:59], v[64:67], v[108:123]
    v_cvt_pk_bf16_f32 v73, v102, v103
    v_exp_f32 v105, v105
    v_exp_f32 v106, v106
    v_smfmac_f32_16x16x64_bf16 v[36:39], v[32:35], v[60:67], v159
    v_cvt_pk_bf16_f32 v74, v104, v105
    v_exp_f32 v107, v107
    v_exp_f32 v76, v76
    v_cvt_pk_bf16_f32 v75, v106, v107
    v_mfma_f32_32x32x16_bf16 v[92:107], v[44:47], v[24:27], 0
    v_exp_f32 v77, v77
    v_exp_f32 v78, v78
    v_cvt_pk_bf16_f32 v60, v76, v77
    v_mfma_f32_32x32x16_bf16 v[92:107], v[48:51], v[28:31], v[92:107]
    v_exp_f32 v79, v79
    s_waitcnt vmcnt(9)
    s_barrier
    ds_read_b128 v[44:47], v2 offset:49152
    v_exp_f32 v80, v80
    ds_read_b128 v[48:51], v2 offset:50176
    v_cvt_pk_bf16_f32 v61, v78, v79
    s_add_u32 m0, s76, 16384
    s_nop 0
    buffer_load_dwordx4 v4, s[40:43], s77 offen offset:0 sc1 lds
    v_exp_f32 v81, v81
    s_waitcnt lgkmcnt(2)
    v_mfma_f32_32x32x16_bf16 v[192:207], v[184:187], v[140:143], v[192:207]
    v_exp_f32 v82, v82
    v_cvt_pk_bf16_f32 v62, v80, v81
    v_exp_f32 v83, v83
    v_mfma_f32_32x32x16_bf16 v[224:239], v[188:191], v[140:143], v[224:239]
    v_exp_f32 v84, v84
    ds_read_b128 v[140:143], v11 offset:16384
    v_cvt_pk_bf16_f32 v63, v82, v83
    s_add_u32 s6, s79, s72
    buffer_load_dwordx4 v[180:183], v4, s[52:55], s6 offen offset:0 sc1
    v_exp_f32 v85, v85
    v_exp_f32 v86, v86
    v_mfma_f32_32x32x16_bf16 v[124:139], v[52:55], v[68:71], v[124:139]
    v_cvt_pk_bf16_f32 v64, v84, v85
    v_exp_f32 v87, v87
    v_exp_f32 v88, v88
    v_mfma_f32_32x32x16_bf16 v[124:139], v[56:59], v[72:75], v[124:139]
    v_cvt_pk_bf16_f32 v65, v86, v87
    ds_read_b128 v[52:55], v2 offset:38912
    v_exp_f32 v89, v89
    ds_read_b128 v[56:59], v2 offset:39936
    v_exp_f32 v90, v90
    v_smfmac_f32_16x16x64_bf16 v[40:43], v[32:35], v[68:75], v159
    v_cvt_pk_bf16_f32 v66, v88, v89
    v_exp_f32 v91, v91
    v_exp_f32 v92, v92
    v_cvt_pk_bf16_f32 v67, v90, v91
    s_waitcnt lgkmcnt(3)
    v_mfma_f32_32x32x16_bf16 v[76:91], v[44:47], v[16:19], 0
    v_exp_f32 v93, v93
    v_exp_f32 v94, v94
    s_add_u32 m0, s76, 16384
    s_nop 0
    buffer_load_dwordx4 v4, s[40:43], s77 offen offset:1024 sc1 lds
    s_add_u32 s77, s77, 16384
    s_and_b32 s77, s77, 262143
    v_cvt_pk_bf16_f32 v68, v92, v93
    v_mfma_f32_32x32x16_bf16 v[76:91], v[48:51], v[20:23], v[76:91]
    v_exp_f32 v95, v95
    v_exp_f32 v96, v96
    v_cvt_pk_bf16_f32 v69, v94, v95
    v_exp_f32 v97, v97
    s_waitcnt lgkmcnt(2)
    v_mfma_f32_32x32x16_bf16 v[208:223], v[184:187], v[140:143], v[208:223]
    v_exp_f32 v98, v98
    v_cvt_pk_bf16_f32 v70, v96, v97
    v_exp_f32 v99, v99
    v_mfma_f32_32x32x16_bf16 v[240:255], v[188:191], v[140:143], v[240:255]
    v_exp_f32 v100, v100
    ds_read_b128 v[140:143], v8 offset:32768
    v_cvt_pk_bf16_f32 v71, v98, v99
    s_add_u32 s6, s79, s71
    buffer_load_dwordx4 v[184:187], v4, s[52:55], s6 offen offset:1024 sc1
    v_exp_f32 v101, v101
    v_exp_f32 v102, v102
    s_waitcnt lgkmcnt(1)
    v_mfma_f32_32x32x16_bf16 v[108:123], v[52:55], v[60:63], v[108:123]
    v_cvt_pk_bf16_f32 v72, v100, v101
    v_exp_f32 v103, v103
    v_exp_f32 v104, v104
    v_mfma_f32_32x32x16_bf16 v[108:123], v[56:59], v[64:67], v[108:123]
    v_cvt_pk_bf16_f32 v73, v102, v103
    v_exp_f32 v105, v105
    v_exp_f32 v106, v106
    v_smfmac_f32_16x16x64_bf16 v[36:39], v[32:35], v[60:67], v159
    v_cvt_pk_bf16_f32 v74, v104, v105
    v_exp_f32 v107, v107
    v_exp_f32 v76, v76
    v_cvt_pk_bf16_f32 v75, v106, v107
    v_mfma_f32_32x32x16_bf16 v[92:107], v[44:47], v[24:27], 0
    v_exp_f32 v77, v77
    v_exp_f32 v78, v78
    s_add_u32 m0, s75, 65536
    s_nop 0
    buffer_load_dwordx4 v5, s[44:47], s80 offen lds
    v_cvt_pk_bf16_f32 v60, v76, v77
    v_mfma_f32_32x32x16_bf16 v[92:107], v[48:51], v[28:31], v[92:107]
    v_exp_f32 v79, v79
    ds_read_b128 v[44:47], v2 offset:53248
    v_exp_f32 v80, v80
    ds_read_b128 v[48:51], v2 offset:54272
    v_cvt_pk_bf16_f32 v61, v78, v79
    v_exp_f32 v81, v81
    s_waitcnt vmcnt(11)
    s_waitcnt lgkmcnt(2)
    v_mfma_f32_32x32x16_bf16 v[192:207], v[160:163], v[140:143], v[192:207]
    v_exp_f32 v82, v82
    v_cvt_pk_bf16_f32 v62, v80, v81
    v_exp_f32 v83, v83
    v_mfma_f32_32x32x16_bf16 v[224:239], v[164:167], v[140:143], v[224:239]
    v_exp_f32 v84, v84
    ds_read_b128 v[140:143], v10 offset:32768
    v_cvt_pk_bf16_f32 v63, v82, v83
    s_add_u32 s6, s79, s72
    buffer_load_dwordx4 v[188:191], v4, s[52:55], s6 offen offset:1024 sc1
    s_add_u32 s79, s79, 8192
    s_and_b32 s79, s79, 131071
    v_exp_f32 v85, v85
    v_exp_f32 v86, v86
    v_mfma_f32_32x32x16_bf16 v[124:139], v[52:55], v[68:71], v[124:139]
    v_cvt_pk_bf16_f32 v64, v84, v85
    v_exp_f32 v87, v87
    v_exp_f32 v88, v88
    v_mfma_f32_32x32x16_bf16 v[124:139], v[56:59], v[72:75], v[124:139]
    v_cvt_pk_bf16_f32 v65, v86, v87
    ds_read_b128 v[52:55], v2 offset:51200
    v_exp_f32 v89, v89
    ds_read_b128 v[56:59], v2 offset:52224
    v_exp_f32 v90, v90
    v_smfmac_f32_16x16x64_bf16 v[40:43], v[32:35], v[68:75], v159
    v_cvt_pk_bf16_f32 v66, v88, v89
    v_exp_f32 v91, v91
    v_exp_f32 v92, v92
    v_cvt_pk_bf16_f32 v67, v90, v91
    s_waitcnt lgkmcnt(3)
    v_mfma_f32_32x32x16_bf16 v[76:91], v[44:47], v[16:19], 0
    v_exp_f32 v93, v93
    v_exp_f32 v94, v94
    s_add_u32 m0, s75, 73728
    s_nop 0
    buffer_load_dwordx4 v5, s[48:51], s80 offen lds
    s_add_u32 s80, s80, 128
    s_and_b32 s80, s80, 2047
    v_cvt_pk_bf16_f32 v68, v92, v93
    v_mfma_f32_32x32x16_bf16 v[76:91], v[48:51], v[20:23], v[76:91]
    v_exp_f32 v95, v95
    v_exp_f32 v96, v96
    v_cvt_pk_bf16_f32 v69, v94, v95
    v_exp_f32 v97, v97
    s_waitcnt lgkmcnt(2)
    v_mfma_f32_32x32x16_bf16 v[208:223], v[160:163], v[140:143], v[208:223]
    v_exp_f32 v98, v98
    v_cvt_pk_bf16_f32 v70, v96, v97
    v_exp_f32 v99, v99
    v_mfma_f32_32x32x16_bf16 v[240:255], v[164:167], v[140:143], v[240:255]
    v_exp_f32 v100, v100
    ds_read_b128 v[140:143], v9 offset:32768
    v_cvt_pk_bf16_f32 v71, v98, v99
    s_add_u32 s6, s79, s71
    buffer_load_dwordx4 v[160:163], v4, s[52:55], s6 offen offset:0 sc1
    v_exp_f32 v101, v101
    v_exp_f32 v102, v102
    s_waitcnt lgkmcnt(1)
    v_mfma_f32_32x32x16_bf16 v[108:123], v[52:55], v[60:63], v[108:123]
    v_cvt_pk_bf16_f32 v72, v100, v101
    v_exp_f32 v103, v103
    v_exp_f32 v104, v104
    v_mfma_f32_32x32x16_bf16 v[108:123], v[56:59], v[64:67], v[108:123]
    v_cvt_pk_bf16_f32 v73, v102, v103
    v_exp_f32 v105, v105
    v_exp_f32 v106, v106
    v_smfmac_f32_16x16x64_bf16 v[36:39], v[32:35], v[60:67], v159
    v_cvt_pk_bf16_f32 v74, v104, v105
    v_exp_f32 v107, v107
    v_exp_f32 v76, v76
    v_cvt_pk_bf16_f32 v75, v106, v107
    v_mfma_f32_32x32x16_bf16 v[92:107], v[44:47], v[24:27], 0
    v_exp_f32 v77, v77
    v_exp_f32 v78, v78
    v_cvt_pk_bf16_f32 v60, v76, v77
    v_mfma_f32_32x32x16_bf16 v[92:107], v[48:51], v[28:31], v[92:107]
    v_exp_f32 v79, v79
    s_waitcnt vmcnt(9)
    s_barrier
    ds_read_b128 v[44:47], v2 offset:0
    v_exp_f32 v80, v80
    ds_read_b128 v[48:51], v2 offset:1024
    v_cvt_pk_bf16_f32 v61, v78, v79
    s_add_u32 m0, s76, 32768
    s_nop 0
    buffer_load_dwordx4 v4, s[40:43], s77 offen offset:0 sc1 lds
    v_exp_f32 v81, v81
    s_waitcnt lgkmcnt(2)
    v_mfma_f32_32x32x16_bf16 v[192:207], v[168:171], v[140:143], v[192:207]
    v_exp_f32 v82, v82
    v_cvt_pk_bf16_f32 v62, v80, v81
    v_exp_f32 v83, v83
    v_mfma_f32_32x32x16_bf16 v[224:239], v[172:175], v[140:143], v[224:239]
    v_exp_f32 v84, v84
    ds_read_b128 v[140:143], v11 offset:32768
    v_cvt_pk_bf16_f32 v63, v82, v83
    s_add_u32 s6, s79, s72
    buffer_load_dwordx4 v[164:167], v4, s[52:55], s6 offen offset:0 sc1
    v_exp_f32 v85, v85
    v_exp_f32 v86, v86
    v_mfma_f32_32x32x16_bf16 v[124:139], v[52:55], v[68:71], v[124:139]
    v_cvt_pk_bf16_f32 v64, v84, v85
    v_exp_f32 v87, v87
    v_exp_f32 v88, v88
    v_mfma_f32_32x32x16_bf16 v[124:139], v[56:59], v[72:75], v[124:139]
    v_cvt_pk_bf16_f32 v65, v86, v87
    ds_read_b128 v[52:55], v2 offset:55296
    v_exp_f32 v89, v89
    ds_read_b128 v[56:59], v2 offset:56320
    v_exp_f32 v90, v90
    v_smfmac_f32_16x16x64_bf16 v[40:43], v[32:35], v[68:75], v159
    v_cvt_pk_bf16_f32 v66, v88, v89
    v_exp_f32 v91, v91
    v_exp_f32 v92, v92
    v_cvt_pk_bf16_f32 v67, v90, v91
    s_waitcnt lgkmcnt(3)
    v_mfma_f32_32x32x16_bf16 v[76:91], v[44:47], v[16:19], 0
    v_exp_f32 v93, v93
    v_exp_f32 v94, v94
    s_add_u32 m0, s76, 32768
    s_nop 0
    buffer_load_dwordx4 v4, s[40:43], s77 offen offset:1024 sc1 lds
    s_add_u32 s77, s77, 16384
    s_and_b32 s77, s77, 262143
    v_cvt_pk_bf16_f32 v68, v92, v93
    v_mfma_f32_32x32x16_bf16 v[76:91], v[48:51], v[20:23], v[76:91]
    v_exp_f32 v95, v95
    v_exp_f32 v96, v96
    v_cvt_pk_bf16_f32 v69, v94, v95
    v_exp_f32 v97, v97
    s_waitcnt lgkmcnt(2)
    v_mfma_f32_32x32x16_bf16 v[208:223], v[168:171], v[140:143], v[208:223]
    v_exp_f32 v98, v98
    v_cvt_pk_bf16_f32 v70, v96, v97
    v_exp_f32 v99, v99
    v_mfma_f32_32x32x16_bf16 v[240:255], v[172:175], v[140:143], v[240:255]
    v_exp_f32 v100, v100
    ds_read_b128 v[140:143], v8 offset:49152
    v_cvt_pk_bf16_f32 v71, v98, v99
    s_add_u32 s6, s79, s71
    buffer_load_dwordx4 v[168:171], v4, s[52:55], s6 offen offset:1024 sc1
    v_exp_f32 v101, v101
    v_exp_f32 v102, v102
    s_waitcnt lgkmcnt(1)
    v_mfma_f32_32x32x16_bf16 v[108:123], v[52:55], v[60:63], v[108:123]
    v_cvt_pk_bf16_f32 v72, v100, v101
    v_exp_f32 v103, v103
    v_exp_f32 v104, v104
    v_mfma_f32_32x32x16_bf16 v[108:123], v[56:59], v[64:67], v[108:123]
    v_cvt_pk_bf16_f32 v73, v102, v103
    v_exp_f32 v105, v105
    v_exp_f32 v106, v106
    v_smfmac_f32_16x16x64_bf16 v[36:39], v[32:35], v[60:67], v159
    v_cvt_pk_bf16_f32 v74, v104, v105
    v_exp_f32 v107, v107
    v_exp_f32 v76, v76
    v_cvt_pk_bf16_f32 v75, v106, v107
    v_mfma_f32_32x32x16_bf16 v[92:107], v[44:47], v[24:27], 0
    v_exp_f32 v77, v77
    v_exp_f32 v78, v78
    s_add_u32 m0, s75, 81920
    s_nop 0
    buffer_load_dwordx4 v5, s[44:47], s80 offen lds
    v_cvt_pk_bf16_f32 v60, v76, v77
    v_mfma_f32_32x32x16_bf16 v[92:107], v[48:51], v[28:31], v[92:107]
    v_exp_f32 v79, v79
    ds_read_b128 v[44:47], v2 offset:4096
    v_exp_f32 v80, v80
    ds_read_b128 v[48:51], v2 offset:5120
    v_cvt_pk_bf16_f32 v61, v78, v79
    v_exp_f32 v81, v81
    s_waitcnt vmcnt(11)
    s_waitcnt lgkmcnt(2)
    v_mfma_f32_32x32x16_bf16 v[192:207], v[176:179], v[140:143], v[192:207]
    v_exp_f32 v82, v82
    v_cvt_pk_bf16_f32 v62, v80, v81
    v_exp_f32 v83, v83
    v_mfma_f32_32x32x16_bf16 v[224:239], v[180:183], v[140:143], v[224:239]
    v_exp_f32 v84, v84
    ds_read_b128 v[140:143], v10 offset:49152
    v_cvt_pk_bf16_f32 v63, v82, v83
    s_add_u32 s6, s79, s72
    buffer_load_dwordx4 v[172:175], v4, s[52:55], s6 offen offset:1024 sc1
    s_add_u32 s79, s79, 8192
    s_and_b32 s79, s79, 131071
    v_exp_f32 v85, v85
    v_exp_f32 v86, v86
    v_mfma_f32_32x32x16_bf16 v[124:139], v[52:55], v[68:71], v[124:139]
    v_cvt_pk_bf16_f32 v64, v84, v85
    v_exp_f32 v87, v87
    v_exp_f32 v88, v88
    v_mfma_f32_32x32x16_bf16 v[124:139], v[56:59], v[72:75], v[124:139]
    v_cvt_pk_bf16_f32 v65, v86, v87
    ds_read_b128 v[52:55], v2 offset:2048
    v_exp_f32 v89, v89
    ds_read_b128 v[56:59], v2 offset:3072
    v_exp_f32 v90, v90
    v_smfmac_f32_16x16x64_bf16 v[40:43], v[32:35], v[68:75], v159
    v_cvt_pk_bf16_f32 v66, v88, v89
    v_exp_f32 v91, v91
    v_exp_f32 v92, v92
    v_cvt_pk_bf16_f32 v67, v90, v91
    s_waitcnt lgkmcnt(3)
    v_mfma_f32_32x32x16_bf16 v[76:91], v[44:47], v[16:19], 0
    v_exp_f32 v93, v93
    v_exp_f32 v94, v94
    s_add_u32 m0, s75, 90112
    s_nop 0
    buffer_load_dwordx4 v5, s[48:51], s80 offen lds
    s_add_u32 s80, s80, 128
    s_and_b32 s80, s80, 2047
    v_cvt_pk_bf16_f32 v68, v92, v93
    v_mfma_f32_32x32x16_bf16 v[76:91], v[48:51], v[20:23], v[76:91]
    v_exp_f32 v95, v95
    v_exp_f32 v96, v96
    v_cvt_pk_bf16_f32 v69, v94, v95
    v_exp_f32 v97, v97
    s_waitcnt lgkmcnt(2)
    v_mfma_f32_32x32x16_bf16 v[208:223], v[176:179], v[140:143], v[208:223]
    v_exp_f32 v98, v98
    v_cvt_pk_bf16_f32 v70, v96, v97
    v_exp_f32 v99, v99
    v_mfma_f32_32x32x16_bf16 v[240:255], v[180:183], v[140:143], v[240:255]
    v_exp_f32 v100, v100
    ds_read_b128 v[140:143], v9 offset:49152
    v_cvt_pk_bf16_f32 v71, v98, v99
    s_add_u32 s6, s79, s71
    buffer_load_dwordx4 v[176:179], v4, s[52:55], s6 offen offset:0 sc1
    v_exp_f32 v101, v101
    v_exp_f32 v102, v102
    s_waitcnt lgkmcnt(1)
    v_mfma_f32_32x32x16_bf16 v[108:123], v[52:55], v[60:63], v[108:123]
    v_cvt_pk_bf16_f32 v72, v100, v101
    v_exp_f32 v103, v103
    v_exp_f32 v104, v104
    v_mfma_f32_32x32x16_bf16 v[108:123], v[56:59], v[64:67], v[108:123]
    v_cvt_pk_bf16_f32 v73, v102, v103
    v_exp_f32 v105, v105
    v_exp_f32 v106, v106
    v_smfmac_f32_16x16x64_bf16 v[36:39], v[32:35], v[60:67], v159
    v_cvt_pk_bf16_f32 v74, v104, v105
    v_exp_f32 v107, v107
    v_exp_f32 v76, v76
    v_cvt_pk_bf16_f32 v75, v106, v107
    v_mfma_f32_32x32x16_bf16 v[92:107], v[44:47], v[24:27], 0
    v_exp_f32 v77, v77
    v_exp_f32 v78, v78
    v_cvt_pk_bf16_f32 v60, v76, v77
    v_mfma_f32_32x32x16_bf16 v[92:107], v[48:51], v[28:31], v[92:107]
    v_exp_f32 v79, v79
    s_waitcnt vmcnt(9)
    s_barrier
    ds_read_b128 v[44:47], v2 offset:16384
    v_exp_f32 v80, v80
    ds_read_b128 v[48:51], v2 offset:17408
    v_cvt_pk_bf16_f32 v61, v78, v79
    s_add_u32 m0, s76, 49152
    s_nop 0
    buffer_load_dwordx4 v4, s[40:43], s77 offen offset:0 sc1 lds
    v_exp_f32 v81, v81
    s_waitcnt lgkmcnt(2)
    v_mfma_f32_32x32x16_bf16 v[192:207], v[184:187], v[140:143], v[192:207]
    v_exp_f32 v82, v82
    v_cvt_pk_bf16_f32 v62, v80, v81
    v_exp_f32 v83, v83
    v_mfma_f32_32x32x16_bf16 v[224:239], v[188:191], v[140:143], v[224:239]
    v_exp_f32 v84, v84
    ds_read_b128 v[140:143], v11 offset:49152
    v_cvt_pk_bf16_f32 v63, v82, v83
    s_add_u32 s6, s79, s72
    buffer_load_dwordx4 v[180:183], v4, s[52:55], s6 offen offset:0 sc1
    v_exp_f32 v85, v85
    v_exp_f32 v86, v86
    v_mfma_f32_32x32x16_bf16 v[124:139], v[52:55], v[68:71], v[124:139]
    v_cvt_pk_bf16_f32 v64, v84, v85
    v_exp_f32 v87, v87
    v_exp_f32 v88, v88
    v_mfma_f32_32x32x16_bf16 v[124:139], v[56:59], v[72:75], v[124:139]
    v_cvt_pk_bf16_f32 v65, v86, v87
    ds_read_b128 v[52:55], v2 offset:6144
    v_exp_f32 v89, v89
    ds_read_b128 v[56:59], v2 offset:7168
    v_exp_f32 v90, v90
    v_smfmac_f32_16x16x64_bf16 v[40:43], v[32:35], v[68:75], v159
    v_cvt_pk_bf16_f32 v66, v88, v89
    v_exp_f32 v91, v91
    v_exp_f32 v92, v92
    v_cvt_pk_bf16_f32 v67, v90, v91
    s_waitcnt lgkmcnt(3)
    v_mfma_f32_32x32x16_bf16 v[76:91], v[44:47], v[16:19], 0
    v_exp_f32 v93, v93
    v_exp_f32 v94, v94
    s_add_u32 m0, s76, 49152
    s_nop 0
    buffer_load_dwordx4 v4, s[40:43], s77 offen offset:1024 sc1 lds
    s_add_u32 s77, s77, 16384
    s_and_b32 s77, s77, 262143
    v_cvt_pk_bf16_f32 v68, v92, v93
    v_mfma_f32_32x32x16_bf16 v[76:91], v[48:51], v[20:23], v[76:91]
    v_exp_f32 v95, v95
    v_exp_f32 v96, v96
    v_cvt_pk_bf16_f32 v69, v94, v95
    v_exp_f32 v97, v97
    s_waitcnt lgkmcnt(2)
    v_mfma_f32_32x32x16_bf16 v[208:223], v[184:187], v[140:143], v[208:223]
    v_exp_f32 v98, v98
    v_cvt_pk_bf16_f32 v70, v96, v97
    v_exp_f32 v99, v99
    v_mfma_f32_32x32x16_bf16 v[240:255], v[188:191], v[140:143], v[240:255]
    v_exp_f32 v100, v100
    ds_read_b128 v[140:143], v8 offset:0
    v_cvt_pk_bf16_f32 v71, v98, v99
    s_add_u32 s6, s79, s71
    buffer_load_dwordx4 v[184:187], v4, s[52:55], s6 offen offset:1024 sc1
    v_exp_f32 v101, v101
    v_exp_f32 v102, v102
    s_waitcnt lgkmcnt(1)
    v_mfma_f32_32x32x16_bf16 v[108:123], v[52:55], v[60:63], v[108:123]
    v_cvt_pk_bf16_f32 v72, v100, v101
    v_exp_f32 v103, v103
    v_exp_f32 v104, v104
    v_mfma_f32_32x32x16_bf16 v[108:123], v[56:59], v[64:67], v[108:123]
    v_cvt_pk_bf16_f32 v73, v102, v103
    v_exp_f32 v105, v105
    v_exp_f32 v106, v106
    v_smfmac_f32_16x16x64_bf16 v[36:39], v[32:35], v[60:67], v159
    v_cvt_pk_bf16_f32 v74, v104, v105
    v_exp_f32 v107, v107
    v_exp_f32 v76, v76
    v_cvt_pk_bf16_f32 v75, v106, v107
    v_mfma_f32_32x32x16_bf16 v[92:107], v[44:47], v[24:27], 0
    v_exp_f32 v77, v77
    v_exp_f32 v78, v78
    s_add_u32 m0, s75, 98304
    s_nop 0
    buffer_load_dwordx4 v5, s[44:47], s80 offen lds
    v_cvt_pk_bf16_f32 v60, v76, v77
    v_mfma_f32_32x32x16_bf16 v[92:107], v[48:51], v[28:31], v[92:107]
    v_exp_f32 v79, v79
    ds_read_b128 v[44:47], v2 offset:20480
    v_exp_f32 v80, v80
    ds_read_b128 v[48:51], v2 offset:21504
    v_cvt_pk_bf16_f32 v61, v78, v79
    v_exp_f32 v81, v81
    s_waitcnt vmcnt(11)
    s_waitcnt lgkmcnt(2)
    v_mfma_f32_32x32x16_bf16 v[192:207], v[160:163], v[140:143], v[192:207]
    v_exp_f32 v82, v82
    v_cvt_pk_bf16_f32 v62, v80, v81
    v_exp_f32 v83, v83
    v_mfma_f32_32x32x16_bf16 v[224:239], v[164:167], v[140:143], v[224:239]
    v_exp_f32 v84, v84
    ds_read_b128 v[140:143], v10 offset:0
    v_cvt_pk_bf16_f32 v63, v82, v83
    s_add_u32 s6, s79, s72
    buffer_load_dwordx4 v[188:191], v4, s[52:55], s6 offen offset:1024 sc1
    s_add_u32 s79, s79, 8192
    s_and_b32 s79, s79, 131071
    v_exp_f32 v85, v85
    v_exp_f32 v86, v86
    v_mfma_f32_32x32x16_bf16 v[124:139], v[52:55], v[68:71], v[124:139]
    v_cvt_pk_bf16_f32 v64, v84, v85
    v_exp_f32 v87, v87
    v_exp_f32 v88, v88
    v_mfma_f32_32x32x16_bf16 v[124:139], v[56:59], v[72:75], v[124:139]
    v_cvt_pk_bf16_f32 v65, v86, v87
    ds_read_b128 v[52:55], v2 offset:18432
    v_exp_f32 v89, v89
    ds_read_b128 v[56:59], v2 offset:19456
    v_exp_f32 v90, v90
    v_smfmac_f32_16x16x64_bf16 v[40:43], v[32:35], v[68:75], v159
    v_cvt_pk_bf16_f32 v66, v88, v89
    v_exp_f32 v91, v91
    v_exp_f32 v92, v92
    v_cvt_pk_bf16_f32 v67, v90, v91
    s_waitcnt lgkmcnt(3)
    v_mfma_f32_32x32x16_bf16 v[76:91], v[44:47], v[16:19], 0
    v_exp_f32 v93, v93
    v_exp_f32 v94, v94
    s_add_u32 m0, s75, 106496
    s_nop 0
    buffer_load_dwordx4 v5, s[48:51], s80 offen lds
    s_add_u32 s80, s80, 128
    s_and_b32 s80, s80, 2047
    v_cvt_pk_bf16_f32 v68, v92, v93
    v_mfma_f32_32x32x16_bf16 v[76:91], v[48:51], v[20:23], v[76:91]
    v_exp_f32 v95, v95
    v_exp_f32 v96, v96
    v_cvt_pk_bf16_f32 v69, v94, v95
    v_exp_f32 v97, v97
    s_waitcnt lgkmcnt(2)
    v_mfma_f32_32x32x16_bf16 v[208:223], v[160:163], v[140:143], v[208:223]
    v_exp_f32 v98, v98
    v_cvt_pk_bf16_f32 v70, v96, v97
    v_exp_f32 v99, v99
    v_mfma_f32_32x32x16_bf16 v[240:255], v[164:167], v[140:143], v[240:255]
    v_exp_f32 v100, v100
    ds_read_b128 v[140:143], v9 offset:0
    v_cvt_pk_bf16_f32 v71, v98, v99
    s_add_u32 s6, s79, s71
    buffer_load_dwordx4 v[160:163], v4, s[52:55], s6 offen offset:0 sc1
    v_exp_f32 v101, v101
    v_exp_f32 v102, v102
    s_waitcnt lgkmcnt(1)
    v_mfma_f32_32x32x16_bf16 v[108:123], v[52:55], v[60:63], v[108:123]
    v_cvt_pk_bf16_f32 v72, v100, v101
    v_exp_f32 v103, v103
    v_exp_f32 v104, v104
    v_mfma_f32_32x32x16_bf16 v[108:123], v[56:59], v[64:67], v[108:123]
    v_cvt_pk_bf16_f32 v73, v102, v103
    v_exp_f32 v105, v105
    v_exp_f32 v106, v106
    v_smfmac_f32_16x16x64_bf16 v[36:39], v[32:35], v[60:67], v159
    v_cvt_pk_bf16_f32 v74, v104, v105
    v_exp_f32 v107, v107
    v_exp_f32 v76, v76
    v_cvt_pk_bf16_f32 v75, v106, v107
    v_mfma_f32_32x32x16_bf16 v[92:107], v[44:47], v[24:27], 0
    v_exp_f32 v77, v77
    v_exp_f32 v78, v78
    v_cvt_pk_bf16_f32 v60, v76, v77
    v_mfma_f32_32x32x16_bf16 v[92:107], v[48:51], v[28:31], v[92:107]
    v_exp_f32 v79, v79
    s_waitcnt vmcnt(9)
    s_barrier
    ds_read_b128 v[44:47], v2 offset:32768
    v_exp_f32 v80, v80
    ds_read_b128 v[48:51], v2 offset:33792
    v_cvt_pk_bf16_f32 v61, v78, v79
    s_add_u32 m0, s76, 0
    s_lshl_b32 s6, s82, 18
    buffer_load_dwordx4 v6, s[56:59], s6 offen lds
    v_exp_f32 v81, v81
    s_waitcnt lgkmcnt(2)
    v_mfma_f32_32x32x16_bf16 v[192:207], v[168:171], v[140:143], v[192:207]
    v_exp_f32 v82, v82
    v_cvt_pk_bf16_f32 v62, v80, v81
    v_exp_f32 v83, v83
    v_mfma_f32_32x32x16_bf16 v[224:239], v[172:175], v[140:143], v[224:239]
    v_exp_f32 v84, v84
    ds_read_b128 v[140:143], v11 offset:0
    v_cvt_pk_bf16_f32 v63, v82, v83
    s_add_u32 s6, s79, s72
    buffer_load_dwordx4 v[164:167], v4, s[52:55], s6 offen offset:0 sc1
    v_exp_f32 v85, v85
    v_exp_f32 v86, v86
    v_mfma_f32_32x32x16_bf16 v[124:139], v[52:55], v[68:71], v[124:139]
    v_cvt_pk_bf16_f32 v64, v84, v85
    v_exp_f32 v87, v87
    v_exp_f32 v88, v88
    v_mfma_f32_32x32x16_bf16 v[124:139], v[56:59], v[72:75], v[124:139]
    v_cvt_pk_bf16_f32 v65, v86, v87
    ds_read_b128 v[52:55], v2 offset:22528
    v_exp_f32 v89, v89
    ds_read_b128 v[56:59], v2 offset:23552
    v_exp_f32 v90, v90
    v_smfmac_f32_16x16x64_bf16 v[40:43], v[32:35], v[68:75], v159
    v_cvt_pk_bf16_f32 v66, v88, v89
    v_exp_f32 v91, v91
    v_exp_f32 v92, v92
    v_cvt_pk_bf16_f32 v67, v90, v91
    s_waitcnt lgkmcnt(3)
    v_mfma_f32_32x32x16_bf16 v[76:91], v[44:47], v[16:19], 0
    v_exp_f32 v93, v93
    v_exp_f32 v94, v94
    s_add_u32 m0, s76, 1024
    s_lshl_b32 s6, s82, 18
    buffer_load_dwordx4 v7, s[56:59], s6 offen lds
    s_add_u32 s82, s82, 1
    s_and_b32 s82, s82, 7
    v_cvt_pk_bf16_f32 v68, v92, v93
    v_mfma_f32_32x32x16_bf16 v[76:91], v[48:51], v[20:23], v[76:91]
    v_exp_f32 v95, v95
    v_exp_f32 v96, v96
    v_cvt_pk_bf16_f32 v69, v94, v95
    v_exp_f32 v97, v97
    s_waitcnt lgkmcnt(2)
    v_mfma_f32_32x32x16_bf16 v[208:223], v[168:171], v[140:143], v[208:223]
    v_exp_f32 v98, v98
    v_cvt_pk_bf16_f32 v70, v96, v97
    v_exp_f32 v99, v99
    v_mfma_f32_32x32x16_bf16 v[240:255], v[172:175], v[140:143], v[240:255]
    v_exp_f32 v100, v100
    ds_read_b128 v[140:143], v8 offset:16384
    v_cvt_pk_bf16_f32 v71, v98, v99
    s_add_u32 s6, s79, s71
    buffer_load_dwordx4 v[168:171], v4, s[52:55], s6 offen offset:1024 sc1
    v_exp_f32 v101, v101
    v_exp_f32 v102, v102
    s_waitcnt lgkmcnt(1)
    v_mfma_f32_32x32x16_bf16 v[108:123], v[52:55], v[60:63], v[108:123]
    v_cvt_pk_bf16_f32 v72, v100, v101
    v_exp_f32 v103, v103
    v_exp_f32 v104, v104
    v_mfma_f32_32x32x16_bf16 v[108:123], v[56:59], v[64:67], v[108:123]
    v_cvt_pk_bf16_f32 v73, v102, v103
    v_exp_f32 v105, v105
    v_exp_f32 v106, v106
    v_smfmac_f32_16x16x64_bf16 v[36:39], v[32:35], v[60:67], v159
    v_cvt_pk_bf16_f32 v74, v104, v105
    v_exp_f32 v107, v107
    v_exp_f32 v76, v76
    v_cvt_pk_bf16_f32 v75, v106, v107
    v_mfma_f32_32x32x16_bf16 v[92:107], v[44:47], v[24:27], 0
    v_exp_f32 v77, v77
    v_exp_f32 v78, v78
    s_add_u32 m0, s75, 114688
    s_nop 0
    buffer_load_dwordx4 v5, s[44:47], s80 offen lds
    v_cvt_pk_bf16_f32 v60, v76, v77
    v_mfma_f32_32x32x16_bf16 v[92:107], v[48:51], v[28:31], v[92:107]
    v_exp_f32 v79, v79
    ds_read_b128 v[44:47], v2 offset:36864
    v_exp_f32 v80, v80
    ds_read_b128 v[48:51], v2 offset:37888
    v_cvt_pk_bf16_f32 v61, v78, v79
    v_exp_f32 v81, v81
    s_waitcnt vmcnt(11)
    s_waitcnt lgkmcnt(2)
    v_mfma_f32_32x32x16_bf16 v[192:207], v[176:179], v[140:143], v[192:207]
    v_exp_f32 v82, v82
    v_cvt_pk_bf16_f32 v62, v80, v81
    v_exp_f32 v83, v83
    v_mfma_f32_32x32x16_bf16 v[224:239], v[180:183], v[140:143], v[224:239]
    v_exp_f32 v84, v84
    ds_read_b128 v[140:143], v10 offset:16384
    v_cvt_pk_bf16_f32 v63, v82, v83
    s_add_u32 s6, s79, s72
    buffer_load_dwordx4 v[172:175], v4, s[52:55], s6 offen offset:1024 sc1
    s_add_u32 s79, s79, 8192
    s_and_b32 s79, s79, 131071
    v_exp_f32 v85, v85
    v_exp_f32 v86, v86
    v_mfma_f32_32x32x16_bf16 v[124:139], v[52:55], v[68:71], v[124:139]
    v_cvt_pk_bf16_f32 v64, v84, v85
    v_exp_f32 v87, v87
    v_exp_f32 v88, v88
    v_mfma_f32_32x32x16_bf16 v[124:139], v[56:59], v[72:75], v[124:139]
    v_cvt_pk_bf16_f32 v65, v86, v87
    ds_read_b128 v[52:55], v2 offset:34816
    v_exp_f32 v89, v89
    ds_read_b128 v[56:59], v2 offset:35840
    v_exp_f32 v90, v90
    v_smfmac_f32_16x16x64_bf16 v[40:43], v[32:35], v[68:75], v159
    v_cvt_pk_bf16_f32 v66, v88, v89
    v_exp_f32 v91, v91
    v_exp_f32 v92, v92
    v_cvt_pk_bf16_f32 v67, v90, v91
    s_waitcnt lgkmcnt(3)
    v_mfma_f32_32x32x16_bf16 v[76:91], v[44:47], v[16:19], 0
    v_exp_f32 v93, v93
    v_exp_f32 v94, v94
    s_add_u32 m0, s75, 122880
    s_nop 0
    buffer_load_dwordx4 v5, s[48:51], s80 offen lds
    s_add_u32 s80, s80, 128
    s_and_b32 s80, s80, 2047
    v_cvt_pk_bf16_f32 v68, v92, v93
    v_mfma_f32_32x32x16_bf16 v[76:91], v[48:51], v[20:23], v[76:91]
    v_exp_f32 v95, v95
    v_exp_f32 v96, v96
    v_cvt_pk_bf16_f32 v69, v94, v95
    v_exp_f32 v97, v97
    s_waitcnt lgkmcnt(2)
    v_mfma_f32_32x32x16_bf16 v[208:223], v[176:179], v[140:143], v[208:223]
    v_exp_f32 v98, v98
    v_cvt_pk_bf16_f32 v70, v96, v97
    v_exp_f32 v99, v99
    v_mfma_f32_32x32x16_bf16 v[240:255], v[180:183], v[140:143], v[240:255]
    v_exp_f32 v100, v100
    ds_read_b128 v[140:143], v9 offset:16384
    v_cvt_pk_bf16_f32 v71, v98, v99
    s_add_u32 s6, s79, s71
    buffer_load_dwordx4 v[176:179], v4, s[52:55], s6 offen offset:0 sc1
    v_exp_f32 v101, v101
    v_exp_f32 v102, v102
    s_waitcnt lgkmcnt(1)
    v_mfma_f32_32x32x16_bf16 v[108:123], v[52:55], v[60:63], v[108:123]
    v_cvt_pk_bf16_f32 v72, v100, v101
    v_exp_f32 v103, v103
    v_exp_f32 v104, v104
    v_mfma_f32_32x32x16_bf16 v[108:123], v[56:59], v[64:67], v[108:123]
    v_cvt_pk_bf16_f32 v73, v102, v103
    v_exp_f32 v105, v105
    v_exp_f32 v106, v106
    v_smfmac_f32_16x16x64_bf16 v[36:39], v[32:35], v[60:67], v159
    v_cvt_pk_bf16_f32 v74, v104, v105
    v_exp_f32 v107, v107
    v_exp_f32 v76, v76
    v_cvt_pk_bf16_f32 v75, v106, v107
    v_mfma_f32_32x32x16_bf16 v[92:107], v[44:47], v[24:27], 0
    v_exp_f32 v77, v77
    v_exp_f32 v78, v78
    v_cvt_pk_bf16_f32 v60, v76, v77
    v_mfma_f32_32x32x16_bf16 v[92:107], v[48:51], v[28:31], v[92:107]
    v_exp_f32 v79, v79
    s_waitcnt vmcnt(9)
    s_barrier
    ds_read_b128 v[44:47], v2 offset:49152
    v_exp_f32 v80, v80
    ds_read_b128 v[48:51], v2 offset:50176
    v_cvt_pk_bf16_f32 v61, v78, v79
    s_add_u32 m0, s76, 131072
    s_lshl_b32 s6, s82, 18
    buffer_load_dwordx4 v6, s[56:59], s6 offen lds
    v_exp_f32 v81, v81
    s_waitcnt lgkmcnt(2)
    v_mfma_f32_32x32x16_bf16 v[192:207], v[184:187], v[140:143], v[192:207]
    v_exp_f32 v82, v82
    v_cvt_pk_bf16_f32 v62, v80, v81
    v_exp_f32 v83, v83
    v_mfma_f32_32x32x16_bf16 v[224:239], v[188:191], v[140:143], v[224:239]
    v_exp_f32 v84, v84
    ds_read_b128 v[140:143], v11 offset:16384
    v_cvt_pk_bf16_f32 v63, v82, v83
    s_add_u32 s6, s79, s72
    buffer_load_dwordx4 v[180:183], v4, s[52:55], s6 offen offset:0 sc1
    v_exp_f32 v85, v85
    v_exp_f32 v86, v86
    v_mfma_f32_32x32x16_bf16 v[124:139], v[52:55], v[68:71], v[124:139]
    v_cvt_pk_bf16_f32 v64, v84, v85
    v_exp_f32 v87, v87
    v_exp_f32 v88, v88
    v_mfma_f32_32x32x16_bf16 v[124:139], v[56:59], v[72:75], v[124:139]
    v_cvt_pk_bf16_f32 v65, v86, v87
    ds_read_b128 v[52:55], v2 offset:38912
    v_exp_f32 v89, v89
    ds_read_b128 v[56:59], v2 offset:39936
    v_exp_f32 v90, v90
    v_smfmac_f32_16x16x64_bf16 v[40:43], v[32:35], v[68:75], v159
    v_cvt_pk_bf16_f32 v66, v88, v89
    v_exp_f32 v91, v91
    v_exp_f32 v92, v92
    v_cvt_pk_bf16_f32 v67, v90, v91
    s_waitcnt lgkmcnt(3)
    v_mfma_f32_32x32x16_bf16 v[76:91], v[44:47], v[16:19], 0
    v_exp_f32 v93, v93
    v_exp_f32 v94, v94
    s_add_u32 m0, s76, 132096
    s_lshl_b32 s6, s82, 18
    buffer_load_dwordx4 v7, s[56:59], s6 offen lds
    s_add_u32 s82, s82, 1
    s_and_b32 s82, s82, 7
    v_cvt_pk_bf16_f32 v68, v92, v93
    v_mfma_f32_32x32x16_bf16 v[76:91], v[48:51], v[20:23], v[76:91]
    v_exp_f32 v95, v95
    v_exp_f32 v96, v96
    v_cvt_pk_bf16_f32 v69, v94, v95
    v_exp_f32 v97, v97
    s_waitcnt lgkmcnt(2)
    v_mfma_f32_32x32x16_bf16 v[208:223], v[184:187], v[140:143], v[208:223]
    v_exp_f32 v98, v98
    v_cvt_pk_bf16_f32 v70, v96, v97
    v_exp_f32 v99, v99
    v_mfma_f32_32x32x16_bf16 v[240:255], v[188:191], v[140:143], v[240:255]
    v_exp_f32 v100, v100
    ds_read_b128 v[140:143], v8 offset:32768
    v_cvt_pk_bf16_f32 v71, v98, v99
    s_add_u32 s6, s79, s71
    buffer_load_dwordx4 v[184:187], v4, s[52:55], s6 offen offset:1024 sc1
    v_exp_f32 v101, v101
    v_exp_f32 v102, v102
    s_waitcnt lgkmcnt(1)
    v_mfma_f32_32x32x16_bf16 v[108:123], v[52:55], v[60:63], v[108:123]
    v_cvt_pk_bf16_f32 v72, v100, v101
    v_exp_f32 v103, v103
    v_exp_f32 v104, v104
    v_mfma_f32_32x32x16_bf16 v[108:123], v[56:59], v[64:67], v[108:123]
    v_cvt_pk_bf16_f32 v73, v102, v103
    v_exp_f32 v105, v105
    v_exp_f32 v106, v106
    v_smfmac_f32_16x16x64_bf16 v[36:39], v[32:35], v[60:67], v159
    v_cvt_pk_bf16_f32 v74, v104, v105
    v_exp_f32 v107, v107
    v_exp_f32 v76, v76
    v_cvt_pk_bf16_f32 v75, v106, v107
    v_mfma_f32_32x32x16_bf16 v[92:107], v[44:47], v[24:27], 0
    v_exp_f32 v77, v77
    v_exp_f32 v78, v78
    s_add_u32 m0, s75, 65536
    s_nop 0
    buffer_load_dwordx4 v5, s[44:47], s80 offen lds
    v_cvt_pk_bf16_f32 v60, v76, v77
    v_mfma_f32_32x32x16_bf16 v[92:107], v[48:51], v[28:31], v[92:107]
    v_exp_f32 v79, v79
    ds_read_b128 v[44:47], v2 offset:53248
    v_exp_f32 v80, v80
    ds_read_b128 v[48:51], v2 offset:54272
    v_cvt_pk_bf16_f32 v61, v78, v79
    v_exp_f32 v81, v81
    s_waitcnt vmcnt(11)
    s_waitcnt lgkmcnt(2)
    v_mfma_f32_32x32x16_bf16 v[192:207], v[160:163], v[140:143], v[192:207]
    v_exp_f32 v82, v82
    v_cvt_pk_bf16_f32 v62, v80, v81
    v_exp_f32 v83, v83
    v_mfma_f32_32x32x16_bf16 v[224:239], v[164:167], v[140:143], v[224:239]
    v_exp_f32 v84, v84
    ds_read_b128 v[140:143], v10 offset:32768
    v_cvt_pk_bf16_f32 v63, v82, v83
    s_add_u32 s6, s79, s72
    buffer_load_dwordx4 v[188:191], v4, s[52:55], s6 offen offset:1024 sc1
    s_add_u32 s79, s79, 8192
    s_and_b32 s79, s79, 131071
    v_exp_f32 v85, v85
    v_exp_f32 v86, v86
    v_mfma_f32_32x32x16_bf16 v[124:139], v[52:55], v[68:71], v[124:139]
    v_cvt_pk_bf16_f32 v64, v84, v85
    v_exp_f32 v87, v87
    v_exp_f32 v88, v88
    v_mfma_f32_32x32x16_bf16 v[124:139], v[56:59], v[72:75], v[124:139]
    v_cvt_pk_bf16_f32 v65, v86, v87
    ds_read_b128 v[52:55], v2 offset:51200
    v_exp_f32 v89, v89
    ds_read_b128 v[56:59], v2 offset:52224
    v_exp_f32 v90, v90
    v_smfmac_f32_16x16x64_bf16 v[40:43], v[32:35], v[68:75], v159
    v_cvt_pk_bf16_f32 v66, v88, v89
    v_exp_f32 v91, v91
    v_exp_f32 v92, v92
    v_cvt_pk_bf16_f32 v67, v90, v91
    s_waitcnt lgkmcnt(3)
    v_mfma_f32_32x32x16_bf16 v[76:91], v[44:47], v[16:19], 0
    v_exp_f32 v93, v93
    v_exp_f32 v94, v94
    s_add_u32 m0, s75, 73728
    s_nop 0
    buffer_load_dwordx4 v5, s[48:51], s80 offen lds
    s_add_u32 s80, s80, 128
    s_and_b32 s80, s80, 2047
    v_cvt_pk_bf16_f32 v68, v92, v93
    v_mfma_f32_32x32x16_bf16 v[76:91], v[48:51], v[20:23], v[76:91]
    v_exp_f32 v95, v95
    v_exp_f32 v96, v96
    v_cvt_pk_bf16_f32 v69, v94, v95
    v_exp_f32 v97, v97
    s_waitcnt lgkmcnt(2)
    v_mfma_f32_32x32x16_bf16 v[208:223], v[160:163], v[140:143], v[208:223]
    v_exp_f32 v98, v98
    v_cvt_pk_bf16_f32 v70, v96, v97
    v_exp_f32 v99, v99
    v_mfma_f32_32x32x16_bf16 v[240:255], v[164:167], v[140:143], v[240:255]
    v_exp_f32 v100, v100
    ds_read_b128 v[140:143], v9 offset:32768
    v_cvt_pk_bf16_f32 v71, v98, v99
    s_add_u32 s6, s79, s71
    buffer_load_dwordx4 v[160:163], v4, s[52:55], s6 offen offset:0 sc1
    v_exp_f32 v101, v101
    v_exp_f32 v102, v102
    s_waitcnt lgkmcnt(1)
    v_mfma_f32_32x32x16_bf16 v[108:123], v[52:55], v[60:63], v[108:123]
    v_cvt_pk_bf16_f32 v72, v100, v101
    v_exp_f32 v103, v103
    v_exp_f32 v104, v104
    v_mfma_f32_32x32x16_bf16 v[108:123], v[56:59], v[64:67], v[108:123]
    v_cvt_pk_bf16_f32 v73, v102, v103
    v_exp_f32 v105, v105
    v_exp_f32 v106, v106
    v_smfmac_f32_16x16x64_bf16 v[36:39], v[32:35], v[60:67], v159
    v_cvt_pk_bf16_f32 v74, v104, v105
    v_exp_f32 v107, v107
    v_exp_f32 v76, v76
    v_cvt_pk_bf16_f32 v75, v106, v107
    v_mfma_f32_32x32x16_bf16 v[92:107], v[44:47], v[24:27], 0
    v_exp_f32 v77, v77
    v_exp_f32 v78, v78
    v_cvt_pk_bf16_f32 v60, v76, v77
    v_mfma_f32_32x32x16_bf16 v[92:107], v[48:51], v[28:31], v[92:107]
    v_exp_f32 v79, v79
    s_waitcnt vmcnt(9)
    s_barrier
    v_exp_f32 v80, v80
    v_cvt_pk_bf16_f32 v61, v78, v79
    s_add_u32 m0, s75, 81920
    s_nop 0
    buffer_load_dwordx4 v5, s[44:47], s80 offen lds
    v_exp_f32 v81, v81
    s_waitcnt lgkmcnt(0)
    v_mfma_f32_32x32x16_bf16 v[192:207], v[168:171], v[140:143], v[192:207]
    v_exp_f32 v82, v82
    v_cvt_pk_bf16_f32 v62, v80, v81
    v_exp_f32 v83, v83
    v_mfma_f32_32x32x16_bf16 v[224:239], v[172:175], v[140:143], v[224:239]
    v_exp_f32 v84, v84
    ds_read_b128 v[140:143], v11 offset:32768
    v_cvt_pk_bf16_f32 v63, v82, v83
    s_add_u32 s6, s79, s72
    buffer_load_dwordx4 v[164:167], v4, s[52:55], s6 offen offset:0 sc1
    v_exp_f32 v85, v85
    v_exp_f32 v86, v86
    v_mfma_f32_32x32x16_bf16 v[124:139], v[52:55], v[68:71], v[124:139]
    v_cvt_pk_bf16_f32 v64, v84, v85
    v_exp_f32 v87, v87
    v_exp_f32 v88, v88
    v_mfma_f32_32x32x16_bf16 v[124:139], v[56:59], v[72:75], v[124:139]
    v_cvt_pk_bf16_f32 v65, v86, v87
    ds_read_b128 v[52:55], v2 offset:55296
    v_exp_f32 v89, v89
    ds_read_b128 v[56:59], v2 offset:56320
    v_exp_f32 v90, v90
    v_smfmac_f32_16x16x64_bf16 v[40:43], v[32:35], v[68:75], v159
    v_cvt_pk_bf16_f32 v66, v88, v89
    v_exp_f32 v91, v91
    v_exp_f32 v92, v92
    v_cvt_pk_bf16_f32 v67, v90, v91
    v_exp_f32 v93, v93
    v_exp_f32 v94, v94
    s_add_u32 m0, s75, 90112
    s_nop 0
    buffer_load_dwordx4 v5, s[48:51], s80 offen lds
    s_add_u32 s80, s80, 128
    s_and_b32 s80, s80, 2047
    v_cvt_pk_bf16_f32 v68, v92, v93
    v_exp_f32 v95, v95
    v_exp_f32 v96, v96
    v_cvt_pk_bf16_f32 v69, v94, v95
    v_exp_f32 v97, v97
    s_waitcnt lgkmcnt(2)
    v_mfma_f32_32x32x16_bf16 v[208:223], v[168:171], v[140:143], v[208:223]
    v_exp_f32 v98, v98
    v_cvt_pk_bf16_f32 v70, v96, v97
    v_exp_f32 v99, v99
    v_mfma_f32_32x32x16_bf16 v[240:255], v[172:175], v[140:143], v[240:255]
    v_exp_f32 v100, v100
    v_cvt_pk_bf16_f32 v71, v98, v99
    s_add_u32 s6, s79, s71
    buffer_load_dwordx4 v[168:171], v4, s[52:55], s6 offen offset:1024 sc1
    v_exp_f32 v101, v101
    v_exp_f32 v102, v102
    s_waitcnt lgkmcnt(0)
    v_mfma_f32_32x32x16_bf16 v[108:123], v[52:55], v[60:63], v[108:123]
    v_cvt_pk_bf16_f32 v72, v100, v101
    v_exp_f32 v103, v103
    v_exp_f32 v104, v104
    v_mfma_f32_32x32x16_bf16 v[108:123], v[56:59], v[64:67], v[108:123]
    v_cvt_pk_bf16_f32 v73, v102, v103
    v_exp_f32 v105, v105
    v_exp_f32 v106, v106
    s_add_u32 s6, s79, s72
    buffer_load_dwordx4 v[172:175], v4, s[52:55], s6 offen offset:1024 sc1
    s_add_u32 s79, s79, 8192
    s_and_b32 s79, s79, 131071
    v_smfmac_f32_16x16x64_bf16 v[36:39], v[32:35], v[60:67], v159
    v_cvt_pk_bf16_f32 v74, v104, v105
    v_exp_f32 v107, v107
    s_nop 0
    v_cvt_pk_bf16_f32 v75, v106, v107
    v_mfma_f32_32x32x16_bf16 v[124:139], v[52:55], v[68:71], v[124:139]
    s_nop 0
    v_smfmac_f32_16x16x64_bf16 v[40:43], v[32:35], v[68:75], v159
    v_mfma_f32_32x32x16_bf16 v[124:139], v[56:59], v[72:75], v[124:139]
    s_sub_u32 s15, s82, 2
    s_and_b32 s15, s15, 7
    s_lshl_b32 s6, s3, 12
    v_add_u32 v148, s6, v4
    v_xor_b32 v149, 16384, v148
    s_lshl_b32 s6, s3, 8
    s_add_u32 s6, s6, 147456
    v_lshl_add_u32 v150, v0, 2, s6
    v_xor_b32 v151, 1024, v150
    s_add_u32 s6, s79, s71
    s_add_u32 s7, s79, s72
    buffer_load_dwordx4 v[44:47], v4, s[52:55], s6 offen offset:0 sc1
    buffer_load_dwordx4 v[48:51], v4, s[52:55], s7 offen offset:0 sc1
    s_add_u32 s6, s79, s71
    s_add_u32 s7, s79, s72
    buffer_load_dwordx4 v[52:55], v4, s[52:55], s6 offen offset:1024 sc1
    buffer_load_dwordx4 v[56:59], v4, s[52:55], s7 offen offset:1024 sc1
    s_add_u32 s79, s79, 8192
    s_and_b32 s79, s79, 131071
    s_add_u32 s6, s79, s71
    s_add_u32 s7, s79, s72
    buffer_load_dwordx4 v[60:63], v4, s[52:55], s6 offen offset:0 sc1
    buffer_load_dwordx4 v[64:67], v4, s[52:55], s7 offen offset:0 sc1
    s_add_u32 s6, s79, s71
    s_add_u32 s7, s79, s72
    buffer_load_dwordx4 v[68:71], v4, s[52:55], s6 offen offset:1024 sc1
    buffer_load_dwordx4 v[72:75], v4, s[52:55], s7 offen offset:1024 sc1
    s_add_u32 s79, s79, 8192
    s_and_b32 s79, s79, 131071
    v_add_f32 v36, v36, v37
    v_add_f32 v40, v40, v41
    s_nop 3
    ds_write_b128 v148, v[124:127] offset:16384
    ds_write_b128 v148, v[128:131] offset:17408
    ds_write_b128 v148, v[132:135] offset:18432
    ds_write_b128 v148, v[136:139] offset:19456
    ds_write_b32 v150, v40
    v_bfe_u32 v152, v0, 2, 1
    v_lshlrev_b32 v152, 16, v152
    v_bfe_u32 v153, v0, 3, 2
    v_lshl_add_u32 v152, v153, 6, v152
    v_and_b32 v153, 3, v0
    v_lshl_add_u32 v152, v153, 4, v152
    v_lshrrev_b32 v153, 5, v0
    v_lshl_add_u32 v152, v153, 9, v152
    s_lshl_b32 s6, s4, 3
    s_lshl_b32 s7, s65, 1
    s_add_u32 s6, s6, s7
    s_lshl_b32 s6, s6, 16
    s_lshl_b32 s7, s5, 11
    s_add_u32 s6, s6, s7
    s_lshl_b32 s7, s64, 8
    s_add_u32 s6, s6, s7
    s_add_u32 s77, s6, 20971520
    v_sub_f32 v15, 1.0, v15
    v_cvt_pk_bf16_f32 v15, v15, v15
    v_lshlrev_b32 v15, 16, v15
    s_waitcnt lgkmcnt(0)
    s_barrier
    ds_read_b32 v40, v151
    ds_read_b128 v[124:127], v149 offset:16384
    ds_read_b128 v[128:131], v149 offset:17408
    ds_read_b128 v[132:135], v149 offset:18432
    ds_read_b128 v[136:139], v149 offset:19456
    s_waitcnt lgkmcnt(4)
    v_add_f32 v36, v36, v40
    s_waitcnt lgkmcnt(3)
    v_add_f32 v108, v108, v124
    v_add_f32 v109, v109, v125
    v_add_f32 v110, v110, v126
    v_add_f32 v111, v111, v127
    s_waitcnt lgkmcnt(2)
    v_add_f32 v112, v112, v128
    v_add_f32 v113, v113, v129
    v_add_f32 v114, v114, v130
    v_add_f32 v115, v115, v131
    s_waitcnt lgkmcnt(1)
    v_add_f32 v116, v116, v132
    v_add_f32 v117, v117, v133
    v_add_f32 v118, v118, v134
    v_add_f32 v119, v119, v135
    s_waitcnt lgkmcnt(0)
    v_add_f32 v120, v120, v136
    v_add_f32 v121, v121, v137
    v_add_f32 v122, v122, v138
    v_add_f32 v123, v123, v139
    s_mov_b32 s83, 0
L_f_fin:
    v_rcp_f32 v148, v36
    v_mov_b32 v149, v36
    v_mul_f32 v148, v148, v15
    v_fmac_f32 v149, 0, v108
    v_mul_f32 v108, v148, v108
    v_fmac_f32 v149, 0, v109
    v_mul_f32 v109, v148, v109
    v_cvt_pk_bf16_f32 v24, v108, v109
    v_fmac_f32 v149, 0, v110
    v_mul_f32 v110, v148, v110
    v_fmac_f32 v149, 0, v111
    v_mul_f32 v111, v148, v111
    v_cvt_pk_bf16_f32 v25, v110, v111
    v_fmac_f32 v149, 0, v112
    v_mul_f32 v112, v148, v112
    v_fmac_f32 v149, 0, v113
    v_mul_f32 v113, v148, v113
    v_cvt_pk_bf16_f32 v26, v112, v113
    v_fmac_f32 v149, 0, v114
    v_mul_f32 v114, v148, v114
    v_fmac_f32 v149, 0, v115
    v_mul_f32 v115, v148, v115
    v_cvt_pk_bf16_f32 v27, v114, v115
    v_fmac_f32 v149, 0, v116
    v_mul_f32 v116, v148, v116
    v_fmac_f32 v149, 0, v117
    v_mul_f32 v117, v148, v117
    v_cvt_pk_bf16_f32 v28, v116, v117
    v_fmac_f32 v149, 0, v118
    v_mul_f32 v118, v148, v118
    v_fmac_f32 v149, 0, v119
    v_mul_f32 v119, v148, v119
    v_cvt_pk_bf16_f32 v29, v118, v119
    v_fmac_f32 v149, 0, v120
    v_mul_f32 v120, v148, v120
    v_fmac_f32 v149, 0, v121
    v_mul_f32 v121, v148, v121
    v_cvt_pk_bf16_f32 v30, v120, v121
    v_fmac_f32 v149, 0, v122
    v_mul_f32 v122, v148, v122
    v_fmac_f32 v149, 0, v123
    v_mul_f32 v123, v148, v123
    v_cvt_pk_bf16_f32 v31, v122, v123
    v_cmp_gt_f32 vcc, 0x5f800000, v149
    s_mov_b64 s[6:7], vcc
    v_cmp_lt_f32 vcc, 0x1f800000, v149
    s_and_b64 vcc, vcc, s[6:7]
    s_not_b64 vcc, vcc
    s_cmp_lg_u32 s83, 0
    s_cbranch_scc1 L_f_store
    s_cbranch_vccnz L_f_fallback
L_f_store:
    buffer_store_dwordx4 v[24:27], v152, s[52:55], s77 offen sc1
    buffer_store_dwordx4 v[28:31], v152, s[52:55], s77 offen offset:1024 sc1
    ds_read_b128 v[124:127], v8 offset:49152
    ds_read_b128 v[128:131], v10 offset:49152
    ds_read_b128 v[132:135], v9 offset:49152
    ds_read_b128 v[136:139], v11 offset:49152
    v_subrev_u32 v32, 65536, v8
    v_subrev_u32 v33, 65536, v9
    v_subrev_u32 v34, 65536, v10
    v_subrev_u32 v35, 65536, v11
    v_add_u32 v36, 65536, v12
    v_add_u32 v37, 65536, v13
    v_add_u32 v38, 131072, v12
    v_add_u32 v39, 131072, v13
    s_lshl_b32 s6, s4, 2
    s_add_u32 s6, s6, s65
    s_lshl_b32 s6, s6, 6
    s_lshl_b32 s7, s5, 1
    s_add_u32 s6, s6, s7
    s_add_u32 s6, s6, s64
    s_lshl_b32 s6, s6, 3
    s_add_u32 s12, s6, 27262976
    s_lshl_b32 s6, s68, 1
    s_add_u32 s6, s6, s67
    s_lshl_b32 s6, s6, 9
    s_add_u32 s14, s6, 27262976
    v_lshlrev_b32 v140, 3, v0
    v_bfe_u32 v141, v0, 1, 2
    v_cmp_eq_u32 s[10:11], s66, v141
    s_lshl_b32 s6, s70, 7
    s_and_b32 s6, s6, 511
    s_add_u32 s6, s6, 149504
    v_lshrrev_b32 v2, 5, v0
    v_lshl_add_u32 v2, v2, 4, s6
    v_xor_b32 v3, 128, v2
    s_mov_b32 s60, s34
    s_mov_b32 s61, s35
    s_mov_b32 s62, 8388608
    s_mov_b32 s63, 0x20000
    s_waitcnt vmcnt(17) lgkmcnt(0)
    v_mfma_f32_32x32x16_bf16 v[192:207], v[176:179], v[124:127], v[192:207]
    v_mfma_f32_32x32x16_bf16 v[192:207], v[184:187], v[132:135], v[192:207]
    s_waitcnt vmcnt(16)
    s_barrier
    ds_read_b128 v[108:111], v8 offset:0
    ds_read_b128 v[112:115], v10 offset:0
    v_mfma_f32_32x32x16_bf16 v[208:223], v[176:179], v[128:131], v[208:223]
    ds_read_b128 v[116:119], v9 offset:0
    ds_read_b128 v[120:123], v11 offset:0
    v_mfma_f32_32x32x16_bf16 v[208:223], v[184:187], v[136:139], v[208:223]
    s_add_u32 m0, s75, 98304
    s_nop 0
    buffer_load_dwordx4 v5, s[44:47], s80 offen lds
    s_add_u32 m0, s75, 106496
    s_nop 0
    buffer_load_dwordx4 v5, s[48:51], s80 offen lds
    s_add_u32 s80, s80, 128
    s_and_b32 s80, s80, 2047
    s_add_u32 m0, s75, 49152
    s_nop 0
    buffer_load_dwordx4 v5, s[44:47], s80 offen lds
    s_add_u32 m0, s75, 57344
    s_nop 0
    buffer_load_dwordx4 v5, s[48:51], s80 offen lds
    s_add_u32 s80, s80, 128
    s_and_b32 s80, s80, 2047
    v_mfma_f32_32x32x16_bf16 v[224:239], v[180:183], v[124:127], v[224:239]
    v_mfma_f32_32x32x16_bf16 v[224:239], v[188:191], v[132:135], v[224:239]
    v_mfma_f32_32x32x16_bf16 v[240:255], v[180:183], v[128:131], v[240:255]
    v_mfma_f32_32x32x16_bf16 v[240:255], v[188:191], v[136:139], v[240:255]
    s_waitcnt vmcnt(4)
    v_mov_b32 v40, s26
    v_mov_b32 v41, s27
    v_mov_b32 v42, 0
    s_mov_b64 exec, 1
    buffer_store_dwordx2 v[40:41], v42, s[52:55], s12 offen sc1
    s_mov_b64 exec, -1
    s_waitcnt vmcnt(15) lgkmcnt(0)
    v_mfma_f32_32x32x16_bf16 v[192:207], v[160:163], v[108:111], v[192:207]
    v_mfma_f32_32x32x16_bf16 v[192:207], v[168:171], v[116:119], v[192:207]
    s_waitcnt vmcnt(17)
    s_barrier
    ds_read_b128 v[124:127], v8 offset:16384
    ds_read_b128 v[128:131], v10 offset:16384
    v_mfma_f32_32x32x16_bf16 v[208:223], v[160:163], v[112:115], v[208:223]
    ds_read_b128 v[132:135], v9 offset:16384
    ds_read_b128 v[136:139], v11 offset:16384
    v_mfma_f32_32x32x16_bf16 v[208:223], v[168:171], v[120:123], v[208:223]
    s_add_u32 s6, s79, s71
    s_add_u32 s7, s79, s72
    buffer_load_dwordx4 v[76:79], v4, s[52:55], s6 offen offset:0 sc1
    buffer_load_dwordx4 v[80:83], v4, s[52:55], s7 offen offset:0 sc1
    s_add_u32 s6, s79, s71
    s_add_u32 s7, s79, s72
    buffer_load_dwordx4 v[84:87], v4, s[52:55], s6 offen offset:1024 sc1
    buffer_load_dwordx4 v[88:91], v4, s[52:55], s7 offen offset:1024 sc1
    s_add_u32 s79, s79, 8192
    s_and_b32 s79, s79, 131071
    s_add_u32 m0, s76, 16384
    s_lshl_b32 s6, s82, 18
    buffer_load_dwordx4 v6, s[56:59], s6 offen lds
    s_add_u32 m0, m0, 1024
    s_add_u32 s82, s82, 1
    buffer_load_dwordx4 v7, s[56:59], s6 offen lds
    s_and_b32 s82, s82, 7
    s_add_u32 m0, s76, 32768
    s_lshl_b32 s6, s82, 18
    buffer_load_dwordx4 v6, s[56:59], s6 offen lds
    s_add_u32 m0, m0, 1024
    s_add_u32 s82, s82, 1
    buffer_load_dwordx4 v7, s[56:59], s6 offen lds
    s_and_b32 s82, s82, 7
    v_mfma_f32_32x32x16_bf16 v[224:239], v[164:167], v[108:111], v[224:239]
    v_mfma_f32_32x32x16_bf16 v[224:239], v[172:175], v[116:119], v[224:239]
    v_mfma_f32_32x32x16_bf16 v[240:255], v[164:167], v[112:115], v[240:255]
    v_mfma_f32_32x32x16_bf16 v[240:255], v[172:175], v[120:123], v[240:255]
    s_waitcnt vmcnt(19) lgkmcnt(0)
    v_mfma_f32_32x32x16_bf16 v[192:207], v[44:47], v[124:127], v[192:207]
    v_mfma_f32_32x32x16_bf16 v[192:207], v[52:55], v[132:135], v[192:207]
    s_waitcnt vmcnt(11)
    s_barrier
    ds_read_b128 v[108:111], v8 offset:32768
    ds_read_b128 v[112:115], v10 offset:32768
    v_mfma_f32_32x32x16_bf16 v[208:223], v[44:47], v[128:131], v[208:223]
    ds_read_b128 v[116:119], v9 offset:32768
    ds_read_b128 v[120:123], v11 offset:32768
    v_mfma_f32_32x32x16_bf16 v[208:223], v[52:55], v[136:139], v[208:223]
    s_add_u32 m0, s76, 114688
    s_lshl_b32 s6, s82, 18
    buffer_load_dwordx4 v6, s[56:59], s6 offen lds
    s_add_u32 m0, m0, 1024
    s_add_u32 s82, s82, 1
    buffer_load_dwordx4 v7, s[56:59], s6 offen lds
    s_and_b32 s82, s82, 7
    s_add_u32 m0, s76, 65536
    s_lshl_b32 s6, s82, 18
    buffer_load_dwordx4 v6, s[56:59], s6 offen lds
    s_add_u32 m0, m0, 1024
    s_add_u32 s82, s82, 1
    buffer_load_dwordx4 v7, s[56:59], s6 offen lds
    s_and_b32 s82, s82, 7
    v_mfma_f32_32x32x16_bf16 v[224:239], v[48:51], v[124:127], v[224:239]
    v_mfma_f32_32x32x16_bf16 v[224:239], v[56:59], v[132:135], v[224:239]
    v_mfma_f32_32x32x16_bf16 v[240:255], v[48:51], v[128:131], v[240:255]
    v_mfma_f32_32x32x16_bf16 v[240:255], v[56:59], v[136:139], v[240:255]
    s_waitcnt vmcnt(19) lgkmcnt(0)
    v_mfma_f32_32x32x16_bf16 v[192:207], v[60:63], v[108:111], v[192:207]
    v_mfma_f32_32x32x16_bf16 v[192:207], v[68:71], v[116:119], v[192:207]
    s_waitcnt vmcnt(13)
    s_barrier
    ds_read_b128 v[124:127], v32 offset:49152
    ds_read_b128 v[128:131], v34 offset:49152
    v_mfma_f32_32x32x16_bf16 v[208:223], v[60:63], v[112:115], v[208:223]
    ds_read_b128 v[132:135], v33 offset:49152
    ds_read_b128 v[136:139], v35 offset:49152
    v_mfma_f32_32x32x16_bf16 v[208:223], v[68:71], v[120:123], v[208:223]
    s_add_u32 m0, s76, 81920
    s_lshl_b32 s6, s82, 18
    buffer_load_dwordx4 v6, s[56:59], s6 offen lds
    s_add_u32 m0, m0, 1024
    s_add_u32 s82, s82, 1
    buffer_load_dwordx4 v7, s[56:59], s6 offen lds
    s_and_b32 s82, s82, 7
    s_add_u32 m0, s76, 98304
    s_lshl_b32 s6, s82, 18
    buffer_load_dwordx4 v6, s[56:59], s6 offen lds
    s_add_u32 m0, m0, 1024
    s_add_u32 s82, s82, 1
    buffer_load_dwordx4 v7, s[56:59], s6 offen lds
    s_and_b32 s82, s82, 7
    v_mfma_f32_32x32x16_bf16 v[224:239], v[64:67], v[108:111], v[224:239]
    v_mfma_f32_32x32x16_bf16 v[224:239], v[72:75], v[116:119], v[224:239]
    v_mfma_f32_32x32x16_bf16 v[240:255], v[64:67], v[112:115], v[240:255]
    v_mfma_f32_32x32x16_bf16 v[240:255], v[72:75], v[120:123], v[240:255]
    buffer_load_dwordx2 v[142:143], v140, s[52:55], s14 offen sc1
    s_waitcnt vmcnt(13) lgkmcnt(0)
    v_mfma_f32_32x32x16_bf16 v[192:207], v[76:79], v[124:127], v[192:207]
    v_mfma_f32_32x32x16_bf16 v[192:207], v[84:87], v[132:135], v[192:207]
    s_waitcnt vmcnt(9)
    s_barrier
    ds_read_b64_tr_b16 v[108:109], v12 offset:0
    ds_read_b64_tr_b16 v[110:111], v12 offset:1024
    ds_read_b64_tr_b16 v[112:113], v13 offset:0
    ds_read_b64_tr_b16 v[114:115], v13 offset:1024
    v_mfma_f32_32x32x16_bf16 v[208:223], v[76:79], v[128:131], v[208:223]
    ds_read_b64_tr_b16 v[116:117], v12 offset:2048
    ds_read_b64_tr_b16 v[118:119], v12 offset:3072
    ds_read_b64_tr_b16 v[120:121], v13 offset:2048
    ds_read_b64_tr_b16 v[122:123], v13 offset:3072
    v_mfma_f32_32x32x16_bf16 v[208:223], v[84:87], v[136:139], v[208:223]
    v_mfma_f32_32x32x16_bf16 v[224:239], v[80:83], v[124:127], v[224:239]
    v_mfma_f32_32x32x16_bf16 v[224:239], v[88:91], v[132:135], v[224:239]
    v_mfma_f32_32x32x16_bf16 v[240:255], v[80:83], v[128:131], v[240:255]
    v_mfma_f32_32x32x16_bf16 v[240:255], v[88:91], v[136:139], v[240:255]
    ds_read_b128 v[124:127], v2 offset:0
    ds_read_b128 v[128:131], v2 offset:32
    ds_read_b128 v[132:135], v2 offset:64
    ds_read_b128 v[136:139], v2 offset:96
    s_waitcnt vmcnt(0)
    s_mov_b32 s83, 0
L_p4:
    v_cmp_ne_u64 vcc, s[26:27], v[142:143]
    s_and_b64 vcc, vcc, s[10:11]
    s_cbranch_vccz L_p4k
    s_add_u32 s83, s83, 1
    s_cmp_ge_u32 s83, 65536
    s_cbranch_scc1 L_p4k
    buffer_load_dwordx2 v[142:143], v140, s[52:55], s14 offen sc1
    s_waitcnt vmcnt(0)
    s_branch L_p4
L_p4k:
    s_lshl_b32 s79, s15, 13
    s_add_u32 s6, s79, s73
    s_add_u32 s7, s79, s74
    buffer_load_dwordx4 v[92:95], v4, s[52:55], s6 offen offset:0 sc1
    buffer_load_dwordx4 v[96:99], v4, s[52:55], s7 offen offset:0 sc1
    s_add_u32 s6, s79, s73
    s_add_u32 s7, s79, s74
    buffer_load_dwordx4 v[100:103], v4, s[52:55], s6 offen offset:1024 sc1
    buffer_load_dwordx4 v[104:107], v4, s[52:55], s7 offen offset:1024 sc1
    s_add_u32 s79, s79, 8192
    s_and_b32 s79, s79, 65535
    s_add_u32 s6, s79, s73
    s_add_u32 s7, s79, s74
    buffer_load_dwordx4 v[16:19], v4, s[52:55], s6 offen offset:0 sc1
    buffer_load_dwordx4 v[20:23], v4, s[52:55], s7 offen offset:0 sc1
    s_add_u32 s6, s79, s73
    s_add_u32 s7, s79, s74
    buffer_load_dwordx4 v[24:27], v4, s[52:55], s6 offen offset:1024 sc1
    buffer_load_dwordx4 v[28:31], v4, s[52:55], s7 offen offset:1024 sc1
    s_add_u32 s79, s79, 8192
    s_and_b32 s79, s79, 65535
    s_waitcnt vmcnt(4) lgkmcnt(0)
    v_mul_f32 v192, v192, v124
    v_mul_f32 v193, v193, v125
    v_mul_f32 v194, v194, v126
    v_mul_f32 v195, v195, v127
    v_mul_f32 v196, v196, v128
    v_mul_f32 v197, v197, v129
    v_mul_f32 v198, v198, v130
    v_mul_f32 v199, v199, v131
    v_mul_f32 v200, v200, v132
    v_mul_f32 v201, v201, v133
    v_mul_f32 v202, v202, v134
    v_mul_f32 v203, v203, v135
    v_mul_f32 v204, v204, v136
    v_mul_f32 v205, v205, v137
    v_mul_f32 v206, v206, v138
    v_mul_f32 v207, v207, v139
    v_mul_f32 v208, v208, v124
    v_mul_f32 v209, v209, v125
    v_mul_f32 v210, v210, v126
    v_mul_f32 v211, v211, v127
    v_mul_f32 v212, v212, v128
    v_mul_f32 v213, v213, v129
    v_mul_f32 v214, v214, v130
    v_mul_f32 v215, v215, v131
    v_mul_f32 v216, v216, v132
    v_mul_f32 v217, v217, v133
    v_mul_f32 v218, v218, v134
    v_mul_f32 v219, v219, v135
    v_mul_f32 v220, v220, v136
    v_mul_f32 v221, v221, v137
    v_mul_f32 v222, v222, v138
    v_mul_f32 v223, v223, v139
    ds_read_b128 v[124:127], v3 offset:0
    ds_read_b128 v[128:131], v3 offset:32
    ds_read_b128 v[132:135], v3 offset:64
    ds_read_b128 v[136:139], v3 offset:96
    s_waitcnt lgkmcnt(0)
    v_mul_f32 v224, v224, v124
    v_mul_f32 v225, v225, v125
    v_mul_f32 v226, v226, v126
    v_mul_f32 v227, v227, v127
    v_mul_f32 v228, v228, v128
    v_mul_f32 v229, v229, v129
    v_mul_f32 v230, v230, v130
    v_mul_f32 v231, v231, v131
    v_mul_f32 v232, v232, v132
    v_mul_f32 v233, v233, v133
    v_mul_f32 v234, v234, v134
    v_mul_f32 v235, v235, v135
    v_mul_f32 v236, v236, v136
    v_mul_f32 v237, v237, v137
    v_mul_f32 v238, v238, v138
    v_mul_f32 v239, v239, v139
    v_mul_f32 v240, v240, v124
    v_mul_f32 v241, v241, v125
    v_mul_f32 v242, v242, v126
    v_mul_f32 v243, v243, v127
    v_mul_f32 v244, v244, v128
    v_mul_f32 v245, v245, v129
    v_mul_f32 v246, v246, v130
    v_mul_f32 v247, v247, v131
    v_mul_f32 v248, v248, v132
    v_mul_f32 v249, v249, v133
    v_mul_f32 v250, v250, v134
    v_mul_f32 v251, v251, v135
    v_mul_f32 v252, v252, v136
    v_mul_f32 v253, v253, v137
    v_mul_f32 v254, v254, v138
    v_mul_f32 v255, v255, v139
    v_mfma_f32_32x32x16_bf16 v[192:207], v[92:95], v[108:111], v[192:207]
    v_mfma_f32_32x32x16_bf16 v[192:207], v[100:103], v[116:119], v[192:207]
    ds_read_b64_tr_b16 v[124:125], v38 offset:0
    ds_read_b64_tr_b16 v[126:127], v38 offset:1024
    ds_read_b64_tr_b16 v[128:129], v39 offset:0
    ds_read_b64_tr_b16 v[130:131], v39 offset:1024
    v_mfma_f32_32x32x16_bf16 v[208:223], v[92:95], v[112:115], v[208:223]
    ds_read_b64_tr_b16 v[132:133], v38 offset:2048
    ds_read_b64_tr_b16 v[134:135], v38 offset:3072
    ds_read_b64_tr_b16 v[136:137], v39 offset:2048
    ds_read_b64_tr_b16 v[138:139], v39 offset:3072
    v_mfma_f32_32x32x16_bf16 v[208:223], v[100:103], v[120:123], v[208:223]
    v_mfma_f32_32x32x16_bf16 v[224:239], v[96:99], v[108:111], v[224:239]
    v_mfma_f32_32x32x16_bf16 v[224:239], v[104:107], v[116:119], v[224:239]
    v_mfma_f32_32x32x16_bf16 v[240:255], v[96:99], v[112:115], v[240:255]
    v_mfma_f32_32x32x16_bf16 v[240:255], v[104:107], v[120:123], v[240:255]
    s_add_u32 s6, s79, s73
    s_add_u32 s7, s79, s74
    buffer_load_dwordx4 v[144:147], v4, s[52:55], s6 offen offset:0 sc1
    buffer_load_dwordx4 v[148:151], v4, s[52:55], s7 offen offset:0 sc1
    s_add_u32 s6, s79, s73
    s_add_u32 s7, s79, s74
    buffer_load_dwordx4 v[152:155], v4, s[52:55], s6 offen offset:1024 sc1
    buffer_load_dwordx4 v[156:159], v4, s[52:55], s7 offen offset:1024 sc1
    s_add_u32 s79, s79, 8192
    s_and_b32 s79, s79, 65535
    s_waitcnt vmcnt(4) lgkmcnt(0)
    v_mfma_f32_32x32x16_bf16 v[192:207], v[16:19], v[124:127], v[192:207]
    v_mfma_f32_32x32x16_bf16 v[192:207], v[24:27], v[132:135], v[192:207]
    ds_read_b64_tr_b16 v[108:109], v12 offset:16384
    ds_read_b64_tr_b16 v[110:111], v12 offset:17408
    ds_read_b64_tr_b16 v[112:113], v13 offset:16384
    ds_read_b64_tr_b16 v[114:115], v13 offset:17408
    v_mfma_f32_32x32x16_bf16 v[208:223], v[16:19], v[128:131], v[208:223]
    ds_read_b64_tr_b16 v[116:117], v12 offset:18432
    ds_read_b64_tr_b16 v[118:119], v12 offset:19456
    ds_read_b64_tr_b16 v[120:121], v13 offset:18432
    ds_read_b64_tr_b16 v[122:123], v13 offset:19456
    v_mfma_f32_32x32x16_bf16 v[208:223], v[24:27], v[136:139], v[208:223]
    v_mfma_f32_32x32x16_bf16 v[224:239], v[20:23], v[124:127], v[224:239]
    v_mfma_f32_32x32x16_bf16 v[224:239], v[28:31], v[132:135], v[224:239]
    v_mfma_f32_32x32x16_bf16 v[240:255], v[20:23], v[128:131], v[240:255]
    v_mfma_f32_32x32x16_bf16 v[240:255], v[28:31], v[136:139], v[240:255]
    s_add_u32 s6, s79, s73
    s_add_u32 s7, s79, s74
    buffer_load_dwordx4 v[176:179], v4, s[52:55], s6 offen offset:0 sc1
    buffer_load_dwordx4 v[180:183], v4, s[52:55], s7 offen offset:0 sc1
    s_add_u32 s6, s79, s73
    s_add_u32 s7, s79, s74
    buffer_load_dwordx4 v[184:187], v4, s[52:55], s6 offen offset:1024 sc1
    buffer_load_dwordx4 v[188:191], v4, s[52:55], s7 offen offset:1024 sc1
    s_add_u32 s79, s79, 8192
    s_and_b32 s79, s79, 65535
    s_waitcnt vmcnt(4) lgkmcnt(0)
    v_mfma_f32_32x32x16_bf16 v[192:207], v[144:147], v[108:111], v[192:207]
    v_mfma_f32_32x32x16_bf16 v[192:207], v[152:155], v[116:119], v[192:207]
    ds_read_b64_tr_b16 v[124:125], v12 offset:32768
    ds_read_b64_tr_b16 v[126:127], v12 offset:33792
    ds_read_b64_tr_b16 v[128:129], v13 offset:32768
    ds_read_b64_tr_b16 v[130:131], v13 offset:33792
    v_mfma_f32_32x32x16_bf16 v[208:223], v[144:147], v[112:115], v[208:223]
    ds_read_b64_tr_b16 v[132:133], v12 offset:34816
    ds_read_b64_tr_b16 v[134:135], v12 offset:35840
    ds_read_b64_tr_b16 v[136:137], v13 offset:34816
    ds_read_b64_tr_b16 v[138:139], v13 offset:35840
    v_mfma_f32_32x32x16_bf16 v[208:223], v[152:155], v[120:123], v[208:223]
    v_mfma_f32_32x32x16_bf16 v[224:239], v[148:151], v[108:111], v[224:239]
    v_mfma_f32_32x32x16_bf16 v[224:239], v[156:159], v[116:119], v[224:239]
    v_mfma_f32_32x32x16_bf16 v[240:255], v[148:151], v[112:115], v[240:255]
    v_mfma_f32_32x32x16_bf16 v[240:255], v[156:159], v[120:123], v[240:255]
    s_add_u32 s6, s79, s73
    s_add_u32 s7, s79, s74
    buffer_load_dwordx4 v[160:163], v4, s[52:55], s6 offen offset:0 sc1
    buffer_load_dwordx4 v[164:167], v4, s[52:55], s7 offen offset:0 sc1
    s_add_u32 s6, s79, s73
    s_add_u32 s7, s79, s74
    buffer_load_dwordx4 v[168:171], v4, s[52:55], s6 offen offset:1024 sc1
    buffer_load_dwordx4 v[172:175], v4, s[52:55], s7 offen offset:1024 sc1
    s_add_u32 s79, s79, 8192
    s_and_b32 s79, s79, 65535
    s_waitcnt vmcnt(4) lgkmcnt(0)
    v_mfma_f32_32x32x16_bf16 v[192:207], v[176:179], v[124:127], v[192:207]
    v_mfma_f32_32x32x16_bf16 v[192:207], v[184:187], v[132:135], v[192:207]
    s_waitcnt vmcnt(21)
    s_barrier
    ds_read_b64_tr_b16 v[108:109], v36 offset:49152
    ds_read_b64_tr_b16 v[110:111], v36 offset:50176
    ds_read_b64_tr_b16 v[112:113], v37 offset:49152
    ds_read_b64_tr_b16 v[114:115], v37 offset:50176
    v_mfma_f32_32x32x16_bf16 v[208:223], v[176:179], v[128:131], v[208:223]
    ds_read_b64_tr_b16 v[116:117], v36 offset:51200
    ds_read_b64_tr_b16 v[118:119], v36 offset:52224
    ds_read_b64_tr_b16 v[120:121], v37 offset:51200
    ds_read_b64_tr_b16 v[122:123], v37 offset:52224
    v_mfma_f32_32x32x16_bf16 v[208:223], v[184:187], v[136:139], v[208:223]
    v_mfma_f32_32x32x16_bf16 v[224:239], v[180:183], v[124:127], v[224:239]
    v_mfma_f32_32x32x16_bf16 v[224:239], v[188:191], v[132:135], v[224:239]
    v_mfma_f32_32x32x16_bf16 v[240:255], v[180:183], v[128:131], v[240:255]
    v_mfma_f32_32x32x16_bf16 v[240:255], v[188:191], v[136:139], v[240:255]
    s_add_u32 s6, s79, s73
    s_add_u32 s7, s79, s74
    buffer_load_dwordx4 v[44:47], v4, s[52:55], s6 offen offset:0 sc1
    buffer_load_dwordx4 v[48:51], v4, s[52:55], s7 offen offset:0 sc1
    s_add_u32 s6, s79, s73
    s_add_u32 s7, s79, s74
    buffer_load_dwordx4 v[52:55], v4, s[52:55], s6 offen offset:1024 sc1
    buffer_load_dwordx4 v[56:59], v4, s[52:55], s7 offen offset:1024 sc1
    s_add_u32 s79, s79, 8192
    s_and_b32 s79, s79, 65535
    s_waitcnt vmcnt(4) lgkmcnt(0)
    v_mfma_f32_32x32x16_bf16 v[192:207], v[160:163], v[108:111], v[192:207]
    v_mfma_f32_32x32x16_bf16 v[192:207], v[168:171], v[116:119], v[192:207]
    ds_read_b64_tr_b16 v[124:125], v36 offset:0
    ds_read_b64_tr_b16 v[126:127], v36 offset:1024
    ds_read_b64_tr_b16 v[128:129], v37 offset:0
    ds_read_b64_tr_b16 v[130:131], v37 offset:1024
    v_mfma_f32_32x32x16_bf16 v[208:223], v[160:163], v[112:115], v[208:223]
    ds_read_b64_tr_b16 v[132:133], v36 offset:2048
    ds_read_b64_tr_b16 v[134:135], v36 offset:3072
    ds_read_b64_tr_b16 v[136:137], v37 offset:2048
    ds_read_b64_tr_b16 v[138:139], v37 offset:3072
    v_mfma_f32_32x32x16_bf16 v[208:223], v[168:171], v[120:123], v[208:223]
    v_mfma_f32_32x32x16_bf16 v[224:239], v[164:167], v[108:111], v[224:239]
    v_mfma_f32_32x32x16_bf16 v[224:239], v[172:175], v[116:119], v[224:239]
    v_mfma_f32_32x32x16_bf16 v[240:255], v[164:167], v[112:115], v[240:255]
    v_mfma_f32_32x32x16_bf16 v[240:255], v[172:175], v[120:123], v[240:255]
    s_add_u32 s6, s79, s73
    s_add_u32 s7, s79, s74
    buffer_load_dwordx4 v[60:63], v4, s[52:55], s6 offen offset:0 sc1
    buffer_load_dwordx4 v[64:67], v4, s[52:55], s7 offen offset:0 sc1
    s_add_u32 s6, s79, s73
    s_add_u32 s7, s79, s74
    buffer_load_dwordx4 v[68:71], v4, s[52:55], s6 offen offset:1024 sc1
    buffer_load_dwordx4 v[72:75], v4, s[52:55], s7 offen offset:1024 sc1
    s_add_u32 s79, s79, 8192
    s_and_b32 s79, s79, 65535
    s_waitcnt vmcnt(4) lgkmcnt(0)
    v_mfma_f32_32x32x16_bf16 v[192:207], v[44:47], v[124:127], v[192:207]
    v_mfma_f32_32x32x16_bf16 v[192:207], v[52:55], v[132:135], v[192:207]
    ds_read_b64_tr_b16 v[108:109], v36 offset:16384
    ds_read_b64_tr_b16 v[110:111], v36 offset:17408
    ds_read_b64_tr_b16 v[112:113], v37 offset:16384
    ds_read_b64_tr_b16 v[114:115], v37 offset:17408
    v_mfma_f32_32x32x16_bf16 v[208:223], v[44:47], v[128:131], v[208:223]
    ds_read_b64_tr_b16 v[116:117], v36 offset:18432
    ds_read_b64_tr_b16 v[118:119], v36 offset:19456
    ds_read_b64_tr_b16 v[120:121], v37 offset:18432
    ds_read_b64_tr_b16 v[122:123], v37 offset:19456
    v_mfma_f32_32x32x16_bf16 v[208:223], v[52:55], v[136:139], v[208:223]
    v_mfma_f32_32x32x16_bf16 v[224:239], v[48:51], v[124:127], v[224:239]
    v_mfma_f32_32x32x16_bf16 v[224:239], v[56:59], v[132:135], v[224:239]
    v_mfma_f32_32x32x16_bf16 v[240:255], v[48:51], v[128:131], v[240:255]
    v_mfma_f32_32x32x16_bf16 v[240:255], v[56:59], v[136:139], v[240:255]
    s_add_u32 s6, s79, s73
    s_add_u32 s7, s79, s74
    buffer_load_dwordx4 v[76:79], v4, s[52:55], s6 offen offset:0 sc1
    buffer_load_dwordx4 v[80:83], v4, s[52:55], s7 offen offset:0 sc1
    s_add_u32 s6, s79, s73
    s_add_u32 s7, s79, s74
    buffer_load_dwordx4 v[84:87], v4, s[52:55], s6 offen offset:1024 sc1
    buffer_load_dwordx4 v[88:91], v4, s[52:55], s7 offen offset:1024 sc1
    s_add_u32 s79, s79, 8192
    s_and_b32 s79, s79, 65535
    s_waitcnt vmcnt(4) lgkmcnt(0)
    v_mfma_f32_32x32x16_bf16 v[192:207], v[60:63], v[108:111], v[192:207]
    v_mfma_f32_32x32x16_bf16 v[192:207], v[68:71], v[116:119], v[192:207]
    s_barrier
    ds_read_b64_tr_b16 v[124:125], v36 offset:32768
    ds_read_b64_tr_b16 v[126:127], v36 offset:33792
    ds_read_b64_tr_b16 v[128:129], v37 offset:32768
    ds_read_b64_tr_b16 v[130:131], v37 offset:33792
    v_mfma_f32_32x32x16_bf16 v[208:223], v[60:63], v[112:115], v[208:223]
    ds_read_b64_tr_b16 v[132:133], v36 offset:34816
    ds_read_b64_tr_b16 v[134:135], v36 offset:35840
    ds_read_b64_tr_b16 v[136:137], v37 offset:34816
    ds_read_b64_tr_b16 v[138:139], v37 offset:35840
    v_mfma_f32_32x32x16_bf16 v[208:223], v[68:71], v[120:123], v[208:223]
    s_xor_b32 s6, s3, 2
    s_cmp_ge_u32 s6, 4
    s_mov_b32 s7, 0
    s_cmov_b32 s7, 0
    s_lshl_b32 s6, s6, 12
    s_add_u32 s6, s6, s7
    v_add_u32 v33, s6, v4
    s_cmp_ge_u32 s3, 4
    s_mov_b32 s7, 0
    s_cmov_b32 s7, 0
    s_lshl_b32 s6, s3, 12
    s_add_u32 s6, s6, s7
    v_add_u32 v41, s6, v4
    s_xor_b32 s6, s3, 4
    s_cmp_ge_u32 s6, 4
    s_mov_b32 s7, 32768
    s_cmov_b32 s7, 32768
    s_lshl_b32 s6, s6, 12
    s_add_u32 s6, s6, s7
    v_add_u32 v34, s6, v4
    s_cmp_ge_u32 s3, 4
    s_mov_b32 s7, 32768
    s_cmov_b32 s7, 32768
    s_lshl_b32 s6, s3, 12
    s_add_u32 s6, s6, s7
    v_add_u32 v42, s6, v4
    s_xor_b32 s6, s3, 6
    s_cmp_ge_u32 s6, 4
    s_mov_b32 s7, 65536
    s_cmov_b32 s7, 65536
    s_lshl_b32 s6, s6, 12
    s_add_u32 s6, s6, s7
    v_add_u32 v35, s6, v4
    s_cmp_ge_u32 s3, 4
    s_mov_b32 s7, 65536
    s_cmov_b32 s7, 65536
    s_lshl_b32 s6, s3, 12
    s_add_u32 s6, s6, s7
    v_add_u32 v43, s6, v4
    v_mfma_f32_32x32x16_bf16 v[224:239], v[64:67], v[108:111], v[224:239]
    v_mfma_f32_32x32x16_bf16 v[224:239], v[72:75], v[116:119], v[224:239]
    v_mfma_f32_32x32x16_bf16 v[240:255], v[64:67], v[112:115], v[240:255]
    v_mfma_f32_32x32x16_bf16 v[240:255], v[72:75], v[120:123], v[240:255]
    s_waitcnt vmcnt(0) lgkmcnt(0)
    v_mfma_f32_32x32x16_bf16 v[208:223], v[76:79], v[128:131], v[208:223]
    v_mfma_f32_32x32x16_bf16 v[208:223], v[84:87], v[136:139], v[208:223]
    v_mfma_f32_32x32x16_bf16 v[224:239], v[80:83], v[124:127], v[224:239]
    v_mfma_f32_32x32x16_bf16 v[224:239], v[88:91], v[132:135], v[224:239]
    v_mfma_f32_32x32x16_bf16 v[240:255], v[80:83], v[128:131], v[240:255]
    v_mfma_f32_32x32x16_bf16 v[240:255], v[88:91], v[136:139], v[240:255]
    ds_write_b128 v33, v[208:211] offset:0
    ds_write_b128 v33, v[212:215] offset:1024
    ds_write_b128 v33, v[216:219] offset:2048
    ds_write_b128 v33, v[220:223] offset:3072
    v_mfma_f32_32x32x16_bf16 v[192:207], v[76:79], v[124:127], v[192:207]
    ds_write_b128 v34, v[224:227] offset:0
    ds_write_b128 v34, v[228:231] offset:1024
    ds_write_b128 v34, v[232:235] offset:2048
    ds_write_b128 v34, v[236:239] offset:3072
    v_mfma_f32_32x32x16_bf16 v[192:207], v[84:87], v[132:135], v[192:207]
    s_nop 7
    ds_write_b128 v35, v[240:243] offset:0
    ds_write_b128 v35, v[244:247] offset:1024
    ds_write_b128 v35, v[248:251] offset:2048
    ds_write_b128 v35, v[252:255] offset:3072
    s_waitcnt lgkmcnt(0)
    s_barrier
    ds_read_b128 v[208:211], v41 offset:0
    ds_read_b128 v[224:227], v42 offset:0
    ds_read_b128 v[240:243], v43 offset:0
    ds_read_b128 v[212:215], v41 offset:1024
    ds_read_b128 v[228:231], v42 offset:1024
    ds_read_b128 v[244:247], v43 offset:1024
    ds_read_b128 v[216:219], v41 offset:2048
    ds_read_b128 v[232:235], v42 offset:2048
    ds_read_b128 v[248:251], v43 offset:2048
    ds_read_b128 v[220:223], v41 offset:3072
    ds_read_b128 v[236:239], v42 offset:3072
    ds_read_b128 v[252:255], v43 offset:3072
    s_waitcnt lgkmcnt(9)
    v_add_f32 v192, v192, v208
    v_add_f32 v224, v224, v240
    v_add_f32 v193, v193, v209
    v_add_f32 v225, v225, v241
    v_add_f32 v194, v194, v210
    v_add_f32 v226, v226, v242
    v_add_f32 v195, v195, v211
    v_add_f32 v227, v227, v243
    v_add_f32 v192, v192, v224
    v_add_f32 v193, v193, v225
    v_add_f32 v194, v194, v226
    v_add_f32 v195, v195, v227
    s_mov_b32 s6, 0
    buffer_store_dword v192, v14, s[60:63], s6 offen nt
    s_mov_b32 s6, 4096
    buffer_store_dword v193, v14, s[60:63], s6 offen nt
    s_mov_b32 s6, 8192
    buffer_store_dword v194, v14, s[60:63], s6 offen nt
    s_mov_b32 s6, 12288
    buffer_store_dword v195, v14, s[60:63], s6 offen nt
    s_waitcnt lgkmcnt(6)
    v_add_f32 v196, v196, v212
    v_add_f32 v228, v228, v244
    v_add_f32 v197, v197, v213
    v_add_f32 v229, v229, v245
    v_add_f32 v198, v198, v214
    v_add_f32 v230, v230, v246
    v_add_f32 v199, v199, v215
    v_add_f32 v231, v231, v247
    v_add_f32 v196, v196, v228
    v_add_f32 v197, v197, v229
    v_add_f32 v198, v198, v230
    v_add_f32 v199, v199, v231
    s_mov_b32 s6, 32768
    buffer_store_dword v196, v14, s[60:63], s6 offen nt
    s_mov_b32 s6, 36864
    buffer_store_dword v197, v14, s[60:63], s6 offen nt
    s_mov_b32 s6, 40960
    buffer_store_dword v198, v14, s[60:63], s6 offen nt
    s_mov_b32 s6, 45056
    buffer_store_dword v199, v14, s[60:63], s6 offen nt
    s_waitcnt lgkmcnt(3)
    v_add_f32 v200, v200, v216
    v_add_f32 v232, v232, v248
    v_add_f32 v201, v201, v217
    v_add_f32 v233, v233, v249
    v_add_f32 v202, v202, v218
    v_add_f32 v234, v234, v250
    v_add_f32 v203, v203, v219
    v_add_f32 v235, v235, v251
    v_add_f32 v200, v200, v232
    v_add_f32 v201, v201, v233
    v_add_f32 v202, v202, v234
    v_add_f32 v203, v203, v235
    s_mov_b32 s6, 65536
    buffer_store_dword v200, v14, s[60:63], s6 offen nt
    s_mov_b32 s6, 69632
    buffer_store_dword v201, v14, s[60:63], s6 offen nt
    s_mov_b32 s6, 73728
    buffer_store_dword v202, v14, s[60:63], s6 offen nt
    s_mov_b32 s6, 77824
    buffer_store_dword v203, v14, s[60:63], s6 offen nt
    s_waitcnt lgkmcnt(0)
    v_add_f32 v204, v204, v220
    v_add_f32 v236, v236, v252
    v_add_f32 v205, v205, v221
    v_add_f32 v237, v237, v253
    v_add_f32 v206, v206, v222
    v_add_f32 v238, v238, v254
    v_add_f32 v207, v207, v223
    v_add_f32 v239, v239, v255
    v_add_f32 v204, v204, v236
    v_add_f32 v205, v205, v237
    v_add_f32 v206, v206, v238
    v_add_f32 v207, v207, v239
    s_mov_b32 s6, 98304
    buffer_store_dword v204, v14, s[60:63], s6 offen nt
    s_mov_b32 s6, 102400
    buffer_store_dword v205, v14, s[60:63], s6 offen nt
    s_mov_b32 s6, 106496
    buffer_store_dword v206, v14, s[60:63], s6 offen nt
    s_mov_b32 s6, 110592
    buffer_store_dword v207, v14, s[60:63], s6 offen nt
L_end:
    s_endpgm
L_f_fallback:
    s_mov_b32 s83, 1
    s_mov_b32 s78, 0
    v_mov_b32 v148, 0xff800000
    s_waitcnt vmcnt(0)
L_f_fb1:
    buffer_load_dwordx4 v[44:47], v4, s[40:43], s78 offen sc1
    buffer_load_dwordx4 v[48:51], v4, s[40:43], s78 offen offset:1024 sc1
    s_waitcnt vmcnt(0)
    v_mfma_f32_32x32x16_bf16 v[76:91], v[44:47], v[16:19], 0
    v_mfma_f32_32x32x16_bf16 v[76:91], v[48:51], v[20:23], v[76:91]
    s_nop 7
    s_nop 7
    s_nop 7
    v_max3_f32 v148, v148, v76, v77
    v_max3_f32 v148, v148, v78, v79
    v_max3_f32 v148, v148, v80, v81
    v_max3_f32 v148, v148, v82, v83
    v_max3_f32 v148, v148, v84, v85
    v_max3_f32 v148, v148, v86, v87
    v_max3_f32 v148, v148, v88, v89
    v_max3_f32 v148, v148, v90, v91
    s_add_u32 s78, s78, 4096
    s_cmp_lt_u32 s78, 262144
    s_cbranch_scc1 L_f_fb1
    v_mov_b32 v149, v148
    s_nop 1
    v_permlane32_swap_b32 v148, v149
    s_nop 1
    v_max_f32 v148, v148, v149
    v_sub_f32 v92, 0, v148
    v_mov_b32 v108, 0
    v_sub_f32 v93, 0, v148
    v_mov_b32 v109, 0
    v_sub_f32 v94, 0, v148
    v_mov_b32 v110, 0
    v_sub_f32 v95, 0, v148
    v_mov_b32 v111, 0
    v_sub_f32 v96, 0, v148
    v_mov_b32 v112, 0
    v_sub_f32 v97, 0, v148
    v_mov_b32 v113, 0
    v_sub_f32 v98, 0, v148
    v_mov_b32 v114, 0
    v_sub_f32 v99, 0, v148
    v_mov_b32 v115, 0
    v_sub_f32 v100, 0, v148
    v_mov_b32 v116, 0
    v_sub_f32 v101, 0, v148
    v_mov_b32 v117, 0
    v_sub_f32 v102, 0, v148
    v_mov_b32 v118, 0
    v_sub_f32 v103, 0, v148
    v_mov_b32 v119, 0
    v_sub_f32 v104, 0, v148
    v_mov_b32 v120, 0
    v_sub_f32 v105, 0, v148
    v_mov_b32 v121, 0
    v_sub_f32 v106, 0, v148
    v_mov_b32 v122, 0
    v_sub_f32 v107, 0, v148
    v_mov_b32 v123, 0
    v_mov_b32 v36, 0
    v_mov_b32 v37, 0
    v_mov_b32 v38, 0
    v_mov_b32 v39, 0
    s_mov_b32 s78, 0
L_f_fb2:
    buffer_load_dwordx4 v[44:47], v4, s[40:43], s78 offen sc1
    buffer_load_dwordx4 v[48:51], v4, s[40:43], s78 offen offset:1024 sc1
    buffer_load_dwordx4 v[52:55], v4, s[40:43], s78 offen offset:2048 sc1
    buffer_load_dwordx4 v[56:59], v4, s[40:43], s78 offen offset:3072 sc1
    s_waitcnt vmcnt(0)
    v_mfma_f32_32x32x16_bf16 v[76:91], v[44:47], v[16:19], v[92:107]
    v_mfma_f32_32x32x16_bf16 v[76:91], v[48:51], v[20:23], v[76:91]
    s_nop 7
    s_nop 7
    s_nop 7
    v_exp_f32 v76, v76
    v_exp_f32 v77, v77
    v_exp_f32 v78, v78
    v_exp_f32 v79, v79
    v_exp_f32 v80, v80
    v_exp_f32 v81, v81
    v_exp_f32 v82, v82
    v_exp_f32 v83, v83
    v_exp_f32 v84, v84
    v_exp_f32 v85, v85
    v_exp_f32 v86, v86
    v_exp_f32 v87, v87
    v_exp_f32 v88, v88
    v_exp_f32 v89, v89
    v_exp_f32 v90, v90
    v_exp_f32 v91, v91
    s_nop 1
    v_cvt_pk_bf16_f32 v60, v76, v77
    v_cvt_pk_bf16_f32 v61, v78, v79
    v_cvt_pk_bf16_f32 v62, v80, v81
    v_cvt_pk_bf16_f32 v63, v82, v83
    v_cvt_pk_bf16_f32 v64, v84, v85
    v_cvt_pk_bf16_f32 v65, v86, v87
    v_cvt_pk_bf16_f32 v66, v88, v89
    v_cvt_pk_bf16_f32 v67, v90, v91
    s_nop 1
    v_mfma_f32_32x32x16_bf16 v[108:123], v[52:55], v[60:63], v[108:123]
    v_mfma_f32_32x32x16_bf16 v[108:123], v[56:59], v[64:67], v[108:123]
    v_smfmac_f32_16x16x64_bf16 v[36:39], v[32:35], v[60:67], v159
    s_nop 7
    s_nop 7
    s_nop 7
    s_add_u32 s78, s78, 4096
    s_cmp_lt_u32 s78, 262144
    s_cbranch_scc1 L_f_fb2
    s_sub_u32 s79, s79, 16384
    s_and_b32 s79, s79, 131071
    s_add_u32 s6, s79, s71
    s_add_u32 s7, s79, s72
    buffer_load_dwordx4 v[44:47], v4, s[52:55], s6 offen offset:0 sc1
    buffer_load_dwordx4 v[48:51], v4, s[52:55], s7 offen offset:0 sc1
    s_add_u32 s6, s79, s71
    s_add_u32 s7, s79, s72
    buffer_load_dwordx4 v[52:55], v4, s[52:55], s6 offen offset:1024 sc1
    buffer_load_dwordx4 v[56:59], v4, s[52:55], s7 offen offset:1024 sc1
    s_add_u32 s79, s79, 8192
    s_and_b32 s79, s79, 131071
    s_add_u32 s6, s79, s71
    s_add_u32 s7, s79, s72
    buffer_load_dwordx4 v[60:63], v4, s[52:55], s6 offen offset:0 sc1
    buffer_load_dwordx4 v[64:67], v4, s[52:55], s7 offen offset:0 sc1
    s_add_u32 s6, s79, s71
    s_add_u32 s7, s79, s72
    buffer_load_dwordx4 v[68:71], v4, s[52:55], s6 offen offset:1024 sc1
    buffer_load_dwordx4 v[72:75], v4, s[52:55], s7 offen offset:1024 sc1
    s_add_u32 s79, s79, 8192
    s_and_b32 s79, s79, 131071
    v_add_f32 v36, v36, v37
    s_waitcnt vmcnt(0)
    s_branch L_f_fin
L_codeend:
.section .rodata,"a"
.p2align 6
.amdhsa_kernel gated_mix__ssm_conv_s5__softmax_full_mha__prompt_kernel
  .amdhsa_next_free_vgpr 256
  .amdhsa_next_free_sgpr 102
  .amdhsa_accum_offset 256
  .amdhsa_group_segment_fixed_size 0
  .amdhsa_kernarg_size 128
  .amdhsa_user_sgpr_count 2
  .amdhsa_user_sgpr_kernarg_segment_ptr 1
  .amdhsa_system_sgpr_workgroup_id_x 1
.end_amdhsa_kernel
```
